```python
import torch

def _softmax(x, axis=-1):
    return torch.softmax(x, dim=axis)
def _gelu(x):
    return torch.nn.functional.gelu(x, approximate="tanh")
def _silu(x):
    return torch.nn.functional.silu(x)
def _sigmoid(x):
    return torch.sigmoid(x)
def _layernorm(x, axis=-1, eps=1e-5):
    m = x.mean(dim=axis, keepdim=True)
    v = x.var(dim=axis, keepdim=True, unbiased=False)
    return (x - m) / torch.sqrt(v + eps)
def _scatter_add(tgt, idx, src, axis=0):
    return tgt.clone().index_add_(axis, idx, src)
def _segment_sum(src, seg, n):
    out = torch.zeros((n,) + src.shape[1:], dtype=src.dtype)
    return out.index_add_(0, seg, src)
def _pad(x, pw):
    flat = tuple(v for pair in reversed(pw) for v in pair)
    return torch.nn.functional.pad(x, flat)

kernel_name = 'standalone__mha_softmax__near_ridge'

def setup_inputs():

    _w = (lambda a: (lambda t: t.to(torch.bfloat16) if t.is_floating_point() else t)(torch.as_tensor(a)))
    B, H, Sq, Sk, D = 8, 32, 1600, 512, 128
    return {
        "q": _w((lambda *s: torch.randn(*s, dtype=torch.bfloat16) * 0.8)(B, H, Sq, D)),
        "k": _w((lambda *s: torch.randn(*s, dtype=torch.bfloat16) * 0.8)(B, H, Sk, D)),
        "v": _w((lambda *s: torch.randn(*s, dtype=torch.bfloat16) * 0.05)(B, H, Sk, D)),
    }

def reference(q, k, v):
    scale = q.shape[-1] ** -0.5
    scores = torch.einsum("bhqd,bhkd->bhqk", q, k) * scale
    p = _softmax(scores, axis=-1)
    return torch.einsum("bhqk,bhkd->bhqd", p, v)
```

```asm
; @launch grid=(256,1,1) block=(256,1,1) lds=163840
.amdgcn_target "amdgcn-amd-amdhsa--gfx950"
.text
.globl standalone__mha_softmax__near_ridge_kernel
.p2align 8
.type standalone__mha_softmax__near_ridge_kernel,@function
standalone__mha_softmax__near_ridge_kernel:
    s_cmp_ge_u32 s2, 256
    s_cbranch_scc1 L_end
    s_load_dwordx4 s[32:35], s[0:1], 0
    s_load_dwordx4 s[36:39], s[0:1], 16
    v_lshrrev_b32 v165, 6, v0
    v_and_b32 v160, 63, v0
    v_readfirstlane_b32 s20, v165
    v_lshrrev_b32 v161, 4, v160
    v_bfe_u32 v162, v160, 2, 2
    v_and_b32 v163, 3, v160
    v_and_b32 v164, 15, v160
    s_mul_i32 s30, s2, 409600
    s_lshl_b32 s31, s2, 17
    s_and_b32 s43, s20, 1
    s_lshl_b32 s43, s43, 1
    s_lshl_b32 s21, s20, 11
    s_lshl_b32 s44, s20, 12
    s_add_u32 s29, s31, s21
    v_xor_b32 v165, s43, v163
    v_lshlrev_b32 v165, 4, v165
    v_lshl_add_u32 v165, v161, 6, v165
    v_lshl_add_u32 v230, v162, 8, v165
    v_lshlrev_b32 v165, 8, v164
    v_add_u32 v165, s44, v165
    v_lshl_add_u32 v237, v161, 4, v165
    s_add_u32 s23, s21, 98304
    s_lshl_b32 s45, s20, 8
    s_add_u32 s45, s45, 98304
    s_mov_b32 s27, 0x3e0293ee
    s_waitcnt lgkmcnt(0)
    s_add_u32 s52, s34, s29
    s_addc_u32 s53, s35, 0
    s_add_u32 s4, s32, s30
    s_addc_u32 s5, s33, 0
    s_add_u32 s54, s36, s29
    s_addc_u32 s55, s37, 0
    s_add_u32 m0, s21, 0
    v_lshrrev_b32 v165, 3, v164
    global_load_lds_dwordx4 v230, s[52:53] offset:0 nt
    global_load_lds_dwordx4 v230, s[52:53] offset:1024 nt
    v_lshlrev_b32 v165, 1, v165
    v_xor_b32 v165, v165, v161
    v_lshlrev_b32 v165, 4, v165
    v_lshl_add_u32 v165, v163, 6, v165
    v_lshl_add_u32 v228, v162, 10, v165
    v_lshlrev_b32 v165, 4, v160
    v_add_u32 v231, s21, v165
    global_load_dwordx4 a[0:3], v237, s[4:5] offset:0 nt
    global_load_dwordx4 a[4:7], v237, s[4:5] offset:64 nt
    global_load_dwordx4 a[8:11], v237, s[4:5] offset:128 nt
    global_load_dwordx4 a[12:15], v237, s[4:5] offset:192 nt
    s_add_u32 s16, s38, s30
    s_addc_u32 s17, s39, 0
    s_mov_b32 s18, 409600
    s_mov_b32 s19, 0x20000
    s_lshr_b32 s26, s20, 1
    s_lshl_b32 s26, s26, 7
    s_xor_b32 s42, s26, 0x80
    s_lshl_b32 s24, s43, 5
    s_mov_b32 vcc_lo, 0xff00ff00
    s_mov_b32 vcc_hi, 0xff00ff00
    s_lshr_b32 s22, s2, 3
    s_getpc_b64 s[46:47]
L_pc:
    s_lshl_b32 s48, s22, 2
    s_add_u32 s48, s48, s20
    s_mul_i32 s48, s48, 512
    s_min_u32 s48, s48, L_main_end-L_pc-512
    s_add_u32 s46, s46, s48
    s_addc_u32 s47, s47, 0
    s_load_dword s49, s[46:47], 0
    s_load_dword s49, s[46:47], 64
    s_load_dword s49, s[46:47], 128
    s_load_dword s49, s[46:47], 192
    s_load_dword s49, s[46:47], 256
    s_load_dword s49, s[46:47], 320
    s_load_dword s49, s[46:47], 384
    s_load_dword s49, s[46:47], 448
    s_add_u32 m0, s21, 8192
    s_add_u32 s52, s52, 8192
    s_addc_u32 s53, s53, 0
    global_load_lds_dwordx4 v230, s[52:53] offset:0 nt
    global_load_lds_dwordx4 v230, s[52:53] offset:1024 nt
    s_add_u32 m0, s23, 32768
    s_add_u32 s52, s52, 8192
    s_addc_u32 s53, s53, 0
    v_and_b32 v165, 2, v161
    v_xor_b32 v165, v165, v163
    v_lshlrev_b32 v165, 4, v165
    v_lshl_add_u32 v165, v162, 6, v165
    v_lshl_add_u32 v165, v161, 10, v165
    v_add_u32 v232, s45, v165
    v_xor_b32 v233, 0x100, v232
    v_xor_b32 v234, 0x200, v232
    v_xor_b32 v235, 0x300, v232
    s_add_u32 s4, s4, 16384
    s_addc_u32 s5, s5, 0
    v_lshrrev_b32 v165, 1, v163
    v_add_u32 v165, -1, v165
    v_and_b32 v165, 0x3f803f80, v165
    v_accvgpr_write_b32 a132, v165
    v_accvgpr_write_b32 a133, v165
    v_accvgpr_write_b32 a134, v165
    v_accvgpr_write_b32 a135, v165
    v_and_b32 v165, 1, v163
    v_sub_u32 v165, 0, v165
    v_and_b32 v165, 0xaaaaaaaa, v165
    v_or_b32 v238, 0x44444444, v165
    v_accvgpr_write_b32 a112, 0
    v_accvgpr_write_b32 a113, 0
    v_accvgpr_write_b32 a114, 0
    v_accvgpr_write_b32 a115, 0
    v_accvgpr_write_b32 a116, 0
    v_accvgpr_write_b32 a117, 0
    v_accvgpr_write_b32 a118, 0
    v_accvgpr_write_b32 a119, 0
    v_add_u32 v239, 0x10000, v231
    v_add_u32 v229, 0x10000, v228
    v_accvgpr_write_b32 a120, 0
    v_accvgpr_write_b32 a121, 0
    v_accvgpr_write_b32 a122, 0
    v_accvgpr_write_b32 a123, 0
    v_accvgpr_write_b32 a124, 0
    v_accvgpr_write_b32 a125, 0
    v_accvgpr_write_b32 a126, 0
    v_accvgpr_write_b32 a127, 0
    v_accvgpr_write_b32 a128, 0
    v_accvgpr_write_b32 a129, 0
    v_accvgpr_write_b32 a130, 0
    v_accvgpr_write_b32 a131, 0
    v_add_u32 v236, 98304, v231
    v_mov_b32 v227, 0
    s_waitcnt vmcnt(7)
    s_waitcnt lgkmcnt(0)
    ds_read_b128 v[216:219], v231 offset:0
    global_load_lds_dwordx4 v230, s[54:55] offset:0 nt
    s_waitcnt lgkmcnt(0)
    v_lshlrev_b32 v244, 16, v216
    v_and_b32 v245, 0xffff0000, v216
    v_lshlrev_b32 v246, 16, v217
    v_and_b32 v247, 0xffff0000, v217
    v_mul_f32 v244, s27, v244
    v_mul_f32 v245, s27, v245
    v_mul_f32 v246, s27, v246
    v_mul_f32 v247, s27, v247
    v_cvt_pk_bf16_f32 v216, v244, v245
    v_cvt_pk_bf16_f32 v217, v246, v247
    v_lshlrev_b32 v244, 16, v218
    v_and_b32 v245, 0xffff0000, v218
    v_lshlrev_b32 v246, 16, v219
    v_and_b32 v247, 0xffff0000, v219
    v_mul_f32 v244, s27, v244
    v_mul_f32 v245, s27, v245
    v_mul_f32 v246, s27, v246
    v_mul_f32 v247, s27, v247
    v_cvt_pk_bf16_f32 v218, v244, v245
    v_cvt_pk_bf16_f32 v219, v246, v247
    ds_write_b128 v231, v[216:219] offset:0
    s_waitcnt vmcnt(7)
    ds_read_b128 v[220:223], v231 offset:1024
    global_load_lds_dwordx4 v230, s[54:55] offset:1024 nt
    s_add_u32 m0, s21, 16384
    s_add_u32 s54, s54, 8192
    s_addc_u32 s55, s55, 0
    s_waitcnt lgkmcnt(0)
    v_lshlrev_b32 v244, 16, v220
    v_and_b32 v245, 0xffff0000, v220
    v_lshlrev_b32 v246, 16, v221
    v_and_b32 v247, 0xffff0000, v221
    v_mul_f32 v244, s27, v244
    v_mul_f32 v245, s27, v245
    v_mul_f32 v246, s27, v246
    v_mul_f32 v247, s27, v247
    v_cvt_pk_bf16_f32 v220, v244, v245
    v_cvt_pk_bf16_f32 v221, v246, v247
    v_lshlrev_b32 v244, 16, v222
    v_and_b32 v245, 0xffff0000, v222
    v_lshlrev_b32 v246, 16, v223
    v_and_b32 v247, 0xffff0000, v223
    v_mul_f32 v244, s27, v244
    v_mul_f32 v245, s27, v245
    v_mul_f32 v246, s27, v246
    v_mul_f32 v247, s27, v247
    v_cvt_pk_bf16_f32 v222, v244, v245
    v_cvt_pk_bf16_f32 v223, v246, v247
    ds_write_b128 v231, v[220:223] offset:1024
    global_load_lds_dwordx4 v230, s[52:53] offset:0 nt
    s_waitcnt lgkmcnt(0)
    s_barrier
    ds_read_b128 a[80:83], v228 offset:0
    ds_read_b128 a[84:87], v228 offset:256
    ds_read_b128 a[88:91], v228 offset:512
    ds_read_b128 a[92:95], v228 offset:768
    s_waitcnt vmcnt(8) lgkmcnt(3)
    v_mfma_f32_16x16x32_bf16 v[200:203], a[80:83], a[0:3], -4.0
    ds_read_b128 a[80:83], v228 offset:4096
    s_waitcnt vmcnt(7) lgkmcnt(0)
    v_mfma_f32_16x16x32_bf16 v[200:203], a[84:87], a[4:7], v[200:203]
    global_load_lds_dwordx4 v230, s[52:53] offset:1024 nt
    s_add_u32 m0, s23, 40960
    s_add_u32 s52, s52, 8192
    s_addc_u32 s53, s53, 0
    ds_read_b128 a[84:87], v228 offset:4352
    s_waitcnt vmcnt(7)
    v_mfma_f32_16x16x32_bf16 v[200:203], a[88:91], a[8:11], v[200:203]
    global_load_lds_dwordx4 v230, s[54:55] offset:0 nt
    ds_read_b128 a[88:91], v228 offset:4608
    s_waitcnt vmcnt(7)
    v_mfma_f32_16x16x32_bf16 v[200:203], a[92:95], a[12:15], v[200:203]
    global_load_lds_dwordx4 v230, s[54:55] offset:1024 nt
    s_add_u32 m0, s21, 24576
    ds_read_b128 a[92:95], v228 offset:4864
    v_mfma_f32_16x16x32_bf16 v[204:207], a[80:83], a[0:3], -4.0
    s_waitcnt lgkmcnt(1)
    s_add_u32 s54, s54, 8192
    s_addc_u32 s55, s55, 0
    v_mfma_f32_16x16x32_bf16 v[204:207], a[84:87], a[4:7], v[204:207]
    v_exp_f32 v200, v200
    v_mfma_f32_16x16x32_bf16 v[204:207], a[88:91], a[8:11], v[204:207]
    v_exp_f32 v201, v201
    v_exp_f32 v202, v202
    v_exp_f32 v203, v203
    v_cvt_pk_bf16_f32 v160, v200, v201
    v_cvt_pk_bf16_f32 v161, v202, v203
    s_waitcnt lgkmcnt(0)
    v_mfma_f32_16x16x32_bf16 v[204:207], a[92:95], a[12:15], v[204:207]
    s_nop 0
    s_nop 0
    s_nop 0
    s_nop 0
    s_nop 0
    s_nop 0
    s_nop 0
    s_nop 0
    v_exp_f32 v204, v204
    v_exp_f32 v205, v205
    v_exp_f32 v206, v206
    v_exp_f32 v207, v207
    v_cvt_pk_bf16_f32 v162, v204, v205
    v_cvt_pk_bf16_f32 v163, v206, v207
    s_waitcnt vmcnt(7)
    ds_read_b128 v[216:219], v231 offset:8192
    global_load_lds_dwordx4 v230, s[52:53] offset:0 nt
    s_waitcnt lgkmcnt(0)
    v_lshlrev_b32 v244, 16, v216
    v_and_b32 v245, 0xffff0000, v216
    v_lshlrev_b32 v246, 16, v217
    v_and_b32 v247, 0xffff0000, v217
    v_mul_f32 v244, s27, v244
    v_mul_f32 v245, s27, v245
    v_mul_f32 v246, s27, v246
    v_mul_f32 v247, s27, v247
    v_cvt_pk_bf16_f32 v216, v244, v245
    v_cvt_pk_bf16_f32 v217, v246, v247
    v_lshlrev_b32 v244, 16, v218
    v_and_b32 v245, 0xffff0000, v218
    v_lshlrev_b32 v246, 16, v219
    v_and_b32 v247, 0xffff0000, v219
    v_mul_f32 v244, s27, v244
    v_mul_f32 v245, s27, v245
    v_mul_f32 v246, s27, v246
    v_mul_f32 v247, s27, v247
    v_cvt_pk_bf16_f32 v218, v244, v245
    v_cvt_pk_bf16_f32 v219, v246, v247
    ds_write_b128 v231, v[216:219] offset:8192
    s_waitcnt vmcnt(7)
    ds_read_b128 v[220:223], v231 offset:9216
    global_load_lds_dwordx4 v230, s[52:53] offset:1024 nt
    s_add_u32 m0, s23, 49152
    s_add_u32 s52, s52, 8192
    s_addc_u32 s53, s53, 0
    s_waitcnt lgkmcnt(0)
    v_lshlrev_b32 v244, 16, v220
    v_and_b32 v245, 0xffff0000, v220
    v_lshlrev_b32 v246, 16, v221
    v_and_b32 v247, 0xffff0000, v221
    v_mul_f32 v244, s27, v244
    v_mul_f32 v245, s27, v245
    v_mul_f32 v246, s27, v246
    v_mul_f32 v247, s27, v247
    v_cvt_pk_bf16_f32 v220, v244, v245
    v_cvt_pk_bf16_f32 v221, v246, v247
    v_lshlrev_b32 v244, 16, v222
    v_and_b32 v245, 0xffff0000, v222
    v_lshlrev_b32 v246, 16, v223
    v_and_b32 v247, 0xffff0000, v223
    v_mul_f32 v244, s27, v244
    v_mul_f32 v245, s27, v245
    v_mul_f32 v246, s27, v246
    v_mul_f32 v247, s27, v247
    v_cvt_pk_bf16_f32 v222, v244, v245
    v_cvt_pk_bf16_f32 v223, v246, v247
    ds_write_b128 v231, v[220:223] offset:9216
    global_load_lds_dwordx4 v230, s[54:55] offset:0 nt
    s_waitcnt vmcnt(7) lgkmcnt(0)
    s_barrier
    ds_read_b64_tr_b16 a[104:105], v233 offset:32768
    ds_read_b64_tr_b16 a[106:107], v233 offset:36864
    ds_read_b64_tr_b16 a[108:109], v233 offset:32776
    ds_read_b64_tr_b16 a[110:111], v233 offset:36872
    ds_read_b128 a[80:83], v228 offset:8192
    ds_read_b128 a[84:87], v228 offset:8448
    ds_read_b128 a[88:91], v228 offset:8704
    ds_read_b64_tr_b16 a[136:137], v232 offset:32768
    ds_read_b64_tr_b16 a[138:139], v232 offset:36864
    ds_read_b64_tr_b16 a[140:141], v232 offset:32776
    ds_read_b64_tr_b16 a[142:143], v232 offset:36872
    ds_read_b64_tr_b16 a[96:97], v234 offset:32768
    ds_read_b64_tr_b16 a[98:99], v234 offset:36864
    ds_read_b64_tr_b16 a[100:101], v234 offset:32776
    ds_read_b64_tr_b16 a[102:103], v234 offset:36872
    ds_read_b128 a[92:95], v228 offset:8960
    s_waitcnt lgkmcnt(11)
    v_mfma_f32_16x16x32_bf16 v[208:211], a[80:83], a[0:3], -4.0
    s_waitcnt lgkmcnt(10)
    ds_read_b128 a[80:83], v228 offset:12288
    v_mfma_f32_16x16x32_bf16 v[208:211], a[84:87], a[4:7], v[208:211]
    s_waitcnt lgkmcnt(10)
    ds_read_b128 a[84:87], v228 offset:12544
    v_mfma_f32_16x16x32_bf16 v[208:211], a[88:91], a[8:11], v[208:211]
    s_waitcnt vmcnt(6)
    ds_read_b128 v[216:219], v231 offset:16384
    ds_read_b128 a[88:91], v228 offset:12800
    s_waitcnt lgkmcnt(4)
    v_mfma_f32_16x16x32_bf16 v[208:211], a[92:95], a[12:15], v[208:211]
    ds_read_b128 a[92:95], v228 offset:13056
    global_load_lds_dwordx4 v230, s[54:55] offset:1024 nt
    s_add_u32 m0, s21, 32768
    v_mfma_f32_16x16x32_bf16 v[0:3], a[136:139], v[160:163], 0
    global_load_dwordx4 a[16:19], v237, s[4:5] offset:0 nt
    v_mfma_f32_16x16x32_bf16 v[4:7], a[140:143], v[160:163], 0
    s_add_u32 s54, s54, 8192
    s_addc_u32 s55, s55, 0
    v_mfma_f32_16x16x32_bf16 v[8:11], a[104:107], v[160:163], 0
    s_waitcnt lgkmcnt(2)
    v_lshlrev_b32 v244, 16, v216
    v_and_b32 v245, 0xffff0000, v216
    v_lshlrev_b32 v246, 16, v217
    v_and_b32 v247, 0xffff0000, v217
    v_mul_f32 v244, s27, v244
    v_mul_f32 v245, s27, v245
    v_mul_f32 v246, s27, v246
    v_mul_f32 v247, s27, v247
    v_cvt_pk_bf16_f32 v216, v244, v245
    v_cvt_pk_bf16_f32 v217, v246, v247
    v_lshlrev_b32 v244, 16, v218
    v_and_b32 v245, 0xffff0000, v218
    v_lshlrev_b32 v246, 16, v219
    v_and_b32 v247, 0xffff0000, v219
    v_mul_f32 v244, s27, v244
    v_mul_f32 v245, s27, v245
    v_mul_f32 v246, s27, v246
    v_mul_f32 v247, s27, v247
    v_cvt_pk_bf16_f32 v218, v244, v245
    v_cvt_pk_bf16_f32 v219, v246, v247
    ds_write_b128 v231, v[216:219] offset:16384
    v_mfma_f32_16x16x32_bf16 v[12:15], a[108:111], v[160:163], 0
    ds_read_b64_tr_b16 a[104:105], v235 offset:32768
    ds_read_b64_tr_b16 a[106:107], v235 offset:36864
    ds_read_b64_tr_b16 a[108:109], v235 offset:32776
    s_waitcnt vmcnt(7)
    ds_read_b128 v[220:223], v231 offset:17408
    ds_read_b64_tr_b16 a[110:111], v235 offset:36872
    global_load_dwordx4 a[20:23], v237, s[4:5] offset:64 nt
    v_mfma_f32_16x16x32_bf16 v[212:215], a[80:83], a[0:3], -4.0
    v_exp_f32 v208, v208
    v_mfma_f32_16x16x32_bf16 v[212:215], a[84:87], a[4:7], v[212:215]
    s_waitcnt lgkmcnt(5)
    v_exp_f32 v209, v209
    v_mfma_f32_16x16x32_bf16 v[212:215], a[88:91], a[8:11], v[212:215]
    v_exp_f32 v210, v210
    v_mfma_f32_16x16x32_bf16 v[212:215], a[92:95], a[12:15], v[212:215]
    v_exp_f32 v211, v211
    v_mfma_f32_16x16x32_bf16 v[16:19], a[96:99], v[160:163], 0
    s_waitcnt lgkmcnt(1)
    v_lshlrev_b32 v244, 16, v220
    v_and_b32 v245, 0xffff0000, v220
    v_lshlrev_b32 v246, 16, v221
    v_and_b32 v247, 0xffff0000, v221
    v_mul_f32 v244, s27, v244
    v_mul_f32 v245, s27, v245
    v_mul_f32 v246, s27, v246
    v_mul_f32 v247, s27, v247
    v_cvt_pk_bf16_f32 v220, v244, v245
    v_cvt_pk_bf16_f32 v221, v246, v247
    v_lshlrev_b32 v244, 16, v222
    v_and_b32 v245, 0xffff0000, v222
    v_lshlrev_b32 v246, 16, v223
    v_and_b32 v247, 0xffff0000, v223
    v_mul_f32 v244, s27, v244
    v_mul_f32 v245, s27, v245
    v_mul_f32 v246, s27, v246
    v_mul_f32 v247, s27, v247
    v_cvt_pk_bf16_f32 v222, v244, v245
    v_cvt_pk_bf16_f32 v223, v246, v247
    ds_write_b128 v231, v[220:223] offset:17408
    v_mfma_f32_16x16x32_bf16 v[20:23], a[100:103], v[160:163], 0
    v_exp_f32 v212, v212
    v_exp_f32 v213, v213
    v_exp_f32 v214, v214
    v_exp_f32 v215, v215
    v_mfma_f32_16x16x32_bf16 v[24:27], a[104:107], v[160:163], 0
    s_waitcnt lgkmcnt(1)
    v_cvt_pk_bf16_f32 v164, v208, v209
    v_cvt_pk_bf16_f32 v165, v210, v211
    v_cvt_pk_bf16_f32 v166, v212, v213
    v_cvt_pk_bf16_f32 v167, v214, v215
    global_load_dwordx4 a[24:27], v237, s[4:5] offset:128 nt
    v_mfma_f32_16x16x32_bf16 v[28:31], a[108:111], v[160:163], 0
    v_smfmac_f32_16x16x64_bf16 a[112:115], a[132:135], v[160:167], v238
    s_waitcnt vmcnt(7) lgkmcnt(0)
    s_barrier
    global_load_dwordx4 a[28:31], v237, s[4:5] offset:192 nt
    ds_read_b64_tr_b16 a[104:105], v233 offset:40960
    ds_read_b64_tr_b16 a[106:107], v233 offset:45056
    ds_read_b64_tr_b16 a[108:109], v233 offset:40968
    ds_read_b64_tr_b16 a[110:111], v233 offset:45064
    ds_read_b128 a[80:83], v228 offset:16384
    ds_read_b128 a[84:87], v228 offset:16640
    ds_read_b128 a[88:91], v228 offset:16896
    ds_read_b128 a[92:95], v228 offset:17152
    ds_read_b64_tr_b16 a[144:145], v232 offset:40960
    ds_read_b64_tr_b16 a[146:147], v232 offset:45056
    ds_read_b64_tr_b16 a[148:149], v232 offset:40968
    ds_read_b64_tr_b16 a[150:151], v232 offset:45064
    ds_read_b64_tr_b16 a[96:97], v234 offset:40960
    ds_read_b64_tr_b16 a[98:99], v234 offset:45056
    ds_read_b64_tr_b16 a[100:101], v234 offset:40968
    ds_read_b64_tr_b16 a[102:103], v234 offset:45064
    s_waitcnt lgkmcnt(11)
    v_mfma_f32_16x16x32_bf16 v[200:203], a[80:83], a[0:3], -4.0
    s_waitcnt lgkmcnt(10)
    ds_read_b128 a[80:83], v228 offset:20480
    v_mfma_f32_16x16x32_bf16 v[200:203], a[84:87], a[4:7], v[200:203]
    s_waitcnt lgkmcnt(10)
    ds_read_b128 a[84:87], v228 offset:20736
    v_mfma_f32_16x16x32_bf16 v[200:203], a[88:91], a[8:11], v[200:203]
    s_waitcnt lgkmcnt(10)
    ds_read_b128 a[88:91], v228 offset:20992
    v_mfma_f32_16x16x32_bf16 v[200:203], a[92:95], a[12:15], v[200:203]
    s_waitcnt lgkmcnt(9)
    s_waitcnt vmcnt(7)
    ds_read_b128 v[216:219], v231 offset:24576
    global_load_lds_dwordx4 v230, s[52:53] offset:0 nt
    ds_read_b128 a[92:95], v228 offset:21248
    s_add_u32 s4, s4, 16384
    s_addc_u32 s5, s5, 0
    v_mfma_f32_16x16x32_bf16 v[0:3], a[144:147], v[164:167], v[0:3]
    s_waitcnt lgkmcnt(5)
    v_exp_f32 v200, v200
    v_mfma_f32_16x16x32_bf16 v[4:7], a[148:151], v[164:167], v[4:7]
    v_exp_f32 v201, v201
    v_mfma_f32_16x16x32_bf16 v[8:11], a[104:107], v[164:167], v[8:11]
    ds_read_b64_tr_b16 a[104:105], v235 offset:40960
    ds_read_b64_tr_b16 a[106:107], v235 offset:45056
    v_mfma_f32_16x16x32_bf16 v[12:15], a[108:111], v[164:167], v[12:15]
    s_waitcnt lgkmcnt(4)
    s_waitcnt lgkmcnt(3)
    v_lshlrev_b32 v244, 16, v216
    v_and_b32 v245, 0xffff0000, v216
    v_lshlrev_b32 v246, 16, v217
    v_and_b32 v247, 0xffff0000, v217
    v_mul_f32 v244, s27, v244
    v_mul_f32 v245, s27, v245
    v_mul_f32 v246, s27, v246
    v_mul_f32 v247, s27, v247
    v_cvt_pk_bf16_f32 v216, v244, v245
    v_cvt_pk_bf16_f32 v217, v246, v247
    v_lshlrev_b32 v244, 16, v218
    v_and_b32 v245, 0xffff0000, v218
    v_lshlrev_b32 v246, 16, v219
    v_and_b32 v247, 0xffff0000, v219
    v_mul_f32 v244, s27, v244
    v_mul_f32 v245, s27, v245
    v_mul_f32 v246, s27, v246
    v_mul_f32 v247, s27, v247
    v_cvt_pk_bf16_f32 v218, v244, v245
    v_cvt_pk_bf16_f32 v219, v246, v247
    ds_write_b128 v231, v[216:219] offset:24576
    v_mfma_f32_16x16x32_bf16 v[204:207], a[80:83], a[0:3], -4.0
    ds_read_b64_tr_b16 a[108:109], v235 offset:40968
    ds_read_b64_tr_b16 a[110:111], v235 offset:45064
    v_mfma_f32_16x16x32_bf16 v[204:207], a[84:87], a[4:7], v[204:207]
    s_waitcnt vmcnt(7)
    ds_read_b128 v[220:223], v231 offset:25600
    global_load_lds_dwordx4 v230, s[52:53] offset:1024 nt
    v_mfma_f32_16x16x32_bf16 v[204:207], a[88:91], a[8:11], v[204:207]
    s_waitcnt lgkmcnt(4)
    s_add_u32 m0, s23, 57344
    v_cvt_pk_bf16_f32 v160, v200, v201
    v_mfma_f32_16x16x32_bf16 v[204:207], a[92:95], a[12:15], v[204:207]
    s_add_u32 s52, s52, 8192
    s_addc_u32 s53, s53, 0
    v_mfma_f32_16x16x32_bf16 v[16:19], a[96:99], v[164:167], v[16:19]
    v_exp_f32 v202, v202
    v_mfma_f32_16x16x32_bf16 v[20:23], a[100:103], v[164:167], v[20:23]
    v_exp_f32 v203, v203
    v_mfma_f32_16x16x32_bf16 v[24:27], a[104:107], v[164:167], v[24:27]
    s_waitcnt lgkmcnt(1)
    s_waitcnt lgkmcnt(0)
    v_lshlrev_b32 v244, 16, v220
    v_and_b32 v245, 0xffff0000, v220
    v_lshlrev_b32 v246, 16, v221
    v_and_b32 v247, 0xffff0000, v221
    v_mul_f32 v244, s27, v244
    v_mul_f32 v245, s27, v245
    v_mul_f32 v246, s27, v246
    v_mul_f32 v247, s27, v247
    v_cvt_pk_bf16_f32 v220, v244, v245
    v_cvt_pk_bf16_f32 v221, v246, v247
    v_lshlrev_b32 v244, 16, v222
    v_and_b32 v245, 0xffff0000, v222
    v_lshlrev_b32 v246, 16, v223
    v_and_b32 v247, 0xffff0000, v223
    v_mul_f32 v244, s27, v244
    v_mul_f32 v245, s27, v245
    v_mul_f32 v246, s27, v246
    v_mul_f32 v247, s27, v247
    v_cvt_pk_bf16_f32 v222, v244, v245
    v_cvt_pk_bf16_f32 v223, v246, v247
    ds_write_b128 v231, v[220:223] offset:25600
    v_mfma_f32_16x16x32_bf16 v[28:31], a[108:111], v[164:167], v[28:31]
    v_exp_f32 v204, v204
    v_exp_f32 v205, v205
    v_exp_f32 v206, v206
    v_exp_f32 v207, v207
    v_cvt_pk_bf16_f32 v161, v202, v203
    v_cvt_pk_bf16_f32 v162, v204, v205
    v_cvt_pk_bf16_f32 v163, v206, v207
    global_load_lds_dwordx4 v230, s[54:55] offset:0 nt
    s_waitcnt vmcnt(7) lgkmcnt(0)
    s_barrier
    ds_read_b128 a[80:83], v228 offset:24576
    ds_read_b128 a[84:87], v228 offset:24832
    ds_read_b128 a[88:91], v228 offset:25088
    ds_read_b128 a[92:95], v228 offset:25344
    global_load_lds_dwordx4 v230, s[54:55] offset:1024 nt
    ds_read_b64_tr_b16 a[104:105], v233 offset:49152
    ds_read_b64_tr_b16 a[106:107], v233 offset:53248
    ds_read_b64_tr_b16 a[108:109], v233 offset:49160
    ds_read_b64_tr_b16 a[110:111], v233 offset:53256
    ds_read_b64_tr_b16 a[152:153], v232 offset:49152
    s_waitcnt lgkmcnt(8)
    v_mfma_f32_16x16x32_bf16 v[208:211], a[80:83], a[0:3], -4.0
    ds_read_b64_tr_b16 a[154:155], v232 offset:53248
    s_waitcnt lgkmcnt(8)
    v_mfma_f32_16x16x32_bf16 v[208:211], a[84:87], a[4:7], v[208:211]
    s_waitcnt lgkmcnt(7)
    ds_read_b64_tr_b16 a[156:157], v232 offset:49160
    ds_read_b64_tr_b16 a[158:159], v232 offset:53256
    s_add_u32 s54, s54, 8192
    s_addc_u32 s55, s55, 0
    v_mfma_f32_16x16x32_bf16 v[208:211], a[88:91], a[8:11], v[208:211]
    s_waitcnt lgkmcnt(8)
    s_add_u32 m0, s21, 40960
    v_mfma_f32_16x16x32_bf16 v[208:211], a[92:95], a[12:15], v[208:211]
    global_load_lds_dwordx4 v230, s[52:53] offset:0 nt
    ds_read_b64_tr_b16 a[96:97], v234 offset:49152
    ds_read_b64_tr_b16 a[98:99], v234 offset:53248
    ds_read_b64_tr_b16 a[100:101], v234 offset:49160
    ds_read_b64_tr_b16 a[102:103], v234 offset:53256
    global_load_lds_dwordx4 v230, s[52:53] offset:1024 nt
    s_add_u32 m0, s23, 0
    s_add_u32 s52, s52, 8192
    s_addc_u32 s53, s53, 0
    global_load_lds_dwordx4 v230, s[54:55] offset:0 nt
    v_exp_f32 v208, v208
    v_exp_f32 v209, v209
    v_exp_f32 v210, v210
    v_exp_f32 v211, v211
    v_cvt_pk_bf16_f32 v164, v208, v209
    v_cvt_pk_bf16_f32 v165, v210, v211
    s_waitcnt vmcnt(7)
    v_mfma_f32_16x16x32_bf16 v[212:215], a[92:95], a[28:31], -4.0
    ds_read_b128 a[92:95], v228 offset:29440
    v_mfma_f32_16x16x32_bf16 v[212:215], a[88:91], a[24:27], v[212:215]
    ds_read_b128 a[88:91], v228 offset:29184
    v_mfma_f32_16x16x32_bf16 v[212:215], a[84:87], a[20:23], v[212:215]
    ds_read_b128 a[84:87], v228 offset:28928
    v_mfma_f32_16x16x32_bf16 v[212:215], a[80:83], a[16:19], v[212:215]
    s_waitcnt lgkmcnt(3)
    ds_read_b128 a[80:83], v228 offset:28672
    v_mfma_f32_16x16x32_bf16 v[0:3], a[152:155], v[160:163], v[0:3]
    global_load_lds_dwordx4 v230, s[54:55] offset:1024 nt
    v_mfma_f32_16x16x32_bf16 v[4:7], a[156:159], v[160:163], v[4:7]
    s_add_u32 s54, s54, 8192
    s_addc_u32 s55, s55, 0
    s_add_u32 m0, s21, 49152
    v_mfma_f32_16x16x32_bf16 v[8:11], a[104:107], v[160:163], v[8:11]
    ds_read_b64_tr_b16 a[104:105], v235 offset:49152
    ds_read_b64_tr_b16 a[106:107], v235 offset:53248
    v_mfma_f32_16x16x32_bf16 v[12:15], a[108:111], v[160:163], v[12:15]
    ds_read_b64_tr_b16 a[108:109], v235 offset:49160
    ds_read_b64_tr_b16 a[110:111], v235 offset:53256
    v_exp_f32 v212, v212
    v_exp_f32 v213, v213
    v_exp_f32 v214, v214
    v_cvt_pk_bf16_f32 v172, v212, v213
    s_waitcnt lgkmcnt(4)
    v_mfma_f32_16x16x32_bf16 v[200:203], a[80:83], a[0:3], -4.0
    v_exp_f32 v215, v215
    v_mfma_f32_16x16x32_bf16 v[200:203], a[84:87], a[4:7], v[200:203]
    v_cvt_pk_bf16_f32 v173, v214, v215
    v_mfma_f32_16x16x32_bf16 v[200:203], a[88:91], a[8:11], v[200:203]
    v_mfma_f32_16x16x32_bf16 v[200:203], a[92:95], a[12:15], v[200:203]
    v_mfma_f32_16x16x32_bf16 v[204:207], a[92:95], a[28:31], -4.0
    v_mfma_f32_16x16x32_bf16 v[204:207], a[88:91], a[24:27], v[204:207]
    v_mfma_f32_16x16x32_bf16 v[204:207], a[84:87], a[20:23], v[204:207]
    s_waitcnt vmcnt(7)
    ds_read_b128 v[216:219], v231 offset:32768
    global_load_lds_dwordx4 v230, s[52:53] offset:0 nt
    v_mfma_f32_16x16x32_bf16 v[204:207], a[80:83], a[16:19], v[204:207]
    v_mfma_f32_16x16x32_bf16 v[16:19], a[96:99], v[160:163], v[16:19]
    v_exp_f32 v200, v200
    v_mfma_f32_16x16x32_bf16 v[20:23], a[100:103], v[160:163], v[20:23]
    s_waitcnt lgkmcnt(1)
    v_exp_f32 v201, v201
    v_exp_f32 v202, v202
    v_exp_f32 v203, v203
    v_mfma_f32_16x16x32_bf16 v[24:27], a[104:107], v[160:163], v[24:27]
    s_waitcnt lgkmcnt(0)
    v_lshlrev_b32 v244, 16, v216
    v_and_b32 v245, 0xffff0000, v216
    v_lshlrev_b32 v246, 16, v217
    v_and_b32 v247, 0xffff0000, v217
    v_mul_f32 v244, s27, v244
    v_mul_f32 v245, s27, v245
    v_mul_f32 v246, s27, v246
    v_mul_f32 v247, s27, v247
    v_cvt_pk_bf16_f32 v216, v244, v245
    v_cvt_pk_bf16_f32 v217, v246, v247
    v_lshlrev_b32 v244, 16, v218
    v_and_b32 v245, 0xffff0000, v218
    v_lshlrev_b32 v246, 16, v219
    v_and_b32 v247, 0xffff0000, v219
    v_mul_f32 v244, s27, v244
    v_mul_f32 v245, s27, v245
    v_mul_f32 v246, s27, v246
    v_mul_f32 v247, s27, v247
    v_cvt_pk_bf16_f32 v218, v244, v245
    v_cvt_pk_bf16_f32 v219, v246, v247
    ds_write_b128 v231, v[216:219] offset:32768
    v_cvt_pk_bf16_f32 v166, v200, v201
    v_cvt_pk_bf16_f32 v167, v202, v203
    v_mfma_f32_16x16x32_bf16 v[28:31], a[108:111], v[160:163], v[28:31]
    v_exp_f32 v204, v204
    v_smfmac_f32_16x16x64_bf16 a[112:115], a[132:135], v[160:167], v238
    v_exp_f32 v205, v205
    v_exp_f32 v206, v206
    v_exp_f32 v207, v207
    v_cvt_pk_bf16_f32 v174, v204, v205
    v_cvt_pk_bf16_f32 v175, v206, v207
    s_waitcnt vmcnt(7)
    ds_read_b128 v[220:223], v231 offset:33792
    global_load_lds_dwordx4 v230, s[52:53] offset:1024 nt
    s_add_u32 m0, s23, 8192
    s_add_u32 s52, s52, 8192
    s_addc_u32 s53, s53, 0
    s_waitcnt lgkmcnt(0)
    v_lshlrev_b32 v244, 16, v220
    v_and_b32 v245, 0xffff0000, v220
    v_lshlrev_b32 v246, 16, v221
    v_and_b32 v247, 0xffff0000, v221
    v_mul_f32 v244, s27, v244
    v_mul_f32 v245, s27, v245
    v_mul_f32 v246, s27, v246
    v_mul_f32 v247, s27, v247
    v_cvt_pk_bf16_f32 v220, v244, v245
    v_cvt_pk_bf16_f32 v221, v246, v247
    v_lshlrev_b32 v244, 16, v222
    v_and_b32 v245, 0xffff0000, v222
    v_lshlrev_b32 v246, 16, v223
    v_and_b32 v247, 0xffff0000, v223
    v_mul_f32 v244, s27, v244
    v_mul_f32 v245, s27, v245
    v_mul_f32 v246, s27, v246
    v_mul_f32 v247, s27, v247
    v_cvt_pk_bf16_f32 v222, v244, v245
    v_cvt_pk_bf16_f32 v223, v246, v247
    ds_write_b128 v231, v[220:223] offset:33792
    global_load_lds_dwordx4 v230, s[54:55] offset:0 nt
    s_waitcnt vmcnt(7) lgkmcnt(0)
    s_barrier
    ds_read_b128 a[80:83], v228 offset:32768
    ds_read_b128 a[84:87], v228 offset:33024
    ds_read_b128 a[88:91], v228 offset:33280
    ds_read_b128 a[92:95], v228 offset:33536
    ds_read_b64_tr_b16 a[160:161], v232 offset:57344
    ds_read_b64_tr_b16 a[162:163], v232 offset:61440
    ds_read_b64_tr_b16 a[164:165], v232 offset:57352
    ds_read_b64_tr_b16 a[166:167], v232 offset:61448
    ds_read_b64_tr_b16 a[104:105], v233 offset:57344
    ds_read_b64_tr_b16 a[106:107], v233 offset:61440
    s_waitcnt lgkmcnt(9)
    v_mfma_f32_16x16x32_bf16 v[208:211], a[80:83], a[0:3], -4.0
    ds_read_b64_tr_b16 a[108:109], v233 offset:57352
    s_waitcnt lgkmcnt(9)
    v_mfma_f32_16x16x32_bf16 v[208:211], a[84:87], a[4:7], v[208:211]
    s_waitcnt lgkmcnt(8)
    v_mfma_f32_16x16x32_bf16 v[208:211], a[88:91], a[8:11], v[208:211]
    s_waitcnt lgkmcnt(7)
    v_mfma_f32_16x16x32_bf16 v[208:211], a[92:95], a[12:15], v[208:211]
    ds_read_b64_tr_b16 a[110:111], v233 offset:61448
    v_mfma_f32_16x16x32_bf16 v[212:215], a[92:95], a[28:31], -4.0
    global_load_lds_dwordx4 v230, s[54:55] offset:1024 nt
    v_mfma_f32_16x16x32_bf16 v[212:215], a[88:91], a[24:27], v[212:215]
    s_add_u32 s54, s54, 8192
    s_addc_u32 s55, s55, 0
    s_add_u32 m0, s21, 57344
    v_mfma_f32_16x16x32_bf16 v[212:215], a[84:87], a[20:23], v[212:215]
    ds_read_b128 a[84:87], v228 offset:37120
    v_mfma_f32_16x16x32_bf16 v[212:215], a[80:83], a[16:19], v[212:215]
    s_waitcnt lgkmcnt(4)
    v_exp_f32 v208, v208
    v_mfma_f32_16x16x32_bf16 v[0:3], a[160:163], v[164:167], v[0:3]
    s_waitcnt vmcnt(7)
    ds_read_b128 v[216:219], v231 offset:40960
    ds_read_b128 a[80:83], v228 offset:36864
    v_mfma_f32_16x16x32_bf16 v[32:35], a[160:163], v[172:175], 0
    ds_read_b128 a[88:91], v228 offset:37376
    v_mfma_f32_16x16x32_bf16 v[36:39], a[164:167], v[172:175], 0
    ds_read_b128 a[92:95], v228 offset:37632
    v_mfma_f32_16x16x32_bf16 v[4:7], a[164:167], v[164:167], v[4:7]
    s_waitcnt lgkmcnt(5)
    v_exp_f32 v212, v212
    v_mfma_f32_16x16x32_bf16 v[8:11], a[104:107], v[164:167], v[8:11]
    global_load_dwordx4 a[32:35], v237, s[4:5] offset:0 nt
    v_mfma_f32_16x16x32_bf16 v[40:43], a[104:107], v[172:175], 0
    s_waitcnt lgkmcnt(3)
    v_lshlrev_b32 v244, 16, v216
    v_and_b32 v245, 0xffff0000, v216
    v_lshlrev_b32 v246, 16, v217
    v_and_b32 v247, 0xffff0000, v217
    v_mul_f32 v244, s27, v244
    v_mul_f32 v245, s27, v245
    v_mul_f32 v246, s27, v246
    v_mul_f32 v247, s27, v247
    v_cvt_pk_bf16_f32 v216, v244, v245
    v_cvt_pk_bf16_f32 v217, v246, v247
    v_lshlrev_b32 v244, 16, v218
    v_and_b32 v245, 0xffff0000, v218
    v_lshlrev_b32 v246, 16, v219
    v_and_b32 v247, 0xffff0000, v219
    v_mul_f32 v244, s27, v244
    v_mul_f32 v245, s27, v245
    v_mul_f32 v246, s27, v246
    v_mul_f32 v247, s27, v247
    v_cvt_pk_bf16_f32 v218, v244, v245
    v_cvt_pk_bf16_f32 v219, v246, v247
    v_mfma_f32_16x16x32_bf16 v[44:47], a[108:111], v[172:175], 0
    ds_read_b64_tr_b16 a[96:97], v234 offset:57344
    v_mfma_f32_16x16x32_bf16 v[12:15], a[108:111], v[164:167], v[12:15]
    s_waitcnt lgkmcnt(1)
    v_exp_f32 v213, v213
    v_mfma_f32_16x16x32_bf16 v[200:203], a[80:83], a[0:3], -4.0
    ds_write_b128 v231, v[216:219] offset:40960
    v_mfma_f32_16x16x32_bf16 v[200:203], a[84:87], a[4:7], v[200:203]
    ds_read_b64_tr_b16 a[98:99], v234 offset:61440
    s_waitcnt vmcnt(7)
    ds_read_b128 v[220:223], v231 offset:41984
    ds_read_b64_tr_b16 a[100:101], v234 offset:57352
    ds_read_b64_tr_b16 a[102:103], v234 offset:61448
    ds_read_b64_tr_b16 a[104:105], v235 offset:57344
    ds_read_b64_tr_b16 a[106:107], v235 offset:61440
    ds_read_b64_tr_b16 a[108:109], v235 offset:57352
    ds_read_b64_tr_b16 a[110:111], v235 offset:61448
    v_mfma_f32_16x16x32_bf16 v[200:203], a[88:91], a[8:11], v[200:203]
    global_load_dwordx4 a[36:39], v237, s[4:5] offset:64 nt
    v_mfma_f32_16x16x32_bf16 v[200:203], a[92:95], a[12:15], v[200:203]
    s_waitcnt lgkmcnt(6)
    v_lshlrev_b32 v244, 16, v220
    v_and_b32 v245, 0xffff0000, v220
    v_lshlrev_b32 v246, 16, v221
    v_and_b32 v247, 0xffff0000, v221
    v_mul_f32 v244, s27, v244
    v_mul_f32 v245, s27, v245
    v_mul_f32 v246, s27, v246
    v_mul_f32 v247, s27, v247
    v_cvt_pk_bf16_f32 v220, v244, v245
    v_cvt_pk_bf16_f32 v221, v246, v247
    v_lshlrev_b32 v244, 16, v222
    v_and_b32 v245, 0xffff0000, v222
    v_lshlrev_b32 v246, 16, v223
    v_and_b32 v247, 0xffff0000, v223
    v_mul_f32 v244, s27, v244
    v_mul_f32 v245, s27, v245
    v_mul_f32 v246, s27, v246
    v_mul_f32 v247, s27, v247
    v_cvt_pk_bf16_f32 v222, v244, v245
    v_cvt_pk_bf16_f32 v223, v246, v247
    ds_write_b128 v231, v[220:223] offset:41984
    v_mfma_f32_16x16x32_bf16 v[204:207], a[92:95], a[28:31], -4.0
    v_exp_f32 v214, v214
    v_mfma_f32_16x16x32_bf16 v[204:207], a[88:91], a[24:27], v[204:207]
    v_exp_f32 v215, v215
    v_mfma_f32_16x16x32_bf16 v[204:207], a[84:87], a[20:23], v[204:207]
    v_cvt_pk_bf16_f32 v168, v212, v213
    v_cvt_pk_bf16_f32 v169, v214, v215
    v_mfma_f32_16x16x32_bf16 v[204:207], a[80:83], a[16:19], v[204:207]
    v_exp_f32 v209, v209
    v_mfma_f32_16x16x32_bf16 v[16:19], a[96:99], v[164:167], v[16:19]
    v_exp_f32 v210, v210
    v_mfma_f32_16x16x32_bf16 v[48:51], a[96:99], v[172:175], 0
    s_waitcnt lgkmcnt(1)
    v_exp_f32 v211, v211
    v_mfma_f32_16x16x32_bf16 v[52:55], a[100:103], v[172:175], 0
    global_load_dwordx4 a[40:43], v237, s[4:5] offset:128 nt
    v_mfma_f32_16x16x32_bf16 v[20:23], a[100:103], v[164:167], v[20:23]
    v_exp_f32 v204, v204
    v_mfma_f32_16x16x32_bf16 v[24:27], a[104:107], v[164:167], v[24:27]
    v_exp_f32 v205, v205
    v_mfma_f32_16x16x32_bf16 v[56:59], a[104:107], v[172:175], 0
    v_exp_f32 v206, v206
    v_exp_f32 v207, v207
    v_mfma_f32_16x16x32_bf16 v[60:63], a[108:111], v[172:175], 0
    v_cvt_pk_bf16_f32 v170, v204, v205
    v_cvt_pk_bf16_f32 v171, v206, v207
    v_mfma_f32_16x16x32_bf16 v[28:31], a[108:111], v[164:167], v[28:31]
    v_cvt_pk_bf16_f32 v160, v208, v209
    v_cvt_pk_bf16_f32 v161, v210, v211
    v_smfmac_f32_16x16x64_bf16 a[116:119], a[132:135], v[168:175], v238
    v_exp_f32 v200, v200
    v_exp_f32 v201, v201
    v_exp_f32 v202, v202
    v_exp_f32 v203, v203
    v_cvt_pk_bf16_f32 v162, v200, v201
    v_cvt_pk_bf16_f32 v163, v202, v203
    s_waitcnt vmcnt(7) lgkmcnt(0)
    s_barrier
    ds_read_b128 a[80:83], v228 offset:40960
    ds_read_b128 a[84:87], v228 offset:41216
    ds_read_b128 a[88:91], v228 offset:41472
    ds_read_b128 a[92:95], v228 offset:41728
    ds_read_b64_tr_b16 a[168:169], v232 offset:0
    ds_read_b64_tr_b16 a[170:171], v232 offset:4096
    ds_read_b64_tr_b16 a[172:173], v232 offset:8
    ds_read_b64_tr_b16 a[174:175], v232 offset:4104
    global_load_dwordx4 a[44:47], v237, s[4:5] offset:192 nt
    ds_read_b64_tr_b16 a[104:105], v233 offset:0
    s_waitcnt lgkmcnt(8)
    v_mfma_f32_16x16x32_bf16 v[208:211], a[80:83], a[0:3], -4.0
    ds_read_b64_tr_b16 a[106:107], v233 offset:4096
    s_waitcnt lgkmcnt(8)
    v_mfma_f32_16x16x32_bf16 v[208:211], a[84:87], a[4:7], v[208:211]
    s_waitcnt lgkmcnt(7)
    s_add_u32 s4, s4, 16384
    s_addc_u32 s5, s5, 0
    v_mfma_f32_16x16x32_bf16 v[208:211], a[88:91], a[8:11], v[208:211]
    s_waitcnt lgkmcnt(6)
    v_mfma_f32_16x16x32_bf16 v[208:211], a[92:95], a[12:15], v[208:211]
    ds_read_b64_tr_b16 a[108:109], v233 offset:8
    v_mfma_f32_16x16x32_bf16 v[212:215], a[92:95], a[28:31], -4.0
    ds_read_b64_tr_b16 a[110:111], v233 offset:4104
    v_mfma_f32_16x16x32_bf16 v[212:215], a[88:91], a[24:27], v[212:215]
    ds_read_b128 a[88:91], v228 offset:45568
    v_mfma_f32_16x16x32_bf16 v[212:215], a[84:87], a[20:23], v[212:215]
    ds_read_b128 a[84:87], v228 offset:45312
    v_mfma_f32_16x16x32_bf16 v[212:215], a[80:83], a[16:19], v[212:215]
    s_waitcnt lgkmcnt(6)
    v_exp_f32 v208, v208
    v_mfma_f32_16x16x32_bf16 v[0:3], a[168:171], v[160:163], v[0:3]
    ds_read_b128 a[80:83], v228 offset:45056
    v_mfma_f32_16x16x32_bf16 v[32:35], a[168:171], v[168:171], v[32:35]
    s_waitcnt vmcnt(7)
    ds_read_b128 v[216:219], v231 offset:49152
    global_load_lds_dwordx4 v230, s[52:53] offset:0 nt
    v_mfma_f32_16x16x32_bf16 v[36:39], a[172:175], v[168:171], v[36:39]
    ds_read_b128 a[92:95], v228 offset:45824
    v_mfma_f32_16x16x32_bf16 v[4:7], a[172:175], v[160:163], v[4:7]
    s_waitcnt lgkmcnt(5)
    v_exp_f32 v209, v209
    v_mfma_f32_16x16x32_bf16 v[8:11], a[104:107], v[160:163], v[8:11]
    ds_read_b64_tr_b16 a[96:97], v234 offset:0
    v_cvt_pk_bf16_f32 v164, v208, v209
    v_mfma_f32_16x16x32_bf16 v[40:43], a[104:107], v[168:171], v[40:43]
    ds_read_b64_tr_b16 a[98:99], v234 offset:4096
    v_mfma_f32_16x16x32_bf16 v[44:47], a[108:111], v[168:171], v[44:47]
    s_waitcnt lgkmcnt(3)
    v_lshlrev_b32 v244, 16, v216
    v_and_b32 v245, 0xffff0000, v216
    v_lshlrev_b32 v246, 16, v217
    v_and_b32 v247, 0xffff0000, v217
    v_mul_f32 v244, s27, v244
    v_mul_f32 v245, s27, v245
    v_mul_f32 v246, s27, v246
    v_mul_f32 v247, s27, v247
    v_cvt_pk_bf16_f32 v216, v244, v245
    v_cvt_pk_bf16_f32 v217, v246, v247
    v_lshlrev_b32 v244, 16, v218
    v_and_b32 v245, 0xffff0000, v218
    v_lshlrev_b32 v246, 16, v219
    v_and_b32 v247, 0xffff0000, v219
    v_mul_f32 v244, s27, v244
    v_mul_f32 v245, s27, v245
    v_mul_f32 v246, s27, v246
    v_mul_f32 v247, s27, v247
    v_cvt_pk_bf16_f32 v218, v244, v245
    v_cvt_pk_bf16_f32 v219, v246, v247
    v_mfma_f32_16x16x32_bf16 v[12:15], a[108:111], v[160:163], v[12:15]
    ds_read_b64_tr_b16 a[100:101], v234 offset:8
    v_mfma_f32_16x16x32_bf16 v[200:203], a[80:83], a[0:3], -4.0
    ds_write_b128 v231, v[216:219] offset:49152
    v_mfma_f32_16x16x32_bf16 v[200:203], a[84:87], a[4:7], v[200:203]
    ds_read_b64_tr_b16 a[102:103], v234 offset:4104
    ds_read_b64_tr_b16 a[104:105], v235 offset:0
    s_waitcnt vmcnt(7)
    ds_read_b128 v[220:223], v231 offset:50176
    ds_read_b64_tr_b16 a[106:107], v235 offset:4096
    ds_read_b64_tr_b16 a[108:109], v235 offset:8
    ds_read_b64_tr_b16 a[110:111], v235 offset:4104
    global_load_lds_dwordx4 v230, s[52:53] offset:1024 nt
    v_mfma_f32_16x16x32_bf16 v[200:203], a[88:91], a[8:11], v[200:203]
    s_waitcnt lgkmcnt(6)
    s_add_u32 m0, s23, 16384
    v_mfma_f32_16x16x32_bf16 v[200:203], a[92:95], a[12:15], v[200:203]
    s_add_u32 s52, s52, 8192
    s_addc_u32 s53, s53, 0
    v_mfma_f32_16x16x32_bf16 v[204:207], a[92:95], a[28:31], -4.0
    s_waitcnt lgkmcnt(3)
    v_lshlrev_b32 v244, 16, v220
    v_and_b32 v245, 0xffff0000, v220
    v_lshlrev_b32 v246, 16, v221
    v_and_b32 v247, 0xffff0000, v221
    v_mul_f32 v244, s27, v244
    v_mul_f32 v245, s27, v245
    v_mul_f32 v246, s27, v246
    v_mul_f32 v247, s27, v247
    v_cvt_pk_bf16_f32 v220, v244, v245
    v_cvt_pk_bf16_f32 v221, v246, v247
    v_lshlrev_b32 v244, 16, v222
    v_and_b32 v245, 0xffff0000, v222
    v_lshlrev_b32 v246, 16, v223
    v_and_b32 v247, 0xffff0000, v223
    v_mul_f32 v244, s27, v244
    v_mul_f32 v245, s27, v245
    v_mul_f32 v246, s27, v246
    v_mul_f32 v247, s27, v247
    v_cvt_pk_bf16_f32 v222, v244, v245
    v_cvt_pk_bf16_f32 v223, v246, v247
    ds_write_b128 v231, v[220:223] offset:50176
    v_mfma_f32_16x16x32_bf16 v[204:207], a[88:91], a[24:27], v[204:207]
    v_exp_f32 v210, v210
    v_mfma_f32_16x16x32_bf16 v[204:207], a[84:87], a[20:23], v[204:207]
    v_exp_f32 v211, v211
    v_mfma_f32_16x16x32_bf16 v[204:207], a[80:83], a[16:19], v[204:207]
    v_exp_f32 v200, v200
    v_mfma_f32_16x16x32_bf16 v[16:19], a[96:99], v[160:163], v[16:19]
    v_exp_f32 v201, v201
    v_mfma_f32_16x16x32_bf16 v[48:51], a[96:99], v[168:171], v[48:51]
    v_exp_f32 v202, v202
    v_mfma_f32_16x16x32_bf16 v[52:55], a[100:103], v[168:171], v[52:55]
    global_load_lds_dwordx4 v230, s[54:55] offset:0 nt
    v_mfma_f32_16x16x32_bf16 v[20:23], a[100:103], v[160:163], v[20:23]
    s_waitcnt lgkmcnt(1)
    v_exp_f32 v203, v203
    v_mfma_f32_16x16x32_bf16 v[24:27], a[104:107], v[160:163], v[24:27]
    v_cvt_pk_bf16_f32 v165, v210, v211
    v_cvt_pk_bf16_f32 v166, v200, v201
    v_mfma_f32_16x16x32_bf16 v[56:59], a[104:107], v[168:171], v[56:59]
    v_cvt_pk_bf16_f32 v167, v202, v203
    v_mfma_f32_16x16x32_bf16 v[60:63], a[108:111], v[168:171], v[60:63]
    v_exp_f32 v212, v212
    v_mfma_f32_16x16x32_bf16 v[28:31], a[108:111], v[160:163], v[28:31]
    v_exp_f32 v213, v213
    v_smfmac_f32_16x16x64_bf16 a[112:115], a[132:135], v[160:167], v238
    v_exp_f32 v214, v214
    v_exp_f32 v215, v215
    v_cvt_pk_bf16_f32 v172, v212, v213
    v_cvt_pk_bf16_f32 v173, v214, v215
    v_exp_f32 v204, v204
    v_exp_f32 v205, v205
    v_exp_f32 v206, v206
    v_exp_f32 v207, v207
    v_cvt_pk_bf16_f32 v174, v204, v205
    v_cvt_pk_bf16_f32 v175, v206, v207
    s_waitcnt vmcnt(7) lgkmcnt(0)
    s_barrier
    ds_read_b128 a[80:83], v228 offset:49152
    ds_read_b128 a[84:87], v228 offset:49408
    ds_read_b128 a[88:91], v228 offset:49664
    ds_read_b128 a[92:95], v228 offset:49920
    global_load_lds_dwordx4 v230, s[54:55] offset:1024 nt
    s_add_u32 s54, s54, 8192
    s_addc_u32 s55, s55, 0
    ds_read_b64_tr_b16 a[176:177], v232 offset:8192
    ds_read_b64_tr_b16 a[178:179], v232 offset:12288
    s_add_u32 m0, s21, 65536
    ds_read_b64_tr_b16 a[180:181], v232 offset:8200
    ds_read_b64_tr_b16 a[182:183], v232 offset:12296
    s_waitcnt lgkmcnt(7)
    v_mfma_f32_16x16x32_bf16 v[208:211], a[80:83], a[0:3], -4.0
    ds_read_b64_tr_b16 a[104:105], v233 offset:8192
    s_waitcnt lgkmcnt(7)
    v_mfma_f32_16x16x32_bf16 v[208:211], a[84:87], a[4:7], v[208:211]
    s_waitcnt lgkmcnt(6)
    v_mfma_f32_16x16x32_bf16 v[208:211], a[88:91], a[8:11], v[208:211]
    s_waitcnt lgkmcnt(5)
    v_mfma_f32_16x16x32_bf16 v[208:211], a[92:95], a[12:15], v[208:211]
    ds_read_b64_tr_b16 a[106:107], v233 offset:12288
    v_mfma_f32_16x16x32_bf16 v[212:215], a[92:95], a[28:31], -4.0
    ds_read_b64_tr_b16 a[108:109], v233 offset:8200
    v_mfma_f32_16x16x32_bf16 v[212:215], a[88:91], a[24:27], v[212:215]
    ds_read_b64_tr_b16 a[110:111], v233 offset:12296
    v_mfma_f32_16x16x32_bf16 v[212:215], a[84:87], a[20:23], v[212:215]
    ds_read_b64_tr_b16 a[96:97], v234 offset:8192
    v_mfma_f32_16x16x32_bf16 v[212:215], a[80:83], a[16:19], v[212:215]
    global_load_lds_dwordx4 v230, s[52:53] offset:0 nt
    s_waitcnt vmcnt(8)
    v_mfma_f32_16x16x32_bf16 v[200:203], a[80:83], a[32:35], -4.0
    ds_read_b128 a[80:83], v228 offset:53248
    v_exp_f32 v208, v208
    v_exp_f32 v209, v209
    v_exp_f32 v210, v210
    v_exp_f32 v211, v211
    ds_read_b64_tr_b16 a[98:99], v234 offset:12288
    ds_read_b64_tr_b16 a[100:101], v234 offset:8200
    ds_read_b64_tr_b16 a[102:103], v234 offset:12296
    v_cvt_pk_bf16_f32 v160, v208, v209
    v_cvt_pk_bf16_f32 v161, v210, v211
    v_exp_f32 v212, v212
    v_exp_f32 v213, v213
    v_exp_f32 v214, v214
    v_exp_f32 v215, v215
    v_cvt_pk_bf16_f32 v168, v212, v213
    v_cvt_pk_bf16_f32 v169, v214, v215
    s_waitcnt vmcnt(7)
    v_mfma_f32_16x16x32_bf16 v[200:203], a[84:87], a[36:39], v[200:203]
    ds_read_b128 a[84:87], v228 offset:53504
    global_load_lds_dwordx4 v230, s[52:53] offset:1024 nt
    s_add_u32 m0, s23, 24576
    s_add_u32 s52, s52, 8192
    s_addc_u32 s53, s53, 0
    s_waitcnt vmcnt(7)
    v_mfma_f32_16x16x32_bf16 v[200:203], a[88:91], a[40:43], v[200:203]
    ds_read_b128 a[88:91], v228 offset:53760
    global_load_lds_dwordx4 v230, s[54:55] offset:0 nt
    s_waitcnt vmcnt(7)
    v_mfma_f32_16x16x32_bf16 v[200:203], a[92:95], a[44:47], v[200:203]
    s_waitcnt lgkmcnt(0)
    v_mfma_f32_16x16x32_bf16 v[0:3], a[176:179], v[164:167], v[0:3]
    ds_read_b128 a[92:95], v228 offset:54016
    v_mfma_f32_16x16x32_bf16 v[32:35], a[176:179], v[172:175], v[32:35]
    global_load_lds_dwordx4 v230, s[54:55] offset:1024 nt
    v_mfma_f32_16x16x32_bf16 v[36:39], a[180:183], v[172:175], v[36:39]
    s_add_u32 s54, s54, 8192
    s_addc_u32 s55, s55, 0
    s_add_u32 m0, s21, 73728
    v_mfma_f32_16x16x32_bf16 v[4:7], a[180:183], v[164:167], v[4:7]
    v_exp_f32 v200, v200
    v_mfma_f32_16x16x32_bf16 v[8:11], a[104:107], v[164:167], v[8:11]
    v_exp_f32 v201, v201
    v_mfma_f32_16x16x32_bf16 v[40:43], a[104:107], v[172:175], v[40:43]
    ds_read_b64_tr_b16 a[104:105], v235 offset:8192
    v_cvt_pk_bf16_f32 v176, v200, v201
    v_mfma_f32_16x16x32_bf16 v[44:47], a[108:111], v[172:175], v[44:47]
    ds_read_b64_tr_b16 a[106:107], v235 offset:12288
    v_mfma_f32_16x16x32_bf16 v[12:15], a[108:111], v[164:167], v[12:15]
    ds_read_b64_tr_b16 a[108:109], v235 offset:8200
    v_mfma_f32_16x16x32_bf16 v[204:207], a[80:83], a[0:3], -4.0
    ds_read_b64_tr_b16 a[110:111], v235 offset:12296
    v_mfma_f32_16x16x32_bf16 v[204:207], a[84:87], a[4:7], v[204:207]
    v_exp_f32 v202, v202
    v_mfma_f32_16x16x32_bf16 v[204:207], a[88:91], a[8:11], v[204:207]
    s_waitcnt lgkmcnt(4)
    v_exp_f32 v203, v203
    v_mfma_f32_16x16x32_bf16 v[204:207], a[92:95], a[12:15], v[204:207]
    v_cvt_pk_bf16_f32 v177, v202, v203
    v_mfma_f32_16x16x32_bf16 v[208:211], a[92:95], a[28:31], -4.0
    v_mfma_f32_16x16x32_bf16 v[208:211], a[88:91], a[24:27], v[208:211]
    v_mfma_f32_16x16x32_bf16 v[208:211], a[84:87], a[20:23], v[208:211]
    v_mfma_f32_16x16x32_bf16 v[208:211], a[80:83], a[16:19], v[208:211]
    v_mfma_f32_16x16x32_bf16 v[212:215], a[80:83], a[32:35], -4.0
    v_mfma_f32_16x16x32_bf16 v[212:215], a[84:87], a[36:39], v[212:215]
    s_waitcnt vmcnt(7)
    ds_read_b128 v[216:219], v231 offset:57344
    global_load_lds_dwordx4 v230, s[52:53] offset:0 nt
    v_mfma_f32_16x16x32_bf16 v[212:215], a[88:91], a[40:43], v[212:215]
    v_exp_f32 v204, v204
    v_mfma_f32_16x16x32_bf16 v[212:215], a[92:95], a[44:47], v[212:215]
    v_exp_f32 v208, v208
    v_mfma_f32_16x16x32_bf16 v[16:19], a[96:99], v[164:167], v[16:19]
    v_exp_f32 v209, v209
    v_mfma_f32_16x16x32_bf16 v[48:51], a[96:99], v[172:175], v[48:51]
    v_exp_f32 v210, v210
    v_mfma_f32_16x16x32_bf16 v[52:55], a[100:103], v[172:175], v[52:55]
    s_waitcnt lgkmcnt(0)
    v_lshlrev_b32 v244, 16, v216
    v_and_b32 v245, 0xffff0000, v216
    v_lshlrev_b32 v246, 16, v217
    v_and_b32 v247, 0xffff0000, v217
    v_mul_f32 v244, s27, v244
    v_mul_f32 v245, s27, v245
    v_mul_f32 v246, s27, v246
    v_mul_f32 v247, s27, v247
    v_cvt_pk_bf16_f32 v216, v244, v245
    v_cvt_pk_bf16_f32 v217, v246, v247
    v_lshlrev_b32 v244, 16, v218
    v_and_b32 v245, 0xffff0000, v218
    v_lshlrev_b32 v246, 16, v219
    v_and_b32 v247, 0xffff0000, v219
    v_mul_f32 v244, s27, v244
    v_mul_f32 v245, s27, v245
    v_mul_f32 v246, s27, v246
    v_mul_f32 v247, s27, v247
    v_cvt_pk_bf16_f32 v218, v244, v245
    v_cvt_pk_bf16_f32 v219, v246, v247
    ds_write_b128 v231, v[216:219] offset:57344
    v_mfma_f32_16x16x32_bf16 v[20:23], a[100:103], v[164:167], v[20:23]
    v_exp_f32 v211, v211
    v_mfma_f32_16x16x32_bf16 v[24:27], a[104:107], v[164:167], v[24:27]
    v_cvt_pk_bf16_f32 v170, v208, v209
    v_cvt_pk_bf16_f32 v171, v210, v211
    v_mfma_f32_16x16x32_bf16 v[56:59], a[104:107], v[172:175], v[56:59]
    v_exp_f32 v205, v205
    v_mfma_f32_16x16x32_bf16 v[60:63], a[108:111], v[172:175], v[60:63]
    s_waitcnt vmcnt(7)
    ds_read_b128 v[220:223], v231 offset:58368
    global_load_lds_dwordx4 v230, s[52:53] offset:1024 nt
    v_mfma_f32_16x16x32_bf16 v[28:31], a[108:111], v[164:167], v[28:31]
    s_add_u32 m0, s23, 32768
    s_add_u32 s52, s52, 8192
    s_addc_u32 s53, s53, 0
    v_smfmac_f32_16x16x64_bf16 a[116:119], a[132:135], v[168:175], v238
    v_exp_f32 v206, v206
    v_exp_f32 v207, v207
    v_cvt_pk_bf16_f32 v162, v204, v205
    v_cvt_pk_bf16_f32 v163, v206, v207
    v_exp_f32 v212, v212
    v_exp_f32 v213, v213
    v_exp_f32 v214, v214
    v_exp_f32 v215, v215
    v_cvt_pk_bf16_f32 v178, v212, v213
    v_cvt_pk_bf16_f32 v179, v214, v215
    s_waitcnt lgkmcnt(0)
    v_lshlrev_b32 v244, 16, v220
    v_and_b32 v245, 0xffff0000, v220
    v_lshlrev_b32 v246, 16, v221
    v_and_b32 v247, 0xffff0000, v221
    v_mul_f32 v244, s27, v244
    v_mul_f32 v245, s27, v245
    v_mul_f32 v246, s27, v246
    v_mul_f32 v247, s27, v247
    v_cvt_pk_bf16_f32 v220, v244, v245
    v_cvt_pk_bf16_f32 v221, v246, v247
    v_lshlrev_b32 v244, 16, v222
    v_and_b32 v245, 0xffff0000, v222
    v_lshlrev_b32 v246, 16, v223
    v_and_b32 v247, 0xffff0000, v223
    v_mul_f32 v244, s27, v244
    v_mul_f32 v245, s27, v245
    v_mul_f32 v246, s27, v246
    v_mul_f32 v247, s27, v247
    v_cvt_pk_bf16_f32 v222, v244, v245
    v_cvt_pk_bf16_f32 v223, v246, v247
    ds_write_b128 v231, v[220:223] offset:58368
    s_nop 0
    s_nop 0
    v_xor_b32 v231, 0x1000, v236
    global_load_lds_dwordx4 v230, s[54:55] offset:0 nt
    s_waitcnt vmcnt(7) lgkmcnt(0)
    s_barrier
    ds_read_b128 a[80:83], v228 offset:57344
    ds_read_b128 a[84:87], v228 offset:57600
    ds_read_b128 a[88:91], v228 offset:57856
    ds_read_b128 a[92:95], v228 offset:58112
    ds_read_b64_tr_b16 a[184:185], v232 offset:16384
    ds_read_b64_tr_b16 a[186:187], v232 offset:20480
    global_load_lds_dwordx4 v230, s[54:55] offset:1024 nt
    s_add_u32 s54, s54, 8192
    s_addc_u32 s55, s55, 0
    s_add_u32 m0, s21, 81920
    ds_read_b64_tr_b16 a[188:189], v232 offset:16392
    ds_read_b64_tr_b16 a[190:191], v232 offset:20488
    s_waitcnt lgkmcnt(7)
    v_mfma_f32_16x16x32_bf16 v[200:203], a[80:83], a[0:3], -4.0
    ds_read_b64_tr_b16 a[104:105], v233 offset:16384
    s_waitcnt lgkmcnt(7)
    v_mfma_f32_16x16x32_bf16 v[200:203], a[84:87], a[4:7], v[200:203]
    s_waitcnt lgkmcnt(6)
    v_mfma_f32_16x16x32_bf16 v[200:203], a[88:91], a[8:11], v[200:203]
    s_waitcnt lgkmcnt(5)
    v_mfma_f32_16x16x32_bf16 v[200:203], a[92:95], a[12:15], v[200:203]
    ds_read_b64_tr_b16 a[106:107], v233 offset:20480
    v_mfma_f32_16x16x32_bf16 v[204:207], a[92:95], a[28:31], -4.0
    ds_read_b64_tr_b16 a[108:109], v233 offset:16392
    v_mfma_f32_16x16x32_bf16 v[204:207], a[88:91], a[24:27], v[204:207]
    ds_read_b64_tr_b16 a[110:111], v233 offset:20488
    v_mfma_f32_16x16x32_bf16 v[204:207], a[84:87], a[20:23], v[204:207]
    ds_read_b64_tr_b16 a[96:97], v234 offset:16384
    v_mfma_f32_16x16x32_bf16 v[204:207], a[80:83], a[16:19], v[204:207]
    v_exp_f32 v200, v200
    v_mfma_f32_16x16x32_bf16 v[208:211], a[80:83], a[32:35], -4.0
    ds_read_b128 a[80:83], v228 offset:61440
    v_mfma_f32_16x16x32_bf16 v[208:211], a[84:87], a[36:39], v[208:211]
    global_load_dwordx4 a[48:51], v237, s[4:5] offset:0 nt
    v_mfma_f32_16x16x32_bf16 v[208:211], a[88:91], a[40:43], v[208:211]
    ds_read_b128 a[84:87], v228 offset:61696
    v_mfma_f32_16x16x32_bf16 v[208:211], a[92:95], a[44:47], v[208:211]
    s_waitcnt lgkmcnt(5)
    v_exp_f32 v201, v201
    v_mfma_f32_16x16x32_bf16 v[0:3], a[184:187], v[160:163], v[0:3]
    s_waitcnt vmcnt(8)
    v_exp_f32 v202, v202
    v_mfma_f32_16x16x32_bf16 v[32:35], a[184:187], v[168:171], v[32:35]
    ds_read_b128 v[216:219], v239 offset:0
    v_cvt_pk_bf16_f32 v164, v200, v201
    v_mfma_f32_16x16x32_bf16 v[64:67], a[184:187], v[176:179], 0
    ds_read_b128 a[88:91], v228 offset:61952
    v_mfma_f32_16x16x32_bf16 v[68:71], a[188:191], v[176:179], 0
    ds_read_b128 a[92:95], v228 offset:62208
    v_mfma_f32_16x16x32_bf16 v[36:39], a[188:191], v[168:171], v[36:39]
    v_exp_f32 v203, v203
    v_mfma_f32_16x16x32_bf16 v[4:7], a[188:191], v[160:163], v[4:7]
    ds_read_b64_tr_b16 a[98:99], v234 offset:20480
    v_cvt_pk_bf16_f32 v165, v202, v203
    v_mfma_f32_16x16x32_bf16 v[8:11], a[104:107], v[160:163], v[8:11]
    ds_read_b64_tr_b16 a[100:101], v234 offset:16392
    v_mfma_f32_16x16x32_bf16 v[40:43], a[104:107], v[168:171], v[40:43]
    ds_read_b64_tr_b16 a[102:103], v234 offset:20488
    v_mfma_f32_16x16x32_bf16 v[72:75], a[104:107], v[176:179], 0
    s_waitcnt lgkmcnt(6)
    v_exp_f32 v204, v204
    v_mfma_f32_16x16x32_bf16 v[76:79], a[108:111], v[176:179], 0
    s_waitcnt lgkmcnt(5)
    v_lshlrev_b32 v244, 16, v216
    v_and_b32 v245, 0xffff0000, v216
    v_mfma_f32_16x16x32_bf16 v[44:47], a[108:111], v[168:171], v[44:47]
    ds_read_b64_tr_b16 a[104:105], v235 offset:16384
    v_lshlrev_b32 v246, 16, v217
    v_mfma_f32_16x16x32_bf16 v[12:15], a[108:111], v[160:163], v[12:15]
    ds_read_b64_tr_b16 a[106:107], v235 offset:20480
    v_and_b32 v247, 0xffff0000, v217
    v_mfma_f32_16x16x32_bf16 v[212:215], a[80:83], a[0:3], -4.0
    ds_read_b64_tr_b16 a[108:109], v235 offset:16392
    v_mul_f32 v244, s27, v244
    v_mfma_f32_16x16x32_bf16 v[212:215], a[84:87], a[4:7], v[212:215]
    s_waitcnt lgkmcnt(6)
    v_mul_f32 v245, s27, v245
    v_mul_f32 v246, s27, v246
    v_mul_f32 v247, s27, v247
    v_mfma_f32_16x16x32_bf16 v[212:215], a[88:91], a[8:11], v[212:215]
    ds_read_b64_tr_b16 a[110:111], v235 offset:20488
    v_cvt_pk_bf16_f32 v216, v244, v245
    v_cvt_pk_bf16_f32 v217, v246, v247
    global_load_dwordx4 a[52:55], v237, s[4:5] offset:64 nt
    s_waitcnt vmcnt(8)
    ds_read_b128 v[220:223], v239 offset:1024
    v_lshlrev_b32 v244, 16, v218
    v_and_b32 v245, 0xffff0000, v218
    v_lshlrev_b32 v246, 16, v219
    v_and_b32 v247, 0xffff0000, v219
    v_mfma_f32_16x16x32_bf16 v[212:215], a[92:95], a[12:15], v[212:215]
    v_mul_f32 v244, s27, v244
    v_mul_f32 v245, s27, v245
    v_mul_f32 v246, s27, v246
    v_mul_f32 v247, s27, v247
    v_cvt_pk_bf16_f32 v218, v244, v245
    v_cvt_pk_bf16_f32 v219, v246, v247
    v_mfma_f32_16x16x32_bf16 v[200:203], a[92:95], a[28:31], -4.0
    v_exp_f32 v205, v205
    v_mfma_f32_16x16x32_bf16 v[200:203], a[88:91], a[24:27], v[200:203]
    v_exp_f32 v206, v206
    v_mfma_f32_16x16x32_bf16 v[200:203], a[84:87], a[20:23], v[200:203]
    s_waitcnt lgkmcnt(0)
    v_lshlrev_b32 v244, 16, v220
    v_and_b32 v245, 0xffff0000, v220
    v_lshlrev_b32 v246, 16, v221
    v_and_b32 v247, 0xffff0000, v221
    v_mul_f32 v244, s27, v244
    v_mul_f32 v245, s27, v245
    v_mul_f32 v246, s27, v246
    v_mul_f32 v247, s27, v247
    v_cvt_pk_bf16_f32 v220, v244, v245
    v_cvt_pk_bf16_f32 v221, v246, v247
    v_lshlrev_b32 v244, 16, v222
    v_and_b32 v245, 0xffff0000, v222
    v_lshlrev_b32 v246, 16, v223
    v_and_b32 v247, 0xffff0000, v223
    v_mul_f32 v244, s27, v244
    v_mul_f32 v245, s27, v245
    v_mul_f32 v246, s27, v246
    v_mul_f32 v247, s27, v247
    v_exp_f32 v207, v207
    v_cvt_pk_bf16_f32 v222, v244, v245
    v_cvt_pk_bf16_f32 v223, v246, v247
    v_mfma_f32_16x16x32_bf16 v[200:203], a[80:83], a[16:19], v[200:203]
    ds_write_b128 v239, v[216:219] offset:0
    v_cvt_pk_bf16_f32 v172, v204, v205
    v_cvt_pk_bf16_f32 v173, v206, v207
    v_mfma_f32_16x16x32_bf16 v[204:207], a[80:83], a[32:35], -4.0
    v_exp_f32 v212, v212
    v_mfma_f32_16x16x32_bf16 v[204:207], a[84:87], a[36:39], v[204:207]
    ds_write_b128 v239, v[220:223] offset:1024
    v_mfma_f32_16x16x32_bf16 v[204:207], a[88:91], a[40:43], v[204:207]
    global_load_dwordx4 a[56:59], v237, s[4:5] offset:128 nt
    v_mfma_f32_16x16x32_bf16 v[204:207], a[92:95], a[44:47], v[204:207]
    v_exp_f32 v213, v213
    v_mfma_f32_16x16x32_bf16 v[16:19], a[96:99], v[160:163], v[16:19]
    v_exp_f32 v214, v214
    v_mfma_f32_16x16x32_bf16 v[48:51], a[96:99], v[168:171], v[48:51]
    v_exp_f32 v215, v215
    v_mfma_f32_16x16x32_bf16 v[80:83], a[96:99], v[176:179], 0
    v_exp_f32 v208, v208
    v_mfma_f32_16x16x32_bf16 v[84:87], a[100:103], v[176:179], 0
    v_exp_f32 v209, v209
    v_mfma_f32_16x16x32_bf16 v[52:55], a[100:103], v[168:171], v[52:55]
    v_exp_f32 v210, v210
    v_mfma_f32_16x16x32_bf16 v[20:23], a[100:103], v[160:163], v[20:23]
    v_exp_f32 v211, v211
    v_mfma_f32_16x16x32_bf16 v[24:27], a[104:107], v[160:163], v[24:27]
    v_cvt_pk_bf16_f32 v166, v212, v213
    v_cvt_pk_bf16_f32 v167, v214, v215
    v_mfma_f32_16x16x32_bf16 v[56:59], a[104:107], v[168:171], v[56:59]
    v_exp_f32 v204, v204
    v_mfma_f32_16x16x32_bf16 v[88:91], a[104:107], v[176:179], 0
    v_exp_f32 v205, v205
    v_mfma_f32_16x16x32_bf16 v[92:95], a[108:111], v[176:179], 0
    v_exp_f32 v206, v206
    v_mfma_f32_16x16x32_bf16 v[60:63], a[108:111], v[168:171], v[60:63]
    v_exp_f32 v207, v207
    v_mfma_f32_16x16x32_bf16 v[28:31], a[108:111], v[160:163], v[28:31]
    v_cvt_pk_bf16_f32 v180, v208, v209
    v_cvt_pk_bf16_f32 v181, v210, v211
    v_cvt_pk_bf16_f32 v182, v204, v205
    v_cvt_pk_bf16_f32 v183, v206, v207
    v_smfmac_f32_16x16x64_bf16 a[112:115], a[132:135], v[160:167], v238
    s_nop 0
    v_smfmac_f32_16x16x64_bf16 a[120:123], a[132:135], v[176:183], v238
    v_exp_f32 v200, v200
    v_exp_f32 v201, v201
    v_exp_f32 v202, v202
    v_exp_f32 v203, v203
    v_cvt_pk_bf16_f32 v174, v200, v201
    v_cvt_pk_bf16_f32 v175, v202, v203
    s_waitcnt vmcnt(7) lgkmcnt(0)
    s_barrier
    ds_read_b128 a[80:83], v229 offset:0
    ds_read_b128 a[84:87], v229 offset:256
    global_load_dwordx4 a[60:63], v237, s[4:5] offset:192 nt
    ds_read_b128 a[88:91], v229 offset:512
    ds_read_b128 a[92:95], v229 offset:768
    ds_read_b64_tr_b16 a[192:193], v232 offset:24576
    ds_read_b64_tr_b16 a[194:195], v232 offset:28672
    s_add_u32 s4, s4, 16384
    s_addc_u32 s5, s5, 0
    ds_read_b64_tr_b16 a[196:197], v232 offset:24584
    ds_read_b64_tr_b16 a[198:199], v232 offset:28680
    s_waitcnt lgkmcnt(7)
    v_mfma_f32_16x16x32_bf16 v[208:211], a[80:83], a[0:3], -4.0
    ds_read_b64_tr_b16 a[104:105], v233 offset:24576
    s_waitcnt lgkmcnt(7)
    v_mfma_f32_16x16x32_bf16 v[208:211], a[84:87], a[4:7], v[208:211]
    ds_read_b64_tr_b16 a[106:107], v233 offset:28672
    s_waitcnt lgkmcnt(7)
    v_mfma_f32_16x16x32_bf16 v[208:211], a[88:91], a[8:11], v[208:211]
    ds_read_b64_tr_b16 a[108:109], v233 offset:24584
    s_waitcnt lgkmcnt(7)
    v_mfma_f32_16x16x32_bf16 v[208:211], a[92:95], a[12:15], v[208:211]
    ds_read_b64_tr_b16 a[110:111], v233 offset:28680
    v_mfma_f32_16x16x32_bf16 v[212:215], a[92:95], a[28:31], -4.0
    ds_read_b64_tr_b16 a[96:97], v234 offset:24576
    v_mfma_f32_16x16x32_bf16 v[212:215], a[88:91], a[24:27], v[212:215]
    ds_read_b64_tr_b16 a[98:99], v234 offset:28672
    v_mfma_f32_16x16x32_bf16 v[212:215], a[84:87], a[20:23], v[212:215]
    ds_read_b64_tr_b16 a[100:101], v234 offset:24584
    v_mfma_f32_16x16x32_bf16 v[212:215], a[80:83], a[16:19], v[212:215]
    v_exp_f32 v208, v208
    v_mfma_f32_16x16x32_bf16 v[200:203], a[80:83], a[32:35], -4.0
    global_load_lds_dwordx4 v230, s[52:53] offset:0 nt
    v_mfma_f32_16x16x32_bf16 v[200:203], a[84:87], a[36:39], v[200:203]
    ds_read_b128 a[80:83], v229 offset:4096
    v_mfma_f32_16x16x32_bf16 v[200:203], a[88:91], a[40:43], v[200:203]
    s_waitcnt vmcnt(8)
    v_exp_f32 v209, v209
    v_mfma_f32_16x16x32_bf16 v[200:203], a[92:95], a[44:47], v[200:203]
    s_waitcnt lgkmcnt(3)
    v_exp_f32 v210, v210
    v_mfma_f32_16x16x32_bf16 v[0:3], a[192:195], v[164:167], v[0:3]
    ds_read_b128 v[216:219], v239 offset:8192
    v_cvt_pk_bf16_f32 v160, v208, v209
    v_mfma_f32_16x16x32_bf16 v[32:35], a[192:195], v[172:175], v[32:35]
    ds_read_b128 a[84:87], v229 offset:4352
    v_mfma_f32_16x16x32_bf16 v[64:67], a[192:195], v[180:183], v[64:67]
    ds_read_b128 a[88:91], v229 offset:4608
    v_mfma_f32_16x16x32_bf16 v[68:71], a[196:199], v[180:183], v[68:71]
    ds_read_b128 a[92:95], v229 offset:4864
    v_mfma_f32_16x16x32_bf16 v[36:39], a[196:199], v[172:175], v[36:39]
    v_exp_f32 v211, v211
    v_mfma_f32_16x16x32_bf16 v[4:7], a[196:199], v[164:167], v[4:7]
    ds_read_b64_tr_b16 a[102:103], v234 offset:28680
    v_cvt_pk_bf16_f32 v161, v210, v211
    v_mfma_f32_16x16x32_bf16 v[8:11], a[104:107], v[164:167], v[8:11]
    v_exp_f32 v212, v212
    v_mfma_f32_16x16x32_bf16 v[40:43], a[104:107], v[172:175], v[40:43]
    v_exp_f32 v213, v213
    v_mfma_f32_16x16x32_bf16 v[72:75], a[104:107], v[180:183], v[72:75]
    s_waitcnt lgkmcnt(4)
    v_lshlrev_b32 v244, 16, v216
    v_and_b32 v245, 0xffff0000, v216
    v_mfma_f32_16x16x32_bf16 v[76:79], a[108:111], v[180:183], v[76:79]
    ds_read_b64_tr_b16 a[104:105], v235 offset:24576
    v_lshlrev_b32 v246, 16, v217
    v_mfma_f32_16x16x32_bf16 v[44:47], a[108:111], v[172:175], v[44:47]
    ds_read_b64_tr_b16 a[106:107], v235 offset:28672
    v_and_b32 v247, 0xffff0000, v217
    v_mfma_f32_16x16x32_bf16 v[12:15], a[108:111], v[164:167], v[12:15]
    ds_read_b64_tr_b16 a[108:109], v235 offset:24584
    v_mul_f32 v244, s27, v244
    v_mfma_f32_16x16x32_bf16 v[204:207], a[80:83], a[0:3], -4.0
    s_waitcnt lgkmcnt(5)
    v_mul_f32 v245, s27, v245
    v_mul_f32 v246, s27, v246
    v_mul_f32 v247, s27, v247
    v_mfma_f32_16x16x32_bf16 v[204:207], a[84:87], a[4:7], v[204:207]
    ds_read_b64_tr_b16 a[110:111], v235 offset:28680
    v_cvt_pk_bf16_f32 v216, v244, v245
    v_cvt_pk_bf16_f32 v217, v246, v247
    global_load_lds_dwordx4 v230, s[52:53] offset:1024 nt
    s_waitcnt vmcnt(8)
    ds_read_b128 v[220:223], v239 offset:9216
    v_lshlrev_b32 v244, 16, v218
    v_and_b32 v245, 0xffff0000, v218
    v_lshlrev_b32 v246, 16, v219
    v_and_b32 v247, 0xffff0000, v219
    v_mfma_f32_16x16x32_bf16 v[204:207], a[88:91], a[8:11], v[204:207]
    s_waitcnt lgkmcnt(4)
    v_mul_f32 v244, s27, v244
    v_mul_f32 v245, s27, v245
    v_mul_f32 v246, s27, v246
    v_mul_f32 v247, s27, v247
    v_cvt_pk_bf16_f32 v218, v244, v245
    v_cvt_pk_bf16_f32 v219, v246, v247
    v_mfma_f32_16x16x32_bf16 v[204:207], a[92:95], a[12:15], v[204:207]
    s_add_u32 m0, s23, 40960
    s_add_u32 s52, s52, 8192
    s_addc_u32 s53, s53, 0
    v_mfma_f32_16x16x32_bf16 v[208:211], a[92:95], a[28:31], -4.0
    ds_write_b128 v239, v[216:219] offset:8192
    v_mfma_f32_16x16x32_bf16 v[208:211], a[88:91], a[24:27], v[208:211]
    s_waitcnt lgkmcnt(1)
    v_lshlrev_b32 v244, 16, v220
    v_and_b32 v245, 0xffff0000, v220
    v_lshlrev_b32 v246, 16, v221
    v_and_b32 v247, 0xffff0000, v221
    v_mul_f32 v244, s27, v244
    v_mul_f32 v245, s27, v245
    v_mul_f32 v246, s27, v246
    v_mul_f32 v247, s27, v247
    v_cvt_pk_bf16_f32 v220, v244, v245
    v_cvt_pk_bf16_f32 v221, v246, v247
    v_lshlrev_b32 v244, 16, v222
    v_and_b32 v245, 0xffff0000, v222
    v_lshlrev_b32 v246, 16, v223
    v_and_b32 v247, 0xffff0000, v223
    v_mul_f32 v244, s27, v244
    v_mul_f32 v245, s27, v245
    v_mul_f32 v246, s27, v246
    v_mul_f32 v247, s27, v247
    v_cvt_pk_bf16_f32 v222, v244, v245
    v_cvt_pk_bf16_f32 v223, v246, v247
    v_mfma_f32_16x16x32_bf16 v[208:211], a[84:87], a[20:23], v[208:211]
    ds_write_b128 v239, v[220:223] offset:9216
    v_exp_f32 v214, v214
    v_exp_f32 v215, v215
    v_mfma_f32_16x16x32_bf16 v[208:211], a[80:83], a[16:19], v[208:211]
    v_cvt_pk_bf16_f32 v168, v212, v213
    v_cvt_pk_bf16_f32 v169, v214, v215
    v_mfma_f32_16x16x32_bf16 v[212:215], a[80:83], a[32:35], -4.0
    v_exp_f32 v200, v200
    v_mfma_f32_16x16x32_bf16 v[212:215], a[84:87], a[36:39], v[212:215]
    v_exp_f32 v201, v201
    v_mfma_f32_16x16x32_bf16 v[212:215], a[88:91], a[40:43], v[212:215]
    global_load_lds_dwordx4 v230, s[54:55] offset:0 nt
    v_mfma_f32_16x16x32_bf16 v[212:215], a[92:95], a[44:47], v[212:215]
    v_exp_f32 v208, v208
    v_mfma_f32_16x16x32_bf16 v[16:19], a[96:99], v[164:167], v[16:19]
    v_exp_f32 v209, v209
    v_mfma_f32_16x16x32_bf16 v[48:51], a[96:99], v[172:175], v[48:51]
    v_exp_f32 v210, v210
    v_mfma_f32_16x16x32_bf16 v[80:83], a[96:99], v[180:183], v[80:83]
    v_exp_f32 v211, v211
    v_mfma_f32_16x16x32_bf16 v[84:87], a[100:103], v[180:183], v[84:87]
    v_cvt_pk_bf16_f32 v170, v208, v209
    v_cvt_pk_bf16_f32 v171, v210, v211
    v_mfma_f32_16x16x32_bf16 v[52:55], a[100:103], v[172:175], v[52:55]
    v_exp_f32 v202, v202
    v_mfma_f32_16x16x32_bf16 v[20:23], a[100:103], v[164:167], v[20:23]
    v_exp_f32 v203, v203
    v_mfma_f32_16x16x32_bf16 v[24:27], a[104:107], v[164:167], v[24:27]
    v_cvt_pk_bf16_f32 v176, v200, v201
    v_cvt_pk_bf16_f32 v177, v202, v203
    v_mfma_f32_16x16x32_bf16 v[56:59], a[104:107], v[172:175], v[56:59]
    v_exp_f32 v204, v204
    v_mfma_f32_16x16x32_bf16 v[88:91], a[104:107], v[180:183], v[88:91]
    v_exp_f32 v205, v205
    v_mfma_f32_16x16x32_bf16 v[92:95], a[108:111], v[180:183], v[92:95]
    v_exp_f32 v206, v206
    v_mfma_f32_16x16x32_bf16 v[60:63], a[108:111], v[172:175], v[60:63]
    v_exp_f32 v207, v207
    v_mfma_f32_16x16x32_bf16 v[28:31], a[108:111], v[164:167], v[28:31]
    v_cvt_pk_bf16_f32 v162, v204, v205
    v_cvt_pk_bf16_f32 v163, v206, v207
    v_smfmac_f32_16x16x64_bf16 a[116:119], a[132:135], v[168:175], v238
    v_exp_f32 v212, v212
    v_exp_f32 v213, v213
    v_exp_f32 v214, v214
    v_exp_f32 v215, v215
    v_cvt_pk_bf16_f32 v178, v212, v213
    v_cvt_pk_bf16_f32 v179, v214, v215
    s_waitcnt vmcnt(7) lgkmcnt(0)
    s_barrier
    ds_read_b128 a[80:83], v229 offset:8192
    global_load_lds_dwordx4 v230, s[54:55] offset:1024 nt
    ds_read_b128 a[84:87], v229 offset:8448
    ds_read_b128 a[88:91], v229 offset:8704
    ds_read_b128 a[92:95], v229 offset:8960
    s_add_u32 s54, s54, 8192
    s_addc_u32 s55, s55, 0
    s_add_u32 m0, s21, 90112
    ds_read_b64_tr_b16 a[200:201], v232 offset:32768
    ds_read_b64_tr_b16 a[202:203], v232 offset:36864
    ds_read_b64_tr_b16 a[204:205], v232 offset:32776
    ds_read_b64_tr_b16 a[206:207], v232 offset:36872
    s_waitcnt lgkmcnt(7)
    v_mfma_f32_16x16x32_bf16 v[200:203], a[80:83], a[0:3], -4.0
    ds_read_b64_tr_b16 a[104:105], v233 offset:32768
    ds_read_b64_tr_b16 a[106:107], v233 offset:36864
    s_waitcnt lgkmcnt(8)
    v_mfma_f32_16x16x32_bf16 v[200:203], a[84:87], a[4:7], v[200:203]
    ds_read_b64_tr_b16 a[108:109], v233 offset:32776
    s_waitcnt lgkmcnt(8)
    v_mfma_f32_16x16x32_bf16 v[200:203], a[88:91], a[8:11], v[200:203]
    s_waitcnt lgkmcnt(7)
    v_mfma_f32_16x16x32_bf16 v[200:203], a[92:95], a[12:15], v[200:203]
    ds_read_b64_tr_b16 a[110:111], v233 offset:36872
    v_mfma_f32_16x16x32_bf16 v[204:207], a[92:95], a[28:31], -4.0
    ds_read_b64_tr_b16 a[96:97], v234 offset:32768
    v_mfma_f32_16x16x32_bf16 v[204:207], a[88:91], a[24:27], v[204:207]
    ds_read_b64_tr_b16 a[98:99], v234 offset:36864
    v_mfma_f32_16x16x32_bf16 v[204:207], a[84:87], a[20:23], v[204:207]
    ds_read_b64_tr_b16 a[100:101], v234 offset:32776
    v_mfma_f32_16x16x32_bf16 v[204:207], a[80:83], a[16:19], v[204:207]
    v_exp_f32 v200, v200
    v_mfma_f32_16x16x32_bf16 v[208:211], a[80:83], a[32:35], -4.0
    global_load_lds_dwordx4 v230, s[52:53] offset:0 nt
    v_mfma_f32_16x16x32_bf16 v[208:211], a[84:87], a[36:39], v[208:211]
    v_exp_f32 v201, v201
    v_mfma_f32_16x16x32_bf16 v[208:211], a[88:91], a[40:43], v[208:211]
    v_exp_f32 v202, v202
    v_mfma_f32_16x16x32_bf16 v[208:211], a[92:95], a[44:47], v[208:211]
    global_load_lds_dwordx4 v230, s[52:53] offset:1024 nt
    s_add_u32 m0, s23, 49152
    s_add_u32 s52, s52, 8192
    s_addc_u32 s53, s53, 0
    global_load_lds_dwordx4 v230, s[54:55] offset:0 nt
    v_exp_f32 v203, v203
    v_cvt_pk_bf16_f32 v164, v200, v201
    v_cvt_pk_bf16_f32 v165, v202, v203
    v_exp_f32 v204, v204
    v_exp_f32 v205, v205
    v_exp_f32 v206, v206
    v_exp_f32 v207, v207
    v_cvt_pk_bf16_f32 v172, v204, v205
    v_cvt_pk_bf16_f32 v173, v206, v207
    v_exp_f32 v208, v208
    v_exp_f32 v209, v209
    v_exp_f32 v210, v210
    v_exp_f32 v211, v211
    v_cvt_pk_bf16_f32 v180, v208, v209
    v_cvt_pk_bf16_f32 v181, v210, v211
    ds_read_b64_tr_b16 a[102:103], v234 offset:36872
    s_waitcnt vmcnt(7)
    v_mfma_f32_16x16x32_bf16 v[212:215], a[92:95], a[60:63], -4.0
    global_load_lds_dwordx4 v230, s[54:55] offset:1024 nt
    v_mfma_f32_16x16x32_bf16 v[212:215], a[88:91], a[56:59], v[212:215]
    s_add_u32 s54, s54, 8192
    s_addc_u32 s55, s55, 0
    s_add_u32 m0, s21, 98304
    v_mfma_f32_16x16x32_bf16 v[212:215], a[84:87], a[52:55], v[212:215]
    ds_read_b128 a[84:87], v229 offset:12544
    v_mfma_f32_16x16x32_bf16 v[212:215], a[80:83], a[48:51], v[212:215]
    s_waitcnt lgkmcnt(1)
    v_mfma_f32_16x16x32_bf16 v[0:3], a[200:203], v[160:163], v[0:3]
    ds_read_b128 a[80:83], v229 offset:12288
    v_mfma_f32_16x16x32_bf16 v[32:35], a[200:203], v[168:171], v[32:35]
    ds_read_b128 a[88:91], v229 offset:12800
    v_mfma_f32_16x16x32_bf16 v[64:67], a[200:203], v[176:179], v[64:67]
    ds_read_b128 a[92:95], v229 offset:13056
    v_mfma_f32_16x16x32_bf16 v[68:71], a[204:207], v[176:179], v[68:71]
    v_exp_f32 v212, v212
    v_mfma_f32_16x16x32_bf16 v[36:39], a[204:207], v[168:171], v[36:39]
    v_exp_f32 v213, v213
    v_mfma_f32_16x16x32_bf16 v[4:7], a[204:207], v[160:163], v[4:7]
    v_exp_f32 v214, v214
    v_mfma_f32_16x16x32_bf16 v[8:11], a[104:107], v[160:163], v[8:11]
    v_exp_f32 v215, v215
    v_mfma_f32_16x16x32_bf16 v[40:43], a[104:107], v[168:171], v[40:43]
    v_cvt_pk_bf16_f32 v188, v212, v213
    v_cvt_pk_bf16_f32 v189, v214, v215
    v_mfma_f32_16x16x32_bf16 v[72:75], a[104:107], v[176:179], v[72:75]
    ds_read_b64_tr_b16 a[104:105], v235 offset:32768
    v_mfma_f32_16x16x32_bf16 v[76:79], a[108:111], v[176:179], v[76:79]
    ds_read_b64_tr_b16 a[106:107], v235 offset:36864
    v_mfma_f32_16x16x32_bf16 v[44:47], a[108:111], v[168:171], v[44:47]
    v_mfma_f32_16x16x32_bf16 v[12:15], a[108:111], v[160:163], v[12:15]
    s_waitcnt lgkmcnt(3)
    v_mfma_f32_16x16x32_bf16 v[200:203], a[80:83], a[0:3], -4.0
    ds_read_b64_tr_b16 a[108:109], v235 offset:32776
    v_mfma_f32_16x16x32_bf16 v[200:203], a[84:87], a[4:7], v[200:203]
    ds_read_b64_tr_b16 a[110:111], v235 offset:36872
    v_mfma_f32_16x16x32_bf16 v[200:203], a[88:91], a[8:11], v[200:203]
    s_waitcnt lgkmcnt(4)
    global_load_lds_dwordx4 v230, s[52:53] offset:0 nt
    s_waitcnt vmcnt(8)
    ds_read_b128 v[216:219], v239 offset:16384
    v_mfma_f32_16x16x32_bf16 v[200:203], a[92:95], a[12:15], v[200:203]
    v_mfma_f32_16x16x32_bf16 v[204:207], a[92:95], a[28:31], -4.0
    v_mfma_f32_16x16x32_bf16 v[204:207], a[88:91], a[24:27], v[204:207]
    v_mfma_f32_16x16x32_bf16 v[204:207], a[84:87], a[20:23], v[204:207]
    v_mfma_f32_16x16x32_bf16 v[204:207], a[80:83], a[16:19], v[204:207]
    v_mfma_f32_16x16x32_bf16 v[208:211], a[80:83], a[32:35], -4.0
    s_waitcnt lgkmcnt(0)
    v_lshlrev_b32 v244, 16, v216
    v_and_b32 v245, 0xffff0000, v216
    v_lshlrev_b32 v246, 16, v217
    v_and_b32 v247, 0xffff0000, v217
    v_mul_f32 v244, s27, v244
    v_mul_f32 v245, s27, v245
    v_mul_f32 v246, s27, v246
    v_mul_f32 v247, s27, v247
    v_cvt_pk_bf16_f32 v216, v244, v245
    v_cvt_pk_bf16_f32 v217, v246, v247
    v_lshlrev_b32 v244, 16, v218
    v_and_b32 v245, 0xffff0000, v218
    v_lshlrev_b32 v246, 16, v219
    v_and_b32 v247, 0xffff0000, v219
    v_mul_f32 v244, s27, v244
    v_mul_f32 v245, s27, v245
    v_mul_f32 v246, s27, v246
    v_mul_f32 v247, s27, v247
    v_cvt_pk_bf16_f32 v218, v244, v245
    v_cvt_pk_bf16_f32 v219, v246, v247
    v_mfma_f32_16x16x32_bf16 v[208:211], a[84:87], a[36:39], v[208:211]
    v_exp_f32 v200, v200
    v_mfma_f32_16x16x32_bf16 v[208:211], a[88:91], a[40:43], v[208:211]
    v_exp_f32 v201, v201
    v_mfma_f32_16x16x32_bf16 v[208:211], a[92:95], a[44:47], v[208:211]
    v_exp_f32 v202, v202
    v_mfma_f32_16x16x32_bf16 v[212:215], a[92:95], a[60:63], -4.0
    v_exp_f32 v203, v203
    v_mfma_f32_16x16x32_bf16 v[212:215], a[88:91], a[56:59], v[212:215]
    s_waitcnt vmcnt(7)
    ds_read_b128 v[220:223], v239 offset:17408
    global_load_lds_dwordx4 v230, s[52:53] offset:1024 nt
    ds_write_b128 v239, v[216:219] offset:16384
    v_mfma_f32_16x16x32_bf16 v[212:215], a[84:87], a[52:55], v[212:215]
    s_add_u32 m0, s23, 57344
    s_add_u32 s52, s52, 8192
    s_addc_u32 s53, s53, 0
    v_mfma_f32_16x16x32_bf16 v[212:215], a[80:83], a[48:51], v[212:215]
    v_cvt_pk_bf16_f32 v166, v200, v201
    v_cvt_pk_bf16_f32 v167, v202, v203
    v_mfma_f32_16x16x32_bf16 v[16:19], a[96:99], v[160:163], v[16:19]
    v_exp_f32 v208, v208
    v_mfma_f32_16x16x32_bf16 v[48:51], a[96:99], v[168:171], v[48:51]
    s_waitcnt lgkmcnt(1)
    v_lshlrev_b32 v244, 16, v220
    v_and_b32 v245, 0xffff0000, v220
    v_lshlrev_b32 v246, 16, v221
    v_and_b32 v247, 0xffff0000, v221
    v_mul_f32 v244, s27, v244
    v_mul_f32 v245, s27, v245
    v_mul_f32 v246, s27, v246
    v_mul_f32 v247, s27, v247
    v_cvt_pk_bf16_f32 v220, v244, v245
    v_cvt_pk_bf16_f32 v221, v246, v247
    v_lshlrev_b32 v244, 16, v222
    v_and_b32 v245, 0xffff0000, v222
    v_lshlrev_b32 v246, 16, v223
    v_and_b32 v247, 0xffff0000, v223
    v_mul_f32 v244, s27, v244
    v_mul_f32 v245, s27, v245
    v_mul_f32 v246, s27, v246
    v_mul_f32 v247, s27, v247
    v_cvt_pk_bf16_f32 v222, v244, v245
    v_cvt_pk_bf16_f32 v223, v246, v247
    ds_write_b128 v239, v[220:223] offset:17408
    v_mfma_f32_16x16x32_bf16 v[80:83], a[96:99], v[176:179], v[80:83]
    v_exp_f32 v209, v209
    v_mfma_f32_16x16x32_bf16 v[84:87], a[100:103], v[176:179], v[84:87]
    v_exp_f32 v210, v210
    v_mfma_f32_16x16x32_bf16 v[52:55], a[100:103], v[168:171], v[52:55]
    v_exp_f32 v211, v211
    v_mfma_f32_16x16x32_bf16 v[20:23], a[100:103], v[160:163], v[20:23]
    v_cvt_pk_bf16_f32 v182, v208, v209
    v_cvt_pk_bf16_f32 v183, v210, v211
    v_mfma_f32_16x16x32_bf16 v[24:27], a[104:107], v[160:163], v[24:27]
    global_load_lds_dwordx4 v230, s[54:55] offset:0 nt
    v_mfma_f32_16x16x32_bf16 v[56:59], a[104:107], v[168:171], v[56:59]
    v_exp_f32 v204, v204
    v_mfma_f32_16x16x32_bf16 v[88:91], a[104:107], v[176:179], v[88:91]
    v_exp_f32 v205, v205
    v_mfma_f32_16x16x32_bf16 v[92:95], a[108:111], v[176:179], v[92:95]
    v_exp_f32 v206, v206
    v_mfma_f32_16x16x32_bf16 v[60:63], a[108:111], v[168:171], v[60:63]
    v_exp_f32 v207, v207
    v_mfma_f32_16x16x32_bf16 v[28:31], a[108:111], v[160:163], v[28:31]
    v_cvt_pk_bf16_f32 v174, v204, v205
    v_cvt_pk_bf16_f32 v175, v206, v207
    v_smfmac_f32_16x16x64_bf16 a[112:115], a[132:135], v[160:167], v238
    v_smfmac_f32_16x16x64_bf16 a[120:123], a[132:135], v[176:183], v238
    v_exp_f32 v212, v212
    v_exp_f32 v213, v213
    v_exp_f32 v214, v214
    v_exp_f32 v215, v215
    v_cvt_pk_bf16_f32 v190, v212, v213
    v_cvt_pk_bf16_f32 v191, v214, v215
    s_waitcnt vmcnt(7) lgkmcnt(0)
    s_barrier
    ds_read_b128 a[80:83], v229 offset:16384
    ds_read_b128 a[84:87], v229 offset:16640
    ds_read_b128 a[88:91], v229 offset:16896
    ds_read_b128 a[92:95], v229 offset:17152
    ds_read_b64_tr_b16 a[208:209], v232 offset:40960
    ds_read_b64_tr_b16 a[210:211], v232 offset:45056
    global_load_lds_dwordx4 v230, s[54:55] offset:1024 nt
    s_add_u32 s54, s54, 8192
    s_addc_u32 s55, s55, 0
    s_add_u32 m0, s21, 106496
    ds_read_b64_tr_b16 a[212:213], v232 offset:40968
    ds_read_b64_tr_b16 a[214:215], v232 offset:45064
    s_waitcnt lgkmcnt(7)
    v_mfma_f32_16x16x32_bf16 v[200:203], a[80:83], a[0:3], -4.0
    ds_read_b64_tr_b16 a[104:105], v233 offset:40960
    s_waitcnt lgkmcnt(7)
    v_mfma_f32_16x16x32_bf16 v[200:203], a[84:87], a[4:7], v[200:203]
    s_waitcnt lgkmcnt(6)
    v_mfma_f32_16x16x32_bf16 v[200:203], a[88:91], a[8:11], v[200:203]
    s_waitcnt lgkmcnt(5)
    v_mfma_f32_16x16x32_bf16 v[200:203], a[92:95], a[12:15], v[200:203]
    ds_read_b64_tr_b16 a[106:107], v233 offset:45056
    s_waitcnt lgkmcnt(4)
    v_mfma_f32_16x16x32_bf16 v[0:3], a[208:211], v[164:167], v[0:3]
    ds_read_b64_tr_b16 a[108:109], v233 offset:40968
    v_mfma_f32_16x16x32_bf16 v[204:207], a[80:83], a[16:19], -4.0
    ds_read_b64_tr_b16 a[110:111], v233 offset:45064
    v_mfma_f32_16x16x32_bf16 v[204:207], a[84:87], a[20:23], v[204:207]
    ds_read_b64_tr_b16 a[96:97], v234 offset:40960
    v_mfma_f32_16x16x32_bf16 v[204:207], a[88:91], a[24:27], v[204:207]
    ds_read_b64_tr_b16 a[98:99], v234 offset:45056
    v_mfma_f32_16x16x32_bf16 v[204:207], a[92:95], a[28:31], v[204:207]
    v_exp_f32 v200, v200
    v_mfma_f32_16x16x32_bf16 v[32:35], a[208:211], v[172:175], v[32:35]
    global_load_dwordx4 a[64:67], v237, s[4:5] offset:0 nt
    v_mfma_f32_16x16x32_bf16 v[208:211], a[80:83], a[32:35], -4.0
    v_exp_f32 v201, v201
    v_mfma_f32_16x16x32_bf16 v[208:211], a[84:87], a[36:39], v[208:211]
    v_exp_f32 v202, v202
    v_mfma_f32_16x16x32_bf16 v[208:211], a[88:91], a[40:43], v[208:211]
    v_exp_f32 v203, v203
    v_mfma_f32_16x16x32_bf16 v[208:211], a[92:95], a[44:47], v[208:211]
    s_waitcnt vmcnt(8)
    v_cvt_pk_bf16_f32 v160, v200, v201
    v_cvt_pk_bf16_f32 v161, v202, v203
    v_mfma_f32_16x16x32_bf16 v[64:67], a[208:211], v[180:183], v[64:67]
    ds_read_b128 v[216:219], v239 offset:24576
    v_mfma_f32_16x16x32_bf16 v[96:99], a[208:211], v[188:191], 0
    v_exp_f32 v204, v204
    v_mfma_f32_16x16x32_bf16 v[212:215], a[80:83], a[48:51], -4.0
    ds_read_b128 a[80:83], v229 offset:20480
    v_mfma_f32_16x16x32_bf16 v[212:215], a[84:87], a[52:55], v[212:215]
    ds_read_b128 a[84:87], v229 offset:20736
    v_mfma_f32_16x16x32_bf16 v[212:215], a[88:91], a[56:59], v[212:215]
    ds_read_b128 a[88:91], v229 offset:20992
    v_mfma_f32_16x16x32_bf16 v[212:215], a[92:95], a[60:63], v[212:215]
    s_waitcnt lgkmcnt(4)
    v_exp_f32 v205, v205
    v_mfma_f32_16x16x32_bf16 v[100:103], a[212:215], v[188:191], 0
    ds_read_b128 a[92:95], v229 offset:21248
    v_cvt_pk_bf16_f32 v168, v204, v205
    v_mfma_f32_16x16x32_bf16 v[68:71], a[212:215], v[180:183], v[68:71]
    v_exp_f32 v206, v206
    v_mfma_f32_16x16x32_bf16 v[36:39], a[212:215], v[172:175], v[36:39]
    v_exp_f32 v207, v207
    v_mfma_f32_16x16x32_bf16 v[4:7], a[212:215], v[164:167], v[4:7]
    ds_read_b64_tr_b16 a[100:101], v234 offset:40968
    v_cvt_pk_bf16_f32 v169, v206, v207
    v_mfma_f32_16x16x32_bf16 v[8:11], a[104:107], v[164:167], v[8:11]
    s_waitcnt lgkmcnt(5)
    v_lshlrev_b32 v244, 16, v216
    v_and_b32 v245, 0xffff0000, v216
    v_mfma_f32_16x16x32_bf16 v[40:43], a[104:107], v[172:175], v[40:43]
    ds_read_b64_tr_b16 a[102:103], v234 offset:45064
    v_lshlrev_b32 v246, 16, v217
    v_mfma_f32_16x16x32_bf16 v[72:75], a[104:107], v[180:183], v[72:75]
    v_and_b32 v247, 0xffff0000, v217
    v_mul_f32 v244, s27, v244
    v_mfma_f32_16x16x32_bf16 v[104:107], a[104:107], v[188:191], 0
    global_load_dwordx4 a[68:71], v237, s[4:5] offset:64 nt
    v_mfma_f32_16x16x32_bf16 v[108:111], a[108:111], v[188:191], 0
    s_waitcnt vmcnt(8)
    v_exp_f32 v208, v208
    v_mfma_f32_16x16x32_bf16 v[76:79], a[108:111], v[180:183], v[76:79]
    ds_read_b128 v[220:223], v239 offset:25600
    v_mul_f32 v245, s27, v245
    v_mfma_f32_16x16x32_bf16 v[44:47], a[108:111], v[172:175], v[44:47]
    v_exp_f32 v209, v209
    v_mfma_f32_16x16x32_bf16 v[12:15], a[108:111], v[164:167], v[12:15]
    s_waitcnt lgkmcnt(2)
    v_exp_f32 v210, v210
    v_mfma_f32_16x16x32_bf16 v[200:203], a[80:83], a[0:3], -4.0
    v_exp_f32 v211, v211
    v_mfma_f32_16x16x32_bf16 v[200:203], a[84:87], a[4:7], v[200:203]
    ds_read_b64_tr_b16 a[104:105], v235 offset:40960
    v_mul_f32 v246, s27, v246
    v_mfma_f32_16x16x32_bf16 v[200:203], a[88:91], a[8:11], v[200:203]
    ds_read_b64_tr_b16 a[106:107], v235 offset:45056
    v_mul_f32 v247, s27, v247
    v_mfma_f32_16x16x32_bf16 v[200:203], a[92:95], a[12:15], v[200:203]
    ds_read_b64_tr_b16 a[108:109], v235 offset:40968
    v_cvt_pk_bf16_f32 v216, v244, v245
    v_mfma_f32_16x16x32_bf16 v[16:19], a[96:99], v[164:167], v[16:19]
    ds_read_b64_tr_b16 a[110:111], v235 offset:45064
    v_cvt_pk_bf16_f32 v217, v246, v247
    v_mfma_f32_16x16x32_bf16 v[204:207], a[80:83], a[16:19], -4.0
    v_cvt_pk_bf16_f32 v176, v208, v209
    v_cvt_pk_bf16_f32 v177, v210, v211
    v_mfma_f32_16x16x32_bf16 v[204:207], a[84:87], a[20:23], v[204:207]
    v_lshlrev_b32 v244, 16, v218
    v_and_b32 v245, 0xffff0000, v218
    v_mfma_f32_16x16x32_bf16 v[204:207], a[88:91], a[24:27], v[204:207]
    v_lshlrev_b32 v246, 16, v219
    v_and_b32 v247, 0xffff0000, v219
    v_mfma_f32_16x16x32_bf16 v[204:207], a[92:95], a[28:31], v[204:207]
    v_mul_f32 v244, s27, v244
    v_mul_f32 v245, s27, v245
    v_mfma_f32_16x16x32_bf16 v[48:51], a[96:99], v[172:175], v[48:51]
    v_mul_f32 v246, s27, v246
    v_mul_f32 v247, s27, v247
    v_mfma_f32_16x16x32_bf16 v[208:211], a[80:83], a[32:35], -4.0
    v_cvt_pk_bf16_f32 v218, v244, v245
    v_cvt_pk_bf16_f32 v219, v246, v247
    v_mfma_f32_16x16x32_bf16 v[208:211], a[84:87], a[36:39], v[208:211]
    s_waitcnt lgkmcnt(3)
    v_lshlrev_b32 v244, 16, v220
    v_and_b32 v245, 0xffff0000, v220
    v_lshlrev_b32 v246, 16, v221
    v_and_b32 v247, 0xffff0000, v221
    v_mul_f32 v244, s27, v244
    v_mul_f32 v245, s27, v245
    v_mul_f32 v246, s27, v246
    v_mul_f32 v247, s27, v247
    global_load_dwordx4 a[72:75], v237, s[4:5] offset:128 nt
    v_mfma_f32_16x16x32_bf16 v[208:211], a[88:91], a[40:43], v[208:211]
    v_cvt_pk_bf16_f32 v220, v244, v245
    v_cvt_pk_bf16_f32 v221, v246, v247
    v_lshlrev_b32 v244, 16, v222
    v_and_b32 v245, 0xffff0000, v222
    v_lshlrev_b32 v246, 16, v223
    v_and_b32 v247, 0xffff0000, v223
    v_mfma_f32_16x16x32_bf16 v[208:211], a[92:95], a[44:47], v[208:211]
    v_mul_f32 v244, s27, v244
    v_mul_f32 v245, s27, v245
    v_mul_f32 v246, s27, v246
    v_mul_f32 v247, s27, v247
    v_cvt_pk_bf16_f32 v222, v244, v245
    v_cvt_pk_bf16_f32 v223, v246, v247
    v_mfma_f32_16x16x32_bf16 v[80:83], a[96:99], v[180:183], v[80:83]
    ds_write_b128 v239, v[216:219] offset:24576
    v_exp_f32 v212, v212
    v_exp_f32 v213, v213
    v_exp_f32 v214, v214
    v_exp_f32 v215, v215
    v_mfma_f32_16x16x32_bf16 v[112:115], a[96:99], v[188:191], 0
    ds_write_b128 v239, v[220:223] offset:25600
    v_cvt_pk_bf16_f32 v184, v212, v213
    v_cvt_pk_bf16_f32 v185, v214, v215
    v_mfma_f32_16x16x32_bf16 v[212:215], a[80:83], a[48:51], -4.0
    v_exp_f32 v204, v204
    v_mfma_f32_16x16x32_bf16 v[212:215], a[84:87], a[52:55], v[212:215]
    v_exp_f32 v205, v205
    v_mfma_f32_16x16x32_bf16 v[212:215], a[88:91], a[56:59], v[212:215]
    v_exp_f32 v206, v206
    v_mfma_f32_16x16x32_bf16 v[212:215], a[92:95], a[60:63], v[212:215]
    v_exp_f32 v207, v207
    v_mfma_f32_16x16x32_bf16 v[116:119], a[100:103], v[188:191], 0
    v_cvt_pk_bf16_f32 v170, v204, v205
    v_cvt_pk_bf16_f32 v171, v206, v207
    v_mfma_f32_16x16x32_bf16 v[84:87], a[100:103], v[180:183], v[84:87]
    v_exp_f32 v200, v200
    v_mfma_f32_16x16x32_bf16 v[52:55], a[100:103], v[172:175], v[52:55]
    v_exp_f32 v201, v201
    v_mfma_f32_16x16x32_bf16 v[20:23], a[100:103], v[164:167], v[20:23]
    s_waitcnt lgkmcnt(0)
    global_load_dwordx4 a[76:79], v237, s[4:5] offset:192 nt
    v_mfma_f32_16x16x32_bf16 v[24:27], a[104:107], v[164:167], v[24:27]
    s_waitcnt vmcnt(8)
    v_exp_f32 v202, v202
    v_mfma_f32_16x16x32_bf16 v[56:59], a[104:107], v[172:175], v[56:59]
    s_barrier
    ds_read_b128 a[80:83], v229 offset:24576
    v_mfma_f32_16x16x32_bf16 v[88:91], a[104:107], v[180:183], v[88:91]
    ds_read_b128 a[84:87], v229 offset:24832
    v_cvt_pk_bf16_f32 v162, v200, v201
    v_mfma_f32_16x16x32_bf16 v[120:123], a[104:107], v[188:191], 0
    ds_read_b128 a[88:91], v229 offset:25088
    v_mfma_f32_16x16x32_bf16 v[124:127], a[108:111], v[188:191], 0
    ds_read_b128 a[92:95], v229 offset:25344
    v_mfma_f32_16x16x32_bf16 v[92:95], a[108:111], v[180:183], v[92:95]
    ds_read_b64_tr_b16 a[216:217], v232 offset:49152
    ds_read_b64_tr_b16 a[218:219], v232 offset:53248
    v_mfma_f32_16x16x32_bf16 v[60:63], a[108:111], v[172:175], v[60:63]
    v_exp_f32 v203, v203
    v_mfma_f32_16x16x32_bf16 v[28:31], a[108:111], v[164:167], v[28:31]
    ds_read_b64_tr_b16 a[220:221], v232 offset:49160
    v_cvt_pk_bf16_f32 v163, v202, v203
    v_smfmac_f32_16x16x64_bf16 a[116:119], a[132:135], v[168:175], v238
    ds_read_b64_tr_b16 a[222:223], v232 offset:53256
    s_waitcnt lgkmcnt(7)
    v_mfma_f32_16x16x32_bf16 v[200:203], a[80:83], a[0:3], -4.0
    ds_read_b64_tr_b16 a[104:105], v233 offset:49152
    s_waitcnt lgkmcnt(7)
    v_mfma_f32_16x16x32_bf16 v[200:203], a[84:87], a[4:7], v[200:203]
    ds_read_b64_tr_b16 a[106:107], v233 offset:53248
    s_waitcnt lgkmcnt(7)
    v_mfma_f32_16x16x32_bf16 v[200:203], a[88:91], a[8:11], v[200:203]
    v_exp_f32 v212, v212
    v_exp_f32 v213, v213
    v_exp_f32 v214, v214
    v_exp_f32 v215, v215
    s_waitcnt lgkmcnt(6)
    v_mfma_f32_16x16x32_bf16 v[200:203], a[92:95], a[12:15], v[200:203]
    s_waitcnt lgkmcnt(4)
    v_cvt_pk_bf16_f32 v186, v212, v213
    v_cvt_pk_bf16_f32 v187, v214, v215
    v_mfma_f32_16x16x32_bf16 v[0:3], a[216:219], v[160:163], v[0:3]
    v_exp_f32 v208, v208
    v_smfmac_f32_16x16x64_bf16 a[124:127], a[132:135], v[184:191], v238
    global_load_lds_dwordx4 v230, s[52:53] offset:0 nt
    v_mfma_f32_16x16x32_bf16 v[204:207], a[80:83], a[16:19], -4.0
    v_exp_f32 v209, v209
    v_mfma_f32_16x16x32_bf16 v[204:207], a[84:87], a[20:23], v[204:207]
    v_exp_f32 v210, v210
    v_mfma_f32_16x16x32_bf16 v[204:207], a[88:91], a[24:27], v[204:207]
    v_exp_f32 v211, v211
    v_mfma_f32_16x16x32_bf16 v[204:207], a[92:95], a[28:31], v[204:207]
    ds_read_b64_tr_b16 a[108:109], v233 offset:49160
    v_cvt_pk_bf16_f32 v178, v208, v209
    v_mfma_f32_16x16x32_bf16 v[32:35], a[216:219], v[168:171], v[32:35]
    ds_read_b64_tr_b16 a[110:111], v233 offset:53256
    v_cvt_pk_bf16_f32 v179, v210, v211
    v_mfma_f32_16x16x32_bf16 v[208:211], a[80:83], a[32:35], -4.0
    ds_read_b64_tr_b16 a[96:97], v234 offset:49152
    v_mfma_f32_16x16x32_bf16 v[208:211], a[84:87], a[36:39], v[208:211]
    ds_read_b64_tr_b16 a[98:99], v234 offset:53248
    v_mfma_f32_16x16x32_bf16 v[208:211], a[88:91], a[40:43], v[208:211]
    v_exp_f32 v200, v200
    v_mfma_f32_16x16x32_bf16 v[208:211], a[92:95], a[44:47], v[208:211]
    v_exp_f32 v201, v201
    v_mfma_f32_16x16x32_bf16 v[64:67], a[216:219], v[176:179], v[64:67]
    v_exp_f32 v202, v202
    v_mfma_f32_16x16x32_bf16 v[96:99], a[216:219], v[184:187], v[96:99]
    v_exp_f32 v203, v203
    v_mfma_f32_16x16x32_bf16 v[212:215], a[80:83], a[48:51], -4.0
    ds_read_b128 a[80:83], v229 offset:28672
    v_cvt_pk_bf16_f32 v164, v200, v201
    v_mfma_f32_16x16x32_bf16 v[212:215], a[84:87], a[52:55], v[212:215]
    ds_read_b128 a[84:87], v229 offset:28928
    v_cvt_pk_bf16_f32 v165, v202, v203
    v_mfma_f32_16x16x32_bf16 v[212:215], a[88:91], a[56:59], v[212:215]
    ds_read_b128 a[88:91], v229 offset:29184
    v_mfma_f32_16x16x32_bf16 v[212:215], a[92:95], a[60:63], v[212:215]
    s_waitcnt lgkmcnt(5)
    v_exp_f32 v204, v204
    v_mfma_f32_16x16x32_bf16 v[100:103], a[220:223], v[184:187], v[100:103]
    ds_read_b128 a[92:95], v229 offset:29440
    v_mfma_f32_16x16x32_bf16 v[68:71], a[220:223], v[176:179], v[68:71]
    s_waitcnt vmcnt(8)
    v_exp_f32 v205, v205
    v_mfma_f32_16x16x32_bf16 v[36:39], a[220:223], v[168:171], v[36:39]
    global_load_lds_dwordx4 v230, s[52:53] offset:1024 nt
    v_mfma_f32_16x16x32_bf16 v[4:7], a[220:223], v[160:163], v[4:7]
    s_add_u32 m0, s23, 32768
    s_add_u32 s52, s52, 8192
    s_addc_u32 s53, s53, 0
    v_mfma_f32_16x16x32_bf16 v[8:11], a[104:107], v[160:163], v[8:11]
    ds_read_b128 v[216:219], v239 offset:32768
    v_cvt_pk_bf16_f32 v172, v204, v205
    v_mfma_f32_16x16x32_bf16 v[40:43], a[104:107], v[168:171], v[40:43]
    s_waitcnt vmcnt(8)
    v_exp_f32 v206, v206
    v_mfma_f32_16x16x32_bf16 v[72:75], a[104:107], v[176:179], v[72:75]
    ds_read_b128 v[220:223], v239 offset:33792
    v_mfma_f32_16x16x32_bf16 v[104:107], a[104:107], v[184:187], v[104:107]
    v_exp_f32 v207, v207
    v_mfma_f32_16x16x32_bf16 v[108:111], a[108:111], v[184:187], v[108:111]
    ds_read_b64_tr_b16 a[100:101], v234 offset:49160
    v_cvt_pk_bf16_f32 v173, v206, v207
    v_mfma_f32_16x16x32_bf16 v[76:79], a[108:111], v[176:179], v[76:79]
    v_exp_f32 v208, v208
    v_mfma_f32_16x16x32_bf16 v[44:47], a[108:111], v[168:171], v[44:47]
    v_exp_f32 v209, v209
    v_mfma_f32_16x16x32_bf16 v[12:15], a[108:111], v[160:163], v[12:15]
    s_waitcnt lgkmcnt(3)
    v_exp_f32 v210, v210
    v_mfma_f32_16x16x32_bf16 v[200:203], a[80:83], a[0:3], -4.0
    v_exp_f32 v211, v211
    v_mfma_f32_16x16x32_bf16 v[200:203], a[84:87], a[4:7], v[200:203]
    s_waitcnt lgkmcnt(2)
    v_lshlrev_b32 v244, 16, v216
    v_and_b32 v245, 0xffff0000, v216
    v_mfma_f32_16x16x32_bf16 v[200:203], a[88:91], a[8:11], v[200:203]
    ds_read_b64_tr_b16 a[102:103], v234 offset:53256
    v_lshlrev_b32 v246, 16, v217
    v_mfma_f32_16x16x32_bf16 v[200:203], a[92:95], a[12:15], v[200:203]
    ds_read_b64_tr_b16 a[104:105], v235 offset:49152
    v_and_b32 v247, 0xffff0000, v217
    v_mfma_f32_16x16x32_bf16 v[16:19], a[96:99], v[160:163], v[16:19]
    ds_read_b64_tr_b16 a[106:107], v235 offset:53248
    v_cvt_pk_bf16_f32 v180, v208, v209
    v_mfma_f32_16x16x32_bf16 v[204:207], a[80:83], a[16:19], -4.0
    ds_read_b64_tr_b16 a[108:109], v235 offset:49160
    v_cvt_pk_bf16_f32 v181, v210, v211
    v_mfma_f32_16x16x32_bf16 v[204:207], a[84:87], a[20:23], v[204:207]
    ds_read_b64_tr_b16 a[110:111], v235 offset:53256
    v_mul_f32 v244, s27, v244
    v_mfma_f32_16x16x32_bf16 v[204:207], a[88:91], a[24:27], v[204:207]
    v_mul_f32 v245, s27, v245
    v_mul_f32 v246, s27, v246
    v_mfma_f32_16x16x32_bf16 v[204:207], a[92:95], a[28:31], v[204:207]
    global_load_lds_dwordx4 v230, s[54:55] offset:0 nt
    v_mfma_f32_16x16x32_bf16 v[48:51], a[96:99], v[168:171], v[48:51]
    v_mul_f32 v247, s27, v247
    v_cvt_pk_bf16_f32 v216, v244, v245
    v_mfma_f32_16x16x32_bf16 v[208:211], a[80:83], a[32:35], -4.0
    v_cvt_pk_bf16_f32 v217, v246, v247
    v_lshlrev_b32 v244, 16, v218
    v_and_b32 v245, 0xffff0000, v218
    v_lshlrev_b32 v246, 16, v219
    v_and_b32 v247, 0xffff0000, v219
    v_mfma_f32_16x16x32_bf16 v[208:211], a[84:87], a[36:39], v[208:211]
    v_mul_f32 v244, s27, v244
    v_mul_f32 v245, s27, v245
    v_mul_f32 v246, s27, v246
    v_mul_f32 v247, s27, v247
    v_cvt_pk_bf16_f32 v218, v244, v245
    v_cvt_pk_bf16_f32 v219, v246, v247
    v_mfma_f32_16x16x32_bf16 v[208:211], a[88:91], a[40:43], v[208:211]
    s_waitcnt lgkmcnt(0)
    v_lshlrev_b32 v244, 16, v220
    v_and_b32 v245, 0xffff0000, v220
    v_lshlrev_b32 v246, 16, v221
    v_and_b32 v247, 0xffff0000, v221
    v_mul_f32 v244, s27, v244
    v_mul_f32 v245, s27, v245
    v_mul_f32 v246, s27, v246
    v_mul_f32 v247, s27, v247
    v_mfma_f32_16x16x32_bf16 v[208:211], a[92:95], a[44:47], v[208:211]
    v_cvt_pk_bf16_f32 v220, v244, v245
    v_cvt_pk_bf16_f32 v221, v246, v247
    v_lshlrev_b32 v244, 16, v222
    v_and_b32 v245, 0xffff0000, v222
    v_lshlrev_b32 v246, 16, v223
    v_and_b32 v247, 0xffff0000, v223
    v_mfma_f32_16x16x32_bf16 v[80:83], a[96:99], v[176:179], v[80:83]
    v_mul_f32 v244, s27, v244
    v_mul_f32 v245, s27, v245
    v_mul_f32 v246, s27, v246
    v_mul_f32 v247, s27, v247
    v_exp_f32 v212, v212
    v_exp_f32 v213, v213
    v_exp_f32 v214, v214
    v_exp_f32 v215, v215
    v_cvt_pk_bf16_f32 v222, v244, v245
    v_cvt_pk_bf16_f32 v223, v246, v247
    v_mfma_f32_16x16x32_bf16 v[112:115], a[96:99], v[184:187], v[112:115]
    ds_write_b128 v239, v[216:219] offset:32768
    v_cvt_pk_bf16_f32 v188, v212, v213
    v_cvt_pk_bf16_f32 v189, v214, v215
    v_mfma_f32_16x16x32_bf16 v[212:215], a[80:83], a[48:51], -4.0
    v_exp_f32 v200, v200
    v_mfma_f32_16x16x32_bf16 v[212:215], a[84:87], a[52:55], v[212:215]
    global_load_lds_dwordx4 v230, s[54:55] offset:1024 nt
    ds_write_b128 v239, v[220:223] offset:33792
    v_mfma_f32_16x16x32_bf16 v[212:215], a[88:91], a[56:59], v[212:215]
    s_add_u32 s54, s54, 8192
    s_addc_u32 s55, s55, 0
    s_add_u32 m0, s21, 114688
    v_mfma_f32_16x16x32_bf16 v[212:215], a[92:95], a[60:63], v[212:215]
    v_exp_f32 v201, v201
    v_mfma_f32_16x16x32_bf16 v[116:119], a[100:103], v[184:187], v[116:119]
    v_exp_f32 v202, v202
    v_mfma_f32_16x16x32_bf16 v[84:87], a[100:103], v[176:179], v[84:87]
    v_exp_f32 v203, v203
    v_mfma_f32_16x16x32_bf16 v[52:55], a[100:103], v[168:171], v[52:55]
    v_cvt_pk_bf16_f32 v166, v200, v201
    v_cvt_pk_bf16_f32 v167, v202, v203
    v_mfma_f32_16x16x32_bf16 v[20:23], a[100:103], v[160:163], v[20:23]
    v_exp_f32 v208, v208
    v_mfma_f32_16x16x32_bf16 v[24:27], a[104:107], v[160:163], v[24:27]
    v_exp_f32 v209, v209
    v_mfma_f32_16x16x32_bf16 v[56:59], a[104:107], v[168:171], v[56:59]
    s_waitcnt vmcnt(8) lgkmcnt(0)
    v_exp_f32 v210, v210
    v_mfma_f32_16x16x32_bf16 v[88:91], a[104:107], v[176:179], v[88:91]
    s_barrier
    ds_read_b128 a[80:83], v229 offset:32768
    v_mfma_f32_16x16x32_bf16 v[120:123], a[104:107], v[184:187], v[120:123]
    ds_read_b128 a[84:87], v229 offset:33024
    v_cvt_pk_bf16_f32 v182, v208, v209
    v_mfma_f32_16x16x32_bf16 v[124:127], a[108:111], v[184:187], v[124:127]
    ds_read_b128 a[88:91], v229 offset:33280
    v_mfma_f32_16x16x32_bf16 v[92:95], a[108:111], v[176:179], v[92:95]
    ds_read_b128 a[92:95], v229 offset:33536
    v_mfma_f32_16x16x32_bf16 v[60:63], a[108:111], v[168:171], v[60:63]
    ds_read_b64_tr_b16 a[224:225], v232 offset:57344
    ds_read_b64_tr_b16 a[226:227], v232 offset:61440
    v_exp_f32 v211, v211
    v_mfma_f32_16x16x32_bf16 v[28:31], a[108:111], v[160:163], v[28:31]
    ds_read_b64_tr_b16 a[228:229], v232 offset:57352
    v_cvt_pk_bf16_f32 v183, v210, v211
    v_smfmac_f32_16x16x64_bf16 a[112:115], a[132:135], v[160:167], v238
    global_load_lds_dwordx4 v230, s[52:53] offset:0 nt
    v_smfmac_f32_16x16x64_bf16 a[120:123], a[132:135], v[176:183], v238
    s_waitcnt lgkmcnt(6)
    v_mfma_f32_16x16x32_bf16 v[200:203], a[80:83], a[0:3], -4.0
    s_waitcnt lgkmcnt(5)
    v_exp_f32 v204, v204
    v_mfma_f32_16x16x32_bf16 v[200:203], a[84:87], a[4:7], v[200:203]
    s_waitcnt lgkmcnt(4)
    v_exp_f32 v205, v205
    v_mfma_f32_16x16x32_bf16 v[200:203], a[88:91], a[8:11], v[200:203]
    s_waitcnt lgkmcnt(3)
    v_exp_f32 v206, v206
    v_mfma_f32_16x16x32_bf16 v[200:203], a[92:95], a[12:15], v[200:203]
    s_waitcnt lgkmcnt(1)
    v_exp_f32 v207, v207
    v_mfma_f32_16x16x32_bf16 v[0:3], a[224:227], v[164:167], v[0:3]
    ds_read_b64_tr_b16 a[230:231], v232 offset:61448
    v_cvt_pk_bf16_f32 v174, v204, v205
    v_cvt_pk_bf16_f32 v175, v206, v207
    v_mfma_f32_16x16x32_bf16 v[204:207], a[80:83], a[16:19], -4.0
    v_exp_f32 v212, v212
    v_mfma_f32_16x16x32_bf16 v[204:207], a[84:87], a[20:23], v[204:207]
    v_exp_f32 v213, v213
    v_mfma_f32_16x16x32_bf16 v[204:207], a[88:91], a[24:27], v[204:207]
    v_exp_f32 v214, v214
    v_mfma_f32_16x16x32_bf16 v[204:207], a[92:95], a[28:31], v[204:207]
    v_exp_f32 v215, v215
    v_mfma_f32_16x16x32_bf16 v[32:35], a[224:227], v[172:175], v[32:35]
    ds_read_b64_tr_b16 a[104:105], v233 offset:57344
    v_cvt_pk_bf16_f32 v190, v212, v213
    v_mfma_f32_16x16x32_bf16 v[208:211], a[80:83], a[32:35], -4.0
    ds_read_b64_tr_b16 a[106:107], v233 offset:61440
    v_cvt_pk_bf16_f32 v191, v214, v215
    v_mfma_f32_16x16x32_bf16 v[208:211], a[84:87], a[36:39], v[208:211]
    v_exp_f32 v200, v200
    v_mfma_f32_16x16x32_bf16 v[208:211], a[88:91], a[40:43], v[208:211]
    v_exp_f32 v201, v201
    v_mfma_f32_16x16x32_bf16 v[208:211], a[92:95], a[44:47], v[208:211]
    v_exp_f32 v202, v202
    v_mfma_f32_16x16x32_bf16 v[64:67], a[224:227], v[180:183], v[64:67]
    v_exp_f32 v203, v203
    v_mfma_f32_16x16x32_bf16 v[212:215], a[80:83], a[48:51], -4.0
    ds_read_b64_tr_b16 a[108:109], v233 offset:57352
    v_cvt_pk_bf16_f32 v160, v200, v201
    v_mfma_f32_16x16x32_bf16 v[212:215], a[84:87], a[52:55], v[212:215]
    global_load_lds_dwordx4 v230, s[52:53] offset:1024 nt
    v_mfma_f32_16x16x32_bf16 v[212:215], a[88:91], a[56:59], v[212:215]
    s_add_u32 m0, s23, 40960
    v_cvt_pk_bf16_f32 v161, v202, v203
    v_mfma_f32_16x16x32_bf16 v[212:215], a[92:95], a[60:63], v[212:215]
    s_add_u32 s52, s52, 8192
    s_addc_u32 s53, s53, 0
    v_mfma_f32_16x16x32_bf16 v[96:99], a[224:227], v[188:191], v[96:99]
    s_waitcnt vmcnt(9)
    v_exp_f32 v204, v204
    v_mfma_f32_16x16x32_bf16 v[200:203], a[80:83], a[64:67], -4.0
    s_waitcnt vmcnt(8)
    v_exp_f32 v205, v205
    v_mfma_f32_16x16x32_bf16 v[200:203], a[84:87], a[68:71], v[200:203]
    ds_read_b64_tr_b16 a[110:111], v233 offset:61448
    ds_read_b128 a[80:83], v229 offset:36864
    ds_read_b128 a[84:87], v229 offset:37120
    ds_read_b64_tr_b16 a[96:97], v234 offset:57344
    ds_read_b64_tr_b16 a[98:99], v234 offset:61440
    v_exp_f32 v206, v206
    v_exp_f32 v207, v207
    v_cvt_pk_bf16_f32 v168, v204, v205
    v_cvt_pk_bf16_f32 v169, v206, v207
    v_exp_f32 v208, v208
    v_exp_f32 v209, v209
    v_exp_f32 v210, v210
    v_exp_f32 v211, v211
    v_cvt_pk_bf16_f32 v176, v208, v209
    v_cvt_pk_bf16_f32 v177, v210, v211
    v_exp_f32 v212, v212
    v_exp_f32 v213, v213
    v_exp_f32 v214, v214
    v_exp_f32 v215, v215
    v_cvt_pk_bf16_f32 v184, v212, v213
    v_cvt_pk_bf16_f32 v185, v214, v215
    ds_read_b64_tr_b16 a[100:101], v234 offset:57352
    ds_read_b64_tr_b16 a[102:103], v234 offset:61448
    s_waitcnt vmcnt(7)
    v_mfma_f32_16x16x32_bf16 v[200:203], a[88:91], a[72:75], v[200:203]
    global_load_lds_dwordx4 v230, s[54:55] offset:0 nt
    ds_read_b128 a[88:91], v229 offset:37376
    s_waitcnt vmcnt(7)
    v_mfma_f32_16x16x32_bf16 v[200:203], a[92:95], a[76:79], v[200:203]
    s_waitcnt lgkmcnt(0)
    v_mfma_f32_16x16x32_bf16 v[100:103], a[228:231], v[188:191], v[100:103]
    global_load_lds_dwordx4 v230, s[54:55] offset:1024 nt
    v_mfma_f32_16x16x32_bf16 v[68:71], a[228:231], v[180:183], v[68:71]
    s_add_u32 s54, s54, 8192
    s_addc_u32 s55, s55, 0
    s_add_u32 m0, s21, 122880
    v_mfma_f32_16x16x32_bf16 v[36:39], a[228:231], v[172:175], v[36:39]
    ds_read_b128 a[92:95], v229 offset:37632
    v_mfma_f32_16x16x32_bf16 v[4:7], a[228:231], v[164:167], v[4:7]
    v_exp_f32 v200, v200
    v_mfma_f32_16x16x32_bf16 v[8:11], a[104:107], v[164:167], v[8:11]
    v_exp_f32 v201, v201
    v_mfma_f32_16x16x32_bf16 v[40:43], a[104:107], v[172:175], v[40:43]
    v_exp_f32 v202, v202
    v_mfma_f32_16x16x32_bf16 v[72:75], a[104:107], v[180:183], v[72:75]
    v_exp_f32 v203, v203
    v_mfma_f32_16x16x32_bf16 v[104:107], a[104:107], v[188:191], v[104:107]
    ds_read_b64_tr_b16 a[104:105], v235 offset:57344
    v_cvt_pk_bf16_f32 v192, v200, v201
    v_mfma_f32_16x16x32_bf16 v[108:111], a[108:111], v[188:191], v[108:111]
    ds_read_b64_tr_b16 a[106:107], v235 offset:61440
    v_cvt_pk_bf16_f32 v193, v202, v203
    v_mfma_f32_16x16x32_bf16 v[76:79], a[108:111], v[180:183], v[76:79]
    v_mfma_f32_16x16x32_bf16 v[44:47], a[108:111], v[172:175], v[44:47]
    v_mfma_f32_16x16x32_bf16 v[12:15], a[108:111], v[164:167], v[12:15]
    ds_read_b64_tr_b16 a[108:109], v235 offset:57352
    v_mfma_f32_16x16x32_bf16 v[204:207], a[80:83], a[0:3], -4.0
    ds_read_b64_tr_b16 a[110:111], v235 offset:61448
    v_mfma_f32_16x16x32_bf16 v[204:207], a[84:87], a[4:7], v[204:207]
    v_mfma_f32_16x16x32_bf16 v[204:207], a[88:91], a[8:11], v[204:207]
    s_waitcnt lgkmcnt(4)
    v_mfma_f32_16x16x32_bf16 v[204:207], a[92:95], a[12:15], v[204:207]
    v_mfma_f32_16x16x32_bf16 v[16:19], a[96:99], v[164:167], v[16:19]
    v_mfma_f32_16x16x32_bf16 v[208:211], a[80:83], a[16:19], -4.0
    global_load_lds_dwordx4 v230, s[52:53] offset:0 nt
    v_mfma_f32_16x16x32_bf16 v[208:211], a[84:87], a[20:23], v[208:211]
    s_waitcnt vmcnt(8)
    ds_read_b128 v[216:219], v239 offset:40960
    v_mfma_f32_16x16x32_bf16 v[208:211], a[88:91], a[24:27], v[208:211]
    v_mfma_f32_16x16x32_bf16 v[208:211], a[92:95], a[28:31], v[208:211]
    v_exp_f32 v204, v204
    v_mfma_f32_16x16x32_bf16 v[48:51], a[96:99], v[172:175], v[48:51]
    v_exp_f32 v205, v205
    v_mfma_f32_16x16x32_bf16 v[212:215], a[80:83], a[32:35], -4.0
    v_exp_f32 v206, v206
    v_mfma_f32_16x16x32_bf16 v[212:215], a[84:87], a[36:39], v[212:215]
    v_exp_f32 v207, v207
    v_mfma_f32_16x16x32_bf16 v[212:215], a[88:91], a[40:43], v[212:215]
    v_cvt_pk_bf16_f32 v162, v204, v205
    v_cvt_pk_bf16_f32 v163, v206, v207
    v_mfma_f32_16x16x32_bf16 v[212:215], a[92:95], a[44:47], v[212:215]
    s_waitcnt lgkmcnt(0)
    v_lshlrev_b32 v244, 16, v216
    v_and_b32 v245, 0xffff0000, v216
    v_lshlrev_b32 v246, 16, v217
    v_and_b32 v247, 0xffff0000, v217
    v_mul_f32 v244, s27, v244
    v_mul_f32 v245, s27, v245
    v_mul_f32 v246, s27, v246
    v_mul_f32 v247, s27, v247
    v_mfma_f32_16x16x32_bf16 v[80:83], a[96:99], v[180:183], v[80:83]
    v_cvt_pk_bf16_f32 v216, v244, v245
    v_cvt_pk_bf16_f32 v217, v246, v247
    v_lshlrev_b32 v244, 16, v218
    v_and_b32 v245, 0xffff0000, v218
    v_lshlrev_b32 v246, 16, v219
    v_and_b32 v247, 0xffff0000, v219
    v_mfma_f32_16x16x32_bf16 v[200:203], a[80:83], a[48:51], -4.0
    v_mul_f32 v244, s27, v244
    v_mul_f32 v245, s27, v245
    v_mul_f32 v246, s27, v246
    v_mul_f32 v247, s27, v247
    v_cvt_pk_bf16_f32 v218, v244, v245
    v_cvt_pk_bf16_f32 v219, v246, v247
    v_mfma_f32_16x16x32_bf16 v[200:203], a[84:87], a[52:55], v[200:203]
    v_exp_f32 v208, v208
    v_mfma_f32_16x16x32_bf16 v[200:203], a[88:91], a[56:59], v[200:203]
    v_exp_f32 v209, v209
    v_mfma_f32_16x16x32_bf16 v[200:203], a[92:95], a[60:63], v[200:203]
    s_waitcnt vmcnt(7)
    ds_read_b128 v[220:223], v239 offset:41984
    global_load_lds_dwordx4 v230, s[52:53] offset:1024 nt
    v_mfma_f32_16x16x32_bf16 v[112:115], a[96:99], v[188:191], v[112:115]
    ds_write_b128 v239, v[216:219] offset:40960
    v_mfma_f32_16x16x32_bf16 v[204:207], a[80:83], a[64:67], -4.0
    s_add_u32 m0, s23, 49152
    v_exp_f32 v210, v210
    v_mfma_f32_16x16x32_bf16 v[204:207], a[84:87], a[68:71], v[204:207]
    v_exp_f32 v211, v211
    v_mfma_f32_16x16x32_bf16 v[204:207], a[88:91], a[72:75], v[204:207]
    v_cvt_pk_bf16_f32 v170, v208, v209
    v_cvt_pk_bf16_f32 v171, v210, v211
    v_mfma_f32_16x16x32_bf16 v[204:207], a[92:95], a[76:79], v[204:207]
    s_waitcnt lgkmcnt(1)
    v_lshlrev_b32 v244, 16, v220
    v_and_b32 v245, 0xffff0000, v220
    v_lshlrev_b32 v246, 16, v221
    v_and_b32 v247, 0xffff0000, v221
    v_mul_f32 v244, s27, v244
    v_mul_f32 v245, s27, v245
    v_mul_f32 v246, s27, v246
    v_mul_f32 v247, s27, v247
    v_cvt_pk_bf16_f32 v220, v244, v245
    v_cvt_pk_bf16_f32 v221, v246, v247
    v_lshlrev_b32 v244, 16, v222
    v_and_b32 v245, 0xffff0000, v222
    v_lshlrev_b32 v246, 16, v223
    v_and_b32 v247, 0xffff0000, v223
    v_mul_f32 v244, s27, v244
    v_mul_f32 v245, s27, v245
    v_mul_f32 v246, s27, v246
    v_mul_f32 v247, s27, v247
    v_cvt_pk_bf16_f32 v222, v244, v245
    v_cvt_pk_bf16_f32 v223, v246, v247
    ds_write_b128 v239, v[220:223] offset:41984
    v_mfma_f32_16x16x32_bf16 v[116:119], a[100:103], v[188:191], v[116:119]
    v_exp_f32 v200, v200
    v_mfma_f32_16x16x32_bf16 v[84:87], a[100:103], v[180:183], v[84:87]
    v_exp_f32 v201, v201
    v_mfma_f32_16x16x32_bf16 v[52:55], a[100:103], v[172:175], v[52:55]
    v_exp_f32 v202, v202
    v_mfma_f32_16x16x32_bf16 v[20:23], a[100:103], v[164:167], v[20:23]
    v_exp_f32 v203, v203
    v_mfma_f32_16x16x32_bf16 v[24:27], a[104:107], v[164:167], v[24:27]
    global_load_lds_dwordx4 v230, s[54:55] offset:0 nt
    v_mfma_f32_16x16x32_bf16 v[56:59], a[104:107], v[172:175], v[56:59]
    v_cvt_pk_bf16_f32 v186, v200, v201
    v_cvt_pk_bf16_f32 v187, v202, v203
    v_mfma_f32_16x16x32_bf16 v[88:91], a[104:107], v[180:183], v[88:91]
    v_exp_f32 v212, v212
    v_mfma_f32_16x16x32_bf16 v[120:123], a[104:107], v[188:191], v[120:123]
    v_exp_f32 v213, v213
    v_mfma_f32_16x16x32_bf16 v[124:127], a[108:111], v[188:191], v[124:127]
    v_exp_f32 v214, v214
    v_mfma_f32_16x16x32_bf16 v[92:95], a[108:111], v[180:183], v[92:95]
    v_exp_f32 v215, v215
    v_mfma_f32_16x16x32_bf16 v[60:63], a[108:111], v[172:175], v[60:63]
    v_cvt_pk_bf16_f32 v178, v212, v213
    v_cvt_pk_bf16_f32 v179, v214, v215
    v_mfma_f32_16x16x32_bf16 v[28:31], a[108:111], v[164:167], v[28:31]
    v_exp_f32 v204, v204
    v_smfmac_f32_16x16x64_bf16 a[116:119], a[132:135], v[168:175], v238
    s_add_u32 s4, s4, 16384
    s_addc_u32 s5, s5, 0
    v_smfmac_f32_16x16x64_bf16 a[124:127], a[132:135], v[184:191], v238
    v_exp_f32 v205, v205
    v_exp_f32 v206, v206
    v_exp_f32 v207, v207
    v_cvt_pk_bf16_f32 v194, v204, v205
    v_cvt_pk_bf16_f32 v195, v206, v207
    s_waitcnt vmcnt(7) lgkmcnt(0)
    s_barrier
    ds_read_b128 a[80:83], v229 offset:40960
    ds_read_b128 a[84:87], v229 offset:41216
    ds_read_b128 a[88:91], v229 offset:41472
    ds_read_b128 a[92:95], v229 offset:41728
    global_load_lds_dwordx4 v230, s[54:55] offset:1024 nt
    s_add_u32 m0, s23, 57344
    s_add_u32 s54, s54, 8192
    s_addc_u32 s55, s55, 0
    ds_read_b64_tr_b16 a[232:233], v232 offset:32768
    ds_read_b64_tr_b16 a[234:235], v232 offset:36864
    ds_read_b64_tr_b16 a[236:237], v232 offset:32776
    ds_read_b64_tr_b16 a[238:239], v232 offset:36872
    s_waitcnt lgkmcnt(7)
    v_mfma_f32_16x16x32_bf16 v[208:211], a[80:83], a[0:3], -4.0
    ds_read_b64_tr_b16 a[104:105], v233 offset:32768
    s_waitcnt lgkmcnt(7)
    v_mfma_f32_16x16x32_bf16 v[208:211], a[84:87], a[4:7], v[208:211]
    s_waitcnt lgkmcnt(6)
    v_mfma_f32_16x16x32_bf16 v[208:211], a[88:91], a[8:11], v[208:211]
    s_waitcnt lgkmcnt(5)
    v_mfma_f32_16x16x32_bf16 v[208:211], a[92:95], a[12:15], v[208:211]
    ds_read_b64_tr_b16 a[106:107], v233 offset:36864
    v_mfma_f32_16x16x32_bf16 v[212:215], a[92:95], a[28:31], -4.0
    ds_read_b64_tr_b16 a[108:109], v233 offset:32776
    v_mfma_f32_16x16x32_bf16 v[212:215], a[88:91], a[24:27], v[212:215]
    ds_read_b64_tr_b16 a[110:111], v233 offset:36872
    v_mfma_f32_16x16x32_bf16 v[212:215], a[84:87], a[20:23], v[212:215]
    ds_read_b64_tr_b16 a[96:97], v234 offset:32768
    v_mfma_f32_16x16x32_bf16 v[212:215], a[80:83], a[16:19], v[212:215]
    v_exp_f32 v208, v208
    v_mfma_f32_16x16x32_bf16 v[200:203], a[80:83], a[32:35], -4.0
    v_exp_f32 v209, v209
    v_mfma_f32_16x16x32_bf16 v[200:203], a[84:87], a[36:39], v[200:203]
    global_load_lds_dwordx4 v230, s[54:55] offset:0 nt
    v_mfma_f32_16x16x32_bf16 v[200:203], a[88:91], a[40:43], v[200:203]
    v_exp_f32 v210, v210
    v_mfma_f32_16x16x32_bf16 v[200:203], a[92:95], a[44:47], v[200:203]
    s_waitcnt lgkmcnt(3)
    v_exp_f32 v211, v211
    v_mfma_f32_16x16x32_bf16 v[0:3], a[232:235], v[160:163], v[0:3]
    ds_read_b64_tr_b16 a[98:99], v234 offset:36864
    v_cvt_pk_bf16_f32 v164, v208, v209
    v_mfma_f32_16x16x32_bf16 v[32:35], a[232:235], v[168:171], v[32:35]
    ds_read_b64_tr_b16 a[100:101], v234 offset:32776
    v_cvt_pk_bf16_f32 v165, v210, v211
    v_mfma_f32_16x16x32_bf16 v[64:67], a[232:235], v[176:179], v[64:67]
    v_exp_f32 v212, v212
    v_mfma_f32_16x16x32_bf16 v[96:99], a[232:235], v[184:187], v[96:99]
    v_exp_f32 v213, v213
    v_mfma_f32_16x16x32_bf16 v[128:131], a[232:235], v[192:195], 0
    v_exp_f32 v214, v214
    v_mfma_f32_16x16x32_bf16 v[132:135], a[236:239], v[192:195], 0
    v_exp_f32 v215, v215
    v_mfma_f32_16x16x32_bf16 v[100:103], a[236:239], v[184:187], v[100:103]
    ds_read_b64_tr_b16 a[102:103], v234 offset:36872
    v_cvt_pk_bf16_f32 v172, v212, v213
    v_mfma_f32_16x16x32_bf16 v[68:71], a[236:239], v[176:179], v[68:71]
    v_cvt_pk_bf16_f32 v173, v214, v215
    v_mfma_f32_16x16x32_bf16 v[36:39], a[236:239], v[168:171], v[36:39]
    v_exp_f32 v200, v200
    v_mfma_f32_16x16x32_bf16 v[4:7], a[236:239], v[160:163], v[4:7]
    v_exp_f32 v201, v201
    v_mfma_f32_16x16x32_bf16 v[204:207], a[92:95], a[60:63], -4.0
    v_exp_f32 v202, v202
    v_mfma_f32_16x16x32_bf16 v[204:207], a[88:91], a[56:59], v[204:207]
    v_exp_f32 v203, v203
    v_mfma_f32_16x16x32_bf16 v[204:207], a[84:87], a[52:55], v[204:207]
    v_cvt_pk_bf16_f32 v180, v200, v201
    v_cvt_pk_bf16_f32 v181, v202, v203
    v_mfma_f32_16x16x32_bf16 v[204:207], a[80:83], a[48:51], v[204:207]
    s_waitcnt vmcnt(8)
    v_mfma_f32_16x16x32_bf16 v[208:211], a[80:83], a[64:67], -4.0
    ds_read_b128 a[80:83], v229 offset:45056
    v_mfma_f32_16x16x32_bf16 v[208:211], a[84:87], a[68:71], v[208:211]
    global_load_dwordx4 a[240:243], v237, s[4:5] offset:0
    v_mfma_f32_16x16x32_bf16 v[208:211], a[88:91], a[72:75], v[208:211]
    ds_read_b128 a[84:87], v229 offset:45312
    v_mfma_f32_16x16x32_bf16 v[208:211], a[92:95], a[76:79], v[208:211]
    ds_read_b128 a[88:91], v229 offset:45568
    v_mfma_f32_16x16x32_bf16 v[8:11], a[104:107], v[160:163], v[8:11]
    ds_read_b128 a[92:95], v229 offset:45824
    v_mfma_f32_16x16x32_bf16 v[40:43], a[104:107], v[168:171], v[40:43]
    v_exp_f32 v204, v204
    v_mfma_f32_16x16x32_bf16 v[72:75], a[104:107], v[176:179], v[72:75]
    v_exp_f32 v205, v205
    v_mfma_f32_16x16x32_bf16 v[104:107], a[104:107], v[184:187], v[104:107]
    v_exp_f32 v206, v206
    v_mfma_f32_16x16x32_bf16 v[136:139], a[104:107], v[192:195], 0
    s_waitcnt lgkmcnt(3)
    v_exp_f32 v207, v207
    v_mfma_f32_16x16x32_bf16 v[140:143], a[108:111], v[192:195], 0
    ds_read_b128 v[216:219], v239 offset:49152
    v_cvt_pk_bf16_f32 v188, v204, v205
    v_mfma_f32_16x16x32_bf16 v[108:111], a[108:111], v[184:187], v[108:111]
    ds_read_b64_tr_b16 a[104:105], v235 offset:32768
    v_cvt_pk_bf16_f32 v189, v206, v207
    v_mfma_f32_16x16x32_bf16 v[76:79], a[108:111], v[176:179], v[76:79]
    s_waitcnt vmcnt(8)
    v_exp_f32 v208, v208
    v_mfma_f32_16x16x32_bf16 v[44:47], a[108:111], v[168:171], v[44:47]
    ds_read_b128 v[220:223], v239 offset:50176
    v_mfma_f32_16x16x32_bf16 v[12:15], a[108:111], v[160:163], v[12:15]
    v_exp_f32 v209, v209
    v_mfma_f32_16x16x32_bf16 v[212:215], a[80:83], a[0:3], -4.0
    s_waitcnt lgkmcnt(3)
    v_exp_f32 v210, v210
    v_mfma_f32_16x16x32_bf16 v[212:215], a[84:87], a[4:7], v[212:215]
    v_exp_f32 v211, v211
    v_mfma_f32_16x16x32_bf16 v[212:215], a[88:91], a[8:11], v[212:215]
    ds_read_b64_tr_b16 a[106:107], v235 offset:36864
    v_cvt_pk_bf16_f32 v196, v208, v209
    v_mfma_f32_16x16x32_bf16 v[212:215], a[92:95], a[12:15], v[212:215]
    s_waitcnt lgkmcnt(3)
    v_lshlrev_b32 v244, 16, v216
    v_and_b32 v245, 0xffff0000, v216
    v_mfma_f32_16x16x32_bf16 v[200:203], a[92:95], a[28:31], -4.0
    ds_read_b64_tr_b16 a[108:109], v235 offset:32776
    v_lshlrev_b32 v246, 16, v217
    v_mfma_f32_16x16x32_bf16 v[200:203], a[88:91], a[24:27], v[200:203]
    global_load_dwordx4 a[244:247], v237, s[4:5] offset:64
    v_mfma_f32_16x16x32_bf16 v[200:203], a[84:87], a[20:23], v[200:203]
    ds_read_b64_tr_b16 a[110:111], v235 offset:36872
    v_and_b32 v247, 0xffff0000, v217
    v_mfma_f32_16x16x32_bf16 v[200:203], a[80:83], a[16:19], v[200:203]
    v_mul_f32 v244, s27, v244
    v_mul_f32 v245, s27, v245
    v_mfma_f32_16x16x32_bf16 v[204:207], a[80:83], a[32:35], -4.0
    v_mul_f32 v246, s27, v246
    v_mul_f32 v247, s27, v247
    v_mfma_f32_16x16x32_bf16 v[204:207], a[84:87], a[36:39], v[204:207]
    v_cvt_pk_bf16_f32 v216, v244, v245
    v_cvt_pk_bf16_f32 v217, v246, v247
    v_mfma_f32_16x16x32_bf16 v[204:207], a[88:91], a[40:43], v[204:207]
    v_lshlrev_b32 v244, 16, v218
    v_and_b32 v245, 0xffff0000, v218
    v_mfma_f32_16x16x32_bf16 v[204:207], a[92:95], a[44:47], v[204:207]
    v_lshlrev_b32 v246, 16, v219
    v_and_b32 v247, 0xffff0000, v219
    v_mfma_f32_16x16x32_bf16 v[16:19], a[96:99], v[160:163], v[16:19]
    v_mul_f32 v244, s27, v244
    v_mul_f32 v245, s27, v245
    v_mfma_f32_16x16x32_bf16 v[48:51], a[96:99], v[168:171], v[48:51]
    v_mul_f32 v246, s27, v246
    v_mul_f32 v247, s27, v247
    v_mfma_f32_16x16x32_bf16 v[80:83], a[96:99], v[176:179], v[80:83]
    v_exp_f32 v212, v212
    v_mfma_f32_16x16x32_bf16 v[112:115], a[96:99], v[184:187], v[112:115]
    v_exp_f32 v213, v213
    v_mfma_f32_16x16x32_bf16 v[144:147], a[96:99], v[192:195], 0
    v_exp_f32 v214, v214
    v_mfma_f32_16x16x32_bf16 v[148:151], a[100:103], v[192:195], 0
    v_exp_f32 v215, v215
    v_mfma_f32_16x16x32_bf16 v[116:119], a[100:103], v[184:187], v[116:119]
    v_cvt_pk_bf16_f32 v218, v244, v245
    v_cvt_pk_bf16_f32 v219, v246, v247
    v_mfma_f32_16x16x32_bf16 v[84:87], a[100:103], v[176:179], v[84:87]
    s_waitcnt lgkmcnt(0)
    v_lshlrev_b32 v244, 16, v220
    v_and_b32 v245, 0xffff0000, v220
    v_mfma_f32_16x16x32_bf16 v[52:55], a[100:103], v[168:171], v[52:55]
    v_lshlrev_b32 v246, 16, v221
    v_and_b32 v247, 0xffff0000, v221
    v_cvt_pk_bf16_f32 v166, v212, v213
    v_cvt_pk_bf16_f32 v167, v214, v215
    v_mul_f32 v244, s27, v244
    v_mul_f32 v245, s27, v245
    v_mul_f32 v246, s27, v246
    v_mul_f32 v247, s27, v247
    v_mfma_f32_16x16x32_bf16 v[20:23], a[100:103], v[160:163], v[20:23]
    global_load_dwordx4 a[248:251], v237, s[4:5] offset:128
    v_cvt_pk_bf16_f32 v220, v244, v245
    v_cvt_pk_bf16_f32 v221, v246, v247
    v_lshlrev_b32 v244, 16, v222
    v_and_b32 v245, 0xffff0000, v222
    v_lshlrev_b32 v246, 16, v223
    v_and_b32 v247, 0xffff0000, v223
    v_smfmac_f32_16x16x64_bf16 a[112:115], a[132:135], v[160:167], v238
    ds_write_b128 v239, v[216:219] offset:49152
    v_mul_f32 v244, s27, v244
    v_mul_f32 v245, s27, v245
    v_mul_f32 v246, s27, v246
    v_mul_f32 v247, s27, v247
    v_cvt_pk_bf16_f32 v197, v210, v211
    v_cvt_pk_bf16_f32 v222, v244, v245
    v_cvt_pk_bf16_f32 v223, v246, v247
    v_mfma_f32_16x16x32_bf16 v[208:211], a[92:95], a[60:63], -4.0
    ds_write_b128 v239, v[220:223] offset:50176
    v_mfma_f32_16x16x32_bf16 v[208:211], a[88:91], a[56:59], v[208:211]
    v_exp_f32 v204, v204
    v_mfma_f32_16x16x32_bf16 v[208:211], a[84:87], a[52:55], v[208:211]
    v_exp_f32 v205, v205
    v_mfma_f32_16x16x32_bf16 v[208:211], a[80:83], a[48:51], v[208:211]
    v_exp_f32 v206, v206
    v_mfma_f32_16x16x32_bf16 v[212:215], a[80:83], a[64:67], -4.0
    v_exp_f32 v207, v207
    v_mfma_f32_16x16x32_bf16 v[212:215], a[84:87], a[68:71], v[212:215]
    v_cvt_pk_bf16_f32 v182, v204, v205
    v_cvt_pk_bf16_f32 v183, v206, v207
    v_mfma_f32_16x16x32_bf16 v[212:215], a[88:91], a[72:75], v[212:215]
    v_exp_f32 v200, v200
    v_mfma_f32_16x16x32_bf16 v[212:215], a[92:95], a[76:79], v[212:215]
    v_exp_f32 v201, v201
    v_mfma_f32_16x16x32_bf16 v[24:27], a[104:107], v[160:163], v[24:27]
    s_waitcnt vmcnt(8) lgkmcnt(0)
    v_exp_f32 v202, v202
    v_mfma_f32_16x16x32_bf16 v[56:59], a[104:107], v[168:171], v[56:59]
    s_barrier
    v_mfma_f32_16x16x32_bf16 v[88:91], a[104:107], v[176:179], v[88:91]
    ds_read_b128 a[80:83], v229 offset:49152
    v_cvt_pk_bf16_f32 v174, v200, v201
    v_mfma_f32_16x16x32_bf16 v[120:123], a[104:107], v[184:187], v[120:123]
    global_load_dwordx4 a[252:255], v237, s[4:5] offset:192
    v_mfma_f32_16x16x32_bf16 v[152:155], a[104:107], v[192:195], 0
    ds_read_b128 a[84:87], v229 offset:49408
    v_mfma_f32_16x16x32_bf16 v[156:159], a[108:111], v[192:195], 0
    ds_read_b128 a[88:91], v229 offset:49664
    v_mfma_f32_16x16x32_bf16 v[124:127], a[108:111], v[184:187], v[124:127]
    ds_read_b128 a[92:95], v229 offset:49920
    v_mfma_f32_16x16x32_bf16 v[92:95], a[108:111], v[176:179], v[92:95]
    v_exp_f32 v203, v203
    v_mfma_f32_16x16x32_bf16 v[60:63], a[108:111], v[168:171], v[60:63]
    ds_read_b64_tr_b16 v[248:249], v232 offset:40960
    v_cvt_pk_bf16_f32 v175, v202, v203
    v_mfma_f32_16x16x32_bf16 v[28:31], a[108:111], v[160:163], v[28:31]
    ds_read_b64_tr_b16 v[250:251], v232 offset:45056
    v_smfmac_f32_16x16x64_bf16 a[120:123], a[132:135], v[176:183], v238
    s_waitcnt lgkmcnt(5)
    v_mfma_f32_16x16x32_bf16 v[200:203], a[80:83], a[0:3], -4.0
    ds_write_b64 v236, a[136:137] offset:32768
    s_waitcnt lgkmcnt(5)
    v_mfma_f32_16x16x32_bf16 v[200:203], a[84:87], a[4:7], v[200:203]
    ds_read_b64_tr_b16 v[252:253], v232 offset:40968
    s_waitcnt lgkmcnt(5)
    v_mfma_f32_16x16x32_bf16 v[200:203], a[88:91], a[8:11], v[200:203]
    ds_read_b64_tr_b16 v[254:255], v232 offset:45064
    s_waitcnt lgkmcnt(5)
    v_mfma_f32_16x16x32_bf16 v[200:203], a[92:95], a[12:15], v[200:203]
    v_exp_f32 v208, v208
    v_mfma_f32_16x16x32_bf16 v[204:207], a[92:95], a[28:31], -4.0
    v_exp_f32 v209, v209
    v_mfma_f32_16x16x32_bf16 v[204:207], a[88:91], a[24:27], v[204:207]
    v_exp_f32 v210, v210
    v_mfma_f32_16x16x32_bf16 v[204:207], a[84:87], a[20:23], v[204:207]
    v_exp_f32 v211, v211
    v_mfma_f32_16x16x32_bf16 v[204:207], a[80:83], a[16:19], v[204:207]
    ds_read_b64_tr_b16 a[104:105], v233 offset:40960
    v_cvt_pk_bf16_f32 v190, v208, v209
    v_cvt_pk_bf16_f32 v191, v210, v211
    v_mfma_f32_16x16x32_bf16 v[208:211], a[80:83], a[32:35], -4.0
    v_exp_f32 v212, v212
    v_mfma_f32_16x16x32_bf16 v[208:211], a[84:87], a[36:39], v[208:211]
    global_load_lds_dwordx4 v230, s[54:55] offset:1024 nt
    v_mfma_f32_16x16x32_bf16 v[208:211], a[88:91], a[40:43], v[208:211]
    v_exp_f32 v213, v213
    v_mfma_f32_16x16x32_bf16 v[208:211], a[92:95], a[44:47], v[208:211]
    s_waitcnt lgkmcnt(1)
    v_exp_f32 v214, v214
    v_mfma_f32_16x16x32_bf16 v[0:3], v[248:251], v[164:167], v[0:3]
    v_exp_f32 v215, v215
    v_mfma_f32_16x16x32_bf16 v[32:35], v[248:251], v[172:175], v[32:35]
    ds_read_b64_tr_b16 a[106:107], v233 offset:45056
    v_cvt_pk_bf16_f32 v198, v212, v213
    v_mfma_f32_16x16x32_bf16 v[64:67], v[248:251], v[180:183], v[64:67]
    ds_read_b64_tr_b16 a[108:109], v233 offset:40968
    v_cvt_pk_bf16_f32 v199, v214, v215
    v_mfma_f32_16x16x32_bf16 v[96:99], v[248:251], v[188:191], v[96:99]
    ds_write_b64 v236, a[138:139] offset:32776
    v_mfma_f32_16x16x32_bf16 v[128:131], v[248:251], v[196:199], v[128:131]
    v_exp_f32 v200, v200
    v_mfma_f32_16x16x32_bf16 v[132:135], v[252:255], v[196:199], v[132:135]
    v_exp_f32 v201, v201
    v_mfma_f32_16x16x32_bf16 v[100:103], v[252:255], v[188:191], v[100:103]
    v_exp_f32 v202, v202
    v_mfma_f32_16x16x32_bf16 v[68:71], v[252:255], v[180:183], v[68:71]
    v_exp_f32 v203, v203
    v_mfma_f32_16x16x32_bf16 v[36:39], v[252:255], v[172:175], v[36:39]
    ds_read_b64_tr_b16 a[110:111], v233 offset:45064
    v_cvt_pk_bf16_f32 v160, v200, v201
    v_mfma_f32_16x16x32_bf16 v[4:7], v[252:255], v[164:167], v[4:7]
    ds_read_b64_tr_b16 a[96:97], v234 offset:40960
    v_cvt_pk_bf16_f32 v161, v202, v203
    v_smfmac_f32_16x16x64_bf16 a[128:131], a[132:135], v[192:199], v238
    ds_write_b64 v236, a[140:141] offset:33792
    v_mfma_f32_16x16x32_bf16 v[212:215], a[92:95], a[60:63], -4.0
    v_exp_f32 v204, v204
    v_mfma_f32_16x16x32_bf16 v[212:215], a[88:91], a[56:59], v[212:215]
    ds_write_b64 v236, a[142:143] offset:33800
    v_mfma_f32_16x16x32_bf16 v[212:215], a[84:87], a[52:55], v[212:215]
    v_exp_f32 v205, v205
    v_mfma_f32_16x16x32_bf16 v[212:215], a[80:83], a[48:51], v[212:215]
    v_exp_f32 v206, v206
    v_mfma_f32_16x16x32_bf16 v[200:203], a[80:83], a[64:67], -4.0
    ds_read_b128 a[80:83], v229 offset:53248
    v_cvt_pk_bf16_f32 v168, v204, v205
    v_mfma_f32_16x16x32_bf16 v[200:203], a[84:87], a[68:71], v[200:203]
    ds_read_b128 a[84:87], v229 offset:53504
    v_xor_b32 v230, 0x800, v236
    v_mfma_f32_16x16x32_bf16 v[200:203], a[88:91], a[72:75], v[200:203]
    ds_read_b128 a[88:91], v229 offset:53760
    v_mfma_f32_16x16x32_bf16 v[200:203], a[92:95], a[76:79], v[200:203]
    s_waitcnt lgkmcnt(5)
    v_exp_f32 v207, v207
    v_mfma_f32_16x16x32_bf16 v[8:11], a[104:107], v[164:167], v[8:11]
    ds_read_b128 a[92:95], v229 offset:54016
    v_cvt_pk_bf16_f32 v169, v206, v207
    v_mfma_f32_16x16x32_bf16 v[40:43], a[104:107], v[172:175], v[40:43]
    v_exp_f32 v208, v208
    v_mfma_f32_16x16x32_bf16 v[72:75], a[104:107], v[180:183], v[72:75]
    v_exp_f32 v209, v209
    v_mfma_f32_16x16x32_bf16 v[104:107], a[104:107], v[188:191], v[104:107]
    v_exp_f32 v210, v210
    v_mfma_f32_16x16x32_bf16 v[136:139], a[104:107], v[196:199], v[136:139]
    v_exp_f32 v211, v211
    v_mfma_f32_16x16x32_bf16 v[140:143], a[108:111], v[196:199], v[140:143]
    ds_read_b64_tr_b16 a[98:99], v234 offset:45056
    v_cvt_pk_bf16_f32 v176, v208, v209
    v_mfma_f32_16x16x32_bf16 v[108:111], a[108:111], v[188:191], v[108:111]
    ds_read_b64_tr_b16 a[100:101], v234 offset:40968
    v_cvt_pk_bf16_f32 v177, v210, v211
    v_mfma_f32_16x16x32_bf16 v[76:79], a[108:111], v[180:183], v[76:79]
    v_exp_f32 v212, v212
    v_mfma_f32_16x16x32_bf16 v[44:47], a[108:111], v[172:175], v[44:47]
    v_exp_f32 v213, v213
    v_mfma_f32_16x16x32_bf16 v[12:15], a[108:111], v[164:167], v[12:15]
    s_waitcnt lgkmcnt(3)
    v_exp_f32 v214, v214
    v_mfma_f32_16x16x32_bf16 v[204:207], a[80:83], a[0:3], -4.0
    v_exp_f32 v215, v215
    v_mfma_f32_16x16x32_bf16 v[204:207], a[84:87], a[4:7], v[204:207]
    s_waitcnt vmcnt(9)
    v_cvt_pk_bf16_f32 v184, v212, v213
    v_cvt_pk_bf16_f32 v185, v214, v215
    v_mfma_f32_16x16x32_bf16 v[204:207], a[88:91], a[8:11], v[204:207]
    s_waitcnt lgkmcnt(2)
    v_exp_f32 v200, v200
    v_mfma_f32_16x16x32_bf16 v[204:207], a[92:95], a[12:15], v[204:207]
    ds_read_b128 v[216:219], v239 offset:57344
    v_mfma_f32_16x16x32_bf16 v[208:211], a[92:95], a[28:31], -4.0
    ds_read_b64_tr_b16 a[102:103], v234 offset:45064
    v_mfma_f32_16x16x32_bf16 v[208:211], a[88:91], a[24:27], v[208:211]
    s_waitcnt vmcnt(8)
    v_exp_f32 v201, v201
    v_mfma_f32_16x16x32_bf16 v[208:211], a[84:87], a[20:23], v[208:211]
    ds_read_b128 v[220:223], v239 offset:58368
    v_cvt_pk_bf16_f32 v192, v200, v201
    v_mfma_f32_16x16x32_bf16 v[208:211], a[80:83], a[16:19], v[208:211]
    v_exp_f32 v202, v202
    v_mfma_f32_16x16x32_bf16 v[212:215], a[80:83], a[32:35], -4.0
    v_exp_f32 v203, v203
    v_mfma_f32_16x16x32_bf16 v[212:215], a[84:87], a[36:39], v[212:215]
    ds_read_b64_tr_b16 a[104:105], v235 offset:40960
    v_cvt_pk_bf16_f32 v193, v202, v203
    v_mfma_f32_16x16x32_bf16 v[212:215], a[88:91], a[40:43], v[212:215]
    ds_read_b64_tr_b16 a[106:107], v235 offset:45056
    v_mfma_f32_16x16x32_bf16 v[212:215], a[92:95], a[44:47], v[212:215]
    s_waitcnt lgkmcnt(5)
    s_waitcnt lgkmcnt(4)
    v_lshlrev_b32 v244, 16, v216
    v_mfma_f32_16x16x32_bf16 v[16:19], a[96:99], v[164:167], v[16:19]
    ds_read_b64_tr_b16 a[108:109], v235 offset:40968
    v_and_b32 v245, 0xffff0000, v216
    v_mfma_f32_16x16x32_bf16 v[48:51], a[96:99], v[172:175], v[48:51]
    ds_read_b64_tr_b16 a[110:111], v235 offset:45064
    v_lshlrev_b32 v246, 16, v217
    v_mfma_f32_16x16x32_bf16 v[80:83], a[96:99], v[180:183], v[80:83]
    v_and_b32 v247, 0xffff0000, v217
    v_mul_f32 v244, s27, v244
    v_mfma_f32_16x16x32_bf16 v[112:115], a[96:99], v[188:191], v[112:115]
    v_mul_f32 v245, s27, v245
    v_mul_f32 v246, s27, v246
    v_mfma_f32_16x16x32_bf16 v[144:147], a[96:99], v[196:199], v[144:147]
    s_waitcnt lgkmcnt(4)
    v_mul_f32 v247, s27, v247
    v_cvt_pk_bf16_f32 v216, v244, v245
    v_mfma_f32_16x16x32_bf16 v[148:151], a[100:103], v[196:199], v[148:151]
    v_cvt_pk_bf16_f32 v217, v246, v247
    v_lshlrev_b32 v244, 16, v218
    v_and_b32 v245, 0xffff0000, v218
    v_lshlrev_b32 v246, 16, v219
    v_and_b32 v247, 0xffff0000, v219
    v_mfma_f32_16x16x32_bf16 v[116:119], a[100:103], v[188:191], v[116:119]
    v_mul_f32 v244, s27, v244
    v_mul_f32 v245, s27, v245
    v_mul_f32 v246, s27, v246
    v_mul_f32 v247, s27, v247
    v_cvt_pk_bf16_f32 v218, v244, v245
    v_cvt_pk_bf16_f32 v219, v246, v247
    v_mfma_f32_16x16x32_bf16 v[84:87], a[100:103], v[180:183], v[84:87]
    v_lshlrev_b32 v244, 16, v220
    v_and_b32 v245, 0xffff0000, v220
    v_lshlrev_b32 v246, 16, v221
    v_and_b32 v247, 0xffff0000, v221
    v_mul_f32 v244, s27, v244
    v_mul_f32 v245, s27, v245
    v_mul_f32 v246, s27, v246
    v_mul_f32 v247, s27, v247
    v_mfma_f32_16x16x32_bf16 v[52:55], a[100:103], v[172:175], v[52:55]
    v_cvt_pk_bf16_f32 v220, v244, v245
    v_cvt_pk_bf16_f32 v221, v246, v247
    v_lshlrev_b32 v244, 16, v222
    v_and_b32 v245, 0xffff0000, v222
    v_lshlrev_b32 v246, 16, v223
    v_and_b32 v247, 0xffff0000, v223
    v_mfma_f32_16x16x32_bf16 v[20:23], a[100:103], v[164:167], v[20:23]
    v_mul_f32 v244, s27, v244
    v_mul_f32 v245, s27, v245
    v_mul_f32 v246, s27, v246
    v_mul_f32 v247, s27, v247
    v_cvt_pk_bf16_f32 v222, v244, v245
    v_cvt_pk_bf16_f32 v223, v246, v247
    v_mfma_f32_16x16x32_bf16 v[200:203], a[92:95], a[60:63], -4.0
    ds_write_b128 v239, v[216:219] offset:57344
    v_mfma_f32_16x16x32_bf16 v[200:203], a[88:91], a[56:59], v[200:203]
    v_exp_f32 v204, v204
    v_mfma_f32_16x16x32_bf16 v[200:203], a[84:87], a[52:55], v[200:203]
    ds_write_b128 v239, v[220:223] offset:58368
    v_exp_f32 v205, v205
    v_exp_f32 v206, v206
    v_exp_f32 v207, v207
    v_mfma_f32_16x16x32_bf16 v[200:203], a[80:83], a[48:51], v[200:203]
    v_cvt_pk_bf16_f32 v162, v204, v205
    v_cvt_pk_bf16_f32 v163, v206, v207
    v_mfma_f32_16x16x32_bf16 v[204:207], a[80:83], a[64:67], -4.0
    v_exp_f32 v208, v208
    v_mfma_f32_16x16x32_bf16 v[204:207], a[84:87], a[68:71], v[204:207]
    v_exp_f32 v209, v209
    v_mfma_f32_16x16x32_bf16 v[204:207], a[88:91], a[72:75], v[204:207]
    v_exp_f32 v210, v210
    v_mfma_f32_16x16x32_bf16 v[204:207], a[92:95], a[76:79], v[204:207]
    s_waitcnt lgkmcnt(1)
    v_exp_f32 v211, v211
    v_mfma_f32_16x16x32_bf16 v[24:27], a[104:107], v[164:167], v[24:27]
    s_waitcnt vmcnt(6) lgkmcnt(0)
    v_cvt_pk_bf16_f32 v170, v208, v209
    v_cvt_pk_bf16_f32 v171, v210, v211
    v_mfma_f32_16x16x32_bf16 v[56:59], a[104:107], v[172:175], v[56:59]
    s_barrier
    v_mfma_f32_16x16x32_bf16 v[88:91], a[104:107], v[180:183], v[88:91]
    ds_read_b128 a[80:83], v229 offset:57344
    v_xor_b32 v239, 0x1800, v236
    v_mfma_f32_16x16x32_bf16 v[120:123], a[104:107], v[188:191], v[120:123]
    ds_read_b128 a[84:87], v229 offset:57600
    v_and_b32 v244, 0xfffff7ff, v237
    v_mfma_f32_16x16x32_bf16 v[152:155], a[104:107], v[196:199], v[152:155]
    ds_read_b128 a[88:91], v229 offset:57856
    v_lshrrev_b32 v245, 5, v237
    v_mfma_f32_16x16x32_bf16 v[156:159], a[108:111], v[196:199], v[156:159]
    ds_read_b128 a[92:95], v229 offset:58112
    v_and_or_b32 v244, v245, 64, v244
    v_mfma_f32_16x16x32_bf16 v[124:127], a[108:111], v[188:191], v[124:127]
    v_exp_f32 v212, v212
    v_mfma_f32_16x16x32_bf16 v[92:95], a[108:111], v[180:183], v[92:95]
    v_exp_f32 v213, v213
    v_mfma_f32_16x16x32_bf16 v[60:63], a[108:111], v[172:175], v[60:63]
    v_exp_f32 v214, v214
    v_mfma_f32_16x16x32_bf16 v[28:31], a[108:111], v[164:167], v[28:31]
    v_exp_f32 v215, v215
    v_smfmac_f32_16x16x64_bf16 a[116:119], a[132:135], v[168:175], v238
    s_waitcnt lgkmcnt(3)
    v_cvt_pk_bf16_f32 v178, v212, v213
    v_mfma_f32_16x16x32_bf16 v[208:211], a[80:83], a[0:3], -4.0
    s_waitcnt lgkmcnt(2)
    v_cvt_pk_bf16_f32 v179, v214, v215
    v_xor_b32 v244, s24, v244
    v_mfma_f32_16x16x32_bf16 v[208:211], a[84:87], a[4:7], v[208:211]
    s_waitcnt lgkmcnt(1)
    v_exp_f32 v200, v200
    v_mfma_f32_16x16x32_bf16 v[208:211], a[88:91], a[8:11], v[208:211]
    s_waitcnt lgkmcnt(0)
    v_exp_f32 v201, v201
    v_mfma_f32_16x16x32_bf16 v[208:211], a[92:95], a[12:15], v[208:211]
    ds_read_b64_tr_b16 a[136:137], v232 offset:49152
    v_cvt_pk_bf16_f32 v186, v200, v201
    v_mfma_f32_16x16x32_bf16 v[212:215], a[92:95], a[28:31], -4.0
    ds_read_b64_tr_b16 a[138:139], v232 offset:53248
    ds_write_b64 v236, a[144:145] offset:40960
    v_mfma_f32_16x16x32_bf16 v[212:215], a[88:91], a[24:27], v[212:215]
    v_exp_f32 v202, v202
    v_mfma_f32_16x16x32_bf16 v[212:215], a[84:87], a[20:23], v[212:215]
    v_exp_f32 v203, v203
    v_mfma_f32_16x16x32_bf16 v[212:215], a[80:83], a[16:19], v[212:215]
    ds_read_b64_tr_b16 a[140:141], v232 offset:49160
    v_cvt_pk_bf16_f32 v187, v202, v203
    v_mfma_f32_16x16x32_bf16 v[200:203], a[80:83], a[32:35], -4.0
    ds_read_b64_tr_b16 a[142:143], v232 offset:53256
    v_xor_b32 v245, 0x840, v244
    v_mfma_f32_16x16x32_bf16 v[200:203], a[84:87], a[36:39], v[200:203]
    v_exp_f32 v204, v204
    v_mfma_f32_16x16x32_bf16 v[200:203], a[88:91], a[40:43], v[200:203]
    v_exp_f32 v205, v205
    v_mfma_f32_16x16x32_bf16 v[200:203], a[92:95], a[44:47], v[200:203]
    v_cvt_pk_bf16_f32 v194, v204, v205
    s_waitcnt lgkmcnt(3)
    v_mfma_f32_16x16x32_bf16 v[0:3], a[136:139], v[160:163], v[0:3]
    v_exp_f32 v206, v206
    v_mfma_f32_16x16x32_bf16 v[32:35], a[136:139], v[168:171], v[32:35]
    v_exp_f32 v207, v207
    v_mfma_f32_16x16x32_bf16 v[64:67], a[136:139], v[176:179], v[64:67]
    ds_read_b64_tr_b16 a[104:105], v233 offset:49152
    v_cvt_pk_bf16_f32 v195, v206, v207
    v_mfma_f32_16x16x32_bf16 v[96:99], a[136:139], v[184:187], v[96:99]
    ds_write_b64 v236, a[146:147] offset:40968
    v_mfma_f32_16x16x32_bf16 v[128:131], a[136:139], v[192:195], v[128:131]
    s_waitcnt lgkmcnt(2)
    v_exp_f32 v208, v208
    v_mfma_f32_16x16x32_bf16 v[132:135], a[140:143], v[192:195], v[132:135]
    ds_read_b64_tr_b16 a[106:107], v233 offset:53248
    v_mfma_f32_16x16x32_bf16 v[100:103], a[140:143], v[184:187], v[100:103]
    v_exp_f32 v209, v209
    v_mfma_f32_16x16x32_bf16 v[68:71], a[140:143], v[176:179], v[68:71]
    v_exp_f32 v210, v210
    v_mfma_f32_16x16x32_bf16 v[36:39], a[140:143], v[168:171], v[36:39]
    v_exp_f32 v211, v211
    v_mfma_f32_16x16x32_bf16 v[4:7], a[140:143], v[160:163], v[4:7]
    ds_read_b64_tr_b16 a[108:109], v233 offset:49160
    v_cvt_pk_bf16_f32 v164, v208, v209
    v_smfmac_f32_16x16x64_bf16 a[124:127], a[132:135], v[184:191], v238
    ds_read_b64_tr_b16 a[110:111], v233 offset:53256
    v_cvt_pk_bf16_f32 v165, v210, v211
    v_mfma_f32_16x16x32_bf16 v[204:207], a[92:95], a[60:63], -4.0
    ds_write_b64 v236, a[148:149] offset:41984
    v_mfma_f32_16x16x32_bf16 v[204:207], a[88:91], a[56:59], v[204:207]
    v_exp_f32 v212, v212
    v_mfma_f32_16x16x32_bf16 v[204:207], a[84:87], a[52:55], v[204:207]
    ds_write_b64 v236, a[150:151] offset:41992
    v_mfma_f32_16x16x32_bf16 v[204:207], a[80:83], a[48:51], v[204:207]
    v_exp_f32 v213, v213
    v_mfma_f32_16x16x32_bf16 v[208:211], a[80:83], a[64:67], -4.0
    ds_read_b128 a[80:83], v229 offset:61440
    v_cvt_pk_bf16_f32 v172, v212, v213
    v_mfma_f32_16x16x32_bf16 v[208:211], a[84:87], a[68:71], v[208:211]
    ds_read_b128 a[84:87], v229 offset:61696
    v_mfma_f32_16x16x32_bf16 v[208:211], a[88:91], a[72:75], v[208:211]
    ds_read_b128 a[88:91], v229 offset:61952
    v_mfma_f32_16x16x32_bf16 v[208:211], a[92:95], a[76:79], v[208:211]
    s_waitcnt lgkmcnt(6)
    v_exp_f32 v214, v214
    v_mfma_f32_16x16x32_bf16 v[8:11], a[104:107], v[160:163], v[8:11]
    ds_read_b128 a[92:95], v229 offset:62208
    v_mfma_f32_16x16x32_bf16 v[40:43], a[104:107], v[168:171], v[40:43]
    v_exp_f32 v215, v215
    v_mfma_f32_16x16x32_bf16 v[72:75], a[104:107], v[176:179], v[72:75]
    ds_read_b64_tr_b16 a[96:97], v234 offset:49152
    v_cvt_pk_bf16_f32 v173, v214, v215
    v_mfma_f32_16x16x32_bf16 v[104:107], a[104:107], v[184:187], v[104:107]
    v_exp_f32 v200, v200
    v_mfma_f32_16x16x32_bf16 v[136:139], a[104:107], v[192:195], v[136:139]
    s_waitcnt lgkmcnt(5)
    v_exp_f32 v201, v201
    v_mfma_f32_16x16x32_bf16 v[140:143], a[108:111], v[192:195], v[140:143]
    v_exp_f32 v202, v202
    v_mfma_f32_16x16x32_bf16 v[108:111], a[108:111], v[184:187], v[108:111]
    v_exp_f32 v203, v203
    v_mfma_f32_16x16x32_bf16 v[76:79], a[108:111], v[176:179], v[76:79]
    ds_read_b64_tr_b16 a[98:99], v234 offset:53248
    v_cvt_pk_bf16_f32 v180, v200, v201
    v_mfma_f32_16x16x32_bf16 v[44:47], a[108:111], v[168:171], v[44:47]
    ds_read_b64_tr_b16 a[100:101], v234 offset:49160
    v_cvt_pk_bf16_f32 v181, v202, v203
    v_mfma_f32_16x16x32_bf16 v[12:15], a[108:111], v[160:163], v[12:15]
    s_waitcnt lgkmcnt(4)
    v_exp_f32 v204, v204
    v_mfma_f32_16x16x32_bf16 v[212:215], a[80:83], a[0:3], -4.0
    v_exp_f32 v205, v205
    v_mfma_f32_16x16x32_bf16 v[212:215], a[84:87], a[4:7], v[212:215]
    v_exp_f32 v206, v206
    v_mfma_f32_16x16x32_bf16 v[212:215], a[88:91], a[8:11], v[212:215]
    s_waitcnt lgkmcnt(2)
    v_exp_f32 v207, v207
    v_mfma_f32_16x16x32_bf16 v[212:215], a[92:95], a[12:15], v[212:215]
    ds_read_b64_tr_b16 a[102:103], v234 offset:53256
    v_cvt_pk_bf16_f32 v188, v204, v205
    v_mfma_f32_16x16x32_bf16 v[200:203], a[92:95], a[28:31], -4.0
    ds_read_b64_tr_b16 a[104:105], v235 offset:49152
    v_cvt_pk_bf16_f32 v189, v206, v207
    v_mfma_f32_16x16x32_bf16 v[200:203], a[88:91], a[24:27], v[200:203]
    v_exp_f32 v208, v208
    v_mfma_f32_16x16x32_bf16 v[200:203], a[84:87], a[20:23], v[200:203]
    v_exp_f32 v212, v212
    v_mfma_f32_16x16x32_bf16 v[200:203], a[80:83], a[16:19], v[200:203]
    v_exp_f32 v213, v213
    v_mfma_f32_16x16x32_bf16 v[204:207], a[80:83], a[32:35], -4.0
    v_exp_f32 v214, v214
    v_mfma_f32_16x16x32_bf16 v[204:207], a[84:87], a[36:39], v[204:207]
    v_exp_f32 v215, v215
    v_mfma_f32_16x16x32_bf16 v[204:207], a[88:91], a[40:43], v[204:207]
    ds_read_b64_tr_b16 a[106:107], v235 offset:53248
    v_cvt_pk_bf16_f32 v166, v212, v213
    v_mfma_f32_16x16x32_bf16 v[204:207], a[92:95], a[44:47], v[204:207]
    s_waitcnt lgkmcnt(3)
    v_cvt_pk_bf16_f32 v167, v214, v215
    v_mfma_f32_16x16x32_bf16 v[16:19], a[96:99], v[160:163], v[16:19]
    v_exp_f32 v209, v209
    v_mfma_f32_16x16x32_bf16 v[48:51], a[96:99], v[168:171], v[48:51]
    v_exp_f32 v210, v210
    v_mfma_f32_16x16x32_bf16 v[80:83], a[96:99], v[176:179], v[80:83]
    v_exp_f32 v211, v211
    v_mfma_f32_16x16x32_bf16 v[112:115], a[96:99], v[184:187], v[112:115]
    ds_read_b64_tr_b16 a[108:109], v235 offset:49160
    v_cvt_pk_bf16_f32 v196, v208, v209
    v_mfma_f32_16x16x32_bf16 v[144:147], a[96:99], v[192:195], v[144:147]
    s_waitcnt lgkmcnt(2)
    v_cvt_pk_bf16_f32 v197, v210, v211
    v_mfma_f32_16x16x32_bf16 v[148:151], a[100:103], v[192:195], v[148:151]
    ds_read_b64_tr_b16 a[110:111], v235 offset:53256
    v_mfma_f32_16x16x32_bf16 v[116:119], a[100:103], v[184:187], v[116:119]
    v_exp_f32 v204, v204
    v_mfma_f32_16x16x32_bf16 v[84:87], a[100:103], v[176:179], v[84:87]
    v_exp_f32 v205, v205
    v_mfma_f32_16x16x32_bf16 v[52:55], a[100:103], v[168:171], v[52:55]
    v_exp_f32 v206, v206
    v_mfma_f32_16x16x32_bf16 v[20:23], a[100:103], v[160:163], v[20:23]
    v_exp_f32 v207, v207
    v_smfmac_f32_16x16x64_bf16 a[112:115], a[132:135], v[160:167], v238
    v_cvt_pk_bf16_f32 v182, v204, v205
    v_mfma_f32_16x16x32_bf16 v[208:211], a[92:95], a[60:63], -4.0
    v_cvt_pk_bf16_f32 v183, v206, v207
    v_mfma_f32_16x16x32_bf16 v[208:211], a[88:91], a[56:59], v[208:211]
    v_exp_f32 v200, v200
    v_mfma_f32_16x16x32_bf16 v[208:211], a[84:87], a[52:55], v[208:211]
    v_exp_f32 v201, v201
    v_mfma_f32_16x16x32_bf16 v[208:211], a[80:83], a[48:51], v[208:211]
    v_accvgpr_read_b32 v224, a112
    v_accvgpr_read_b32 v226, a113
    v_mfma_f32_16x16x32_bf16 v[212:215], a[80:83], a[64:67], -4.0
    v_add_f32 v226, v226, v224
    v_cvt_pk_bf16_f32 v174, v200, v201
    v_mfma_f32_16x16x32_bf16 v[212:215], a[84:87], a[68:71], v[212:215]
    v_rcp_f32 v224, v226
    v_mfma_f32_16x16x32_bf16 v[212:215], a[88:91], a[72:75], v[212:215]
    v_exp_f32 v202, v202
    v_mfma_f32_16x16x32_bf16 v[212:215], a[92:95], a[76:79], v[212:215]
    s_waitcnt lgkmcnt(0)
    v_exp_f32 v203, v203
    v_mfma_f32_16x16x32_bf16 v[24:27], a[104:107], v[160:163], v[24:27]
    s_waitcnt vmcnt(4)
    v_accvgpr_mov_b32 a0, a240
    v_accvgpr_mov_b32 a1, a241
    v_mfma_f32_16x16x32_bf16 v[56:59], a[104:107], v[168:171], v[56:59]
    v_accvgpr_mov_b32 a2, a242
    v_accvgpr_mov_b32 a3, a243
    v_mfma_f32_16x16x32_bf16 v[88:91], a[104:107], v[176:179], v[88:91]
    v_cvt_pk_bf16_f32 v175, v202, v203
    v_mov_b32_dpp v246, v224 row_ror:8 row_mask:0xf bank_mask:0xf
    v_mfma_f32_16x16x32_bf16 v[120:123], a[104:107], v[184:187], v[120:123]
    s_waitcnt vmcnt(0)
    s_barrier
    ds_read_b128 a[80:83], v228 offset:0
    v_mfma_f32_16x16x32_bf16 v[152:155], a[104:107], v[192:195], v[152:155]
    ds_read_b128 a[84:87], v228 offset:256
    v_accvgpr_mov_b32 a4, a244
    v_mfma_f32_16x16x32_bf16 v[156:159], a[108:111], v[192:195], v[156:159]
    ds_read_b128 a[88:91], v228 offset:512
    v_accvgpr_mov_b32 a5, a245
    v_mfma_f32_16x16x32_bf16 v[124:127], a[108:111], v[184:187], v[124:127]
    ds_read_b128 a[92:95], v228 offset:768
    v_accvgpr_mov_b32 a6, a246
    v_mfma_f32_16x16x32_bf16 v[92:95], a[108:111], v[176:179], v[92:95]
    ds_read_b64_tr_b16 a[144:145], v232 offset:57344
    v_accvgpr_mov_b32 a7, a247
    v_mfma_f32_16x16x32_bf16 v[60:63], a[108:111], v[168:171], v[60:63]
    ds_read_b64_tr_b16 a[146:147], v232 offset:61440
    v_accvgpr_mov_b32 a8, a248
    v_mfma_f32_16x16x32_bf16 v[28:31], a[108:111], v[160:163], v[28:31]
    ds_read_b64_tr_b16 a[148:149], v232 offset:57352
    v_accvgpr_mov_b32 a9, a249
    v_smfmac_f32_16x16x64_bf16 a[120:123], a[132:135], v[176:183], v238
    s_waitcnt lgkmcnt(4)
    s_add_u32 s4, s4, 16384
    s_addc_u32 s5, s5, 0
    v_accvgpr_mov_b32 a10, a250
    v_accvgpr_mov_b32 a11, a251
    v_accvgpr_mov_b32 a12, a252
    v_accvgpr_mov_b32 a13, a253
    v_accvgpr_mov_b32 a14, a254
    v_accvgpr_mov_b32 a15, a255
    v_exp_f32 v208, v208
    v_exp_f32 v209, v209
    v_exp_f32 v210, v210
    v_exp_f32 v211, v211
    v_cvt_pk_bf16_f32 v190, v208, v209
    v_cvt_pk_bf16_f32 v191, v210, v211
    ds_read_b64_tr_b16 a[150:151], v232 offset:61448
    v_exp_f32 v212, v212
    v_exp_f32 v213, v213
    ds_read_b64_tr_b16 a[104:105], v233 offset:57344
    ds_read_b64_tr_b16 a[106:107], v233 offset:61440
    ds_read_b64_tr_b16 a[108:109], v233 offset:57352
    ds_read_b64_tr_b16 a[110:111], v233 offset:61448
    ds_read_b64_tr_b16 a[96:97], v234 offset:57344
    ds_read_b64_tr_b16 a[98:99], v234 offset:61440
    ds_read_b64_tr_b16 a[100:101], v234 offset:57352
    ds_read_b64_tr_b16 a[102:103], v234 offset:61448
    v_accvgpr_write_b32 a112, 0
    v_accvgpr_write_b32 a113, 0
    v_max3_f32 v227, v226, v224, v227
    v_mfma_f32_16x16x32_bf16 v[200:203], a[80:83], a[0:3], -4.0
    global_load_dwordx4 a[240:243], v237, s[4:5] offset:0
    v_mfma_f32_16x16x32_bf16 v[200:203], a[84:87], a[4:7], v[200:203]
    global_load_dwordx4 a[244:247], v237, s[4:5] offset:64
    v_mfma_f32_16x16x32_bf16 v[200:203], a[88:91], a[8:11], v[200:203]
    s_waitcnt lgkmcnt(7)
    v_exp_f32 v214, v214
    v_mfma_f32_16x16x32_bf16 v[200:203], a[92:95], a[12:15], v[200:203]
    global_load_dwordx4 a[248:251], v237, s[4:5] offset:128
    v_mfma_f32_16x16x32_bf16 v[204:207], a[92:95], a[28:31], -4.0
    global_load_dwordx4 a[252:255], v237, s[4:5] offset:192
    v_mfma_f32_16x16x32_bf16 v[204:207], a[88:91], a[24:27], v[204:207]
    v_exp_f32 v215, v215
    v_mfma_f32_16x16x32_bf16 v[204:207], a[84:87], a[20:23], v[204:207]
    v_cvt_pk_bf16_f32 v198, v212, v213
    v_cvt_pk_bf16_f32 v199, v214, v215
    v_mfma_f32_16x16x32_bf16 v[204:207], a[80:83], a[16:19], v[204:207]
    v_mfma_f32_16x16x32_bf16 v[208:211], a[80:83], a[32:35], -4.0
    v_mfma_f32_16x16x32_bf16 v[208:211], a[84:87], a[36:39], v[208:211]
    v_exp_f32 v200, v200
    v_mfma_f32_16x16x32_bf16 v[208:211], a[88:91], a[40:43], v[208:211]
    v_exp_f32 v201, v201
    v_mfma_f32_16x16x32_bf16 v[208:211], a[92:95], a[44:47], v[208:211]
    v_exp_f32 v202, v202
    v_mfma_f32_16x16x32_bf16 v[0:3], a[144:147], v[164:167], v[0:3]
    v_exp_f32 v203, v203
    v_mfma_f32_16x16x32_bf16 v[32:35], a[144:147], v[172:175], v[32:35]
    v_cvt_pk_bf16_f32 v160, v200, v201
    v_mfma_f32_16x16x32_bf16 v[64:67], a[144:147], v[180:183], v[64:67]
    v_cvt_pk_bf16_f32 v161, v202, v203
    v_mfma_f32_16x16x32_bf16 v[96:99], a[144:147], v[188:191], v[96:99]
    v_exp_f32 v204, v204
    v_mfma_f32_16x16x32_bf16 v[128:131], a[144:147], v[196:199], v[128:131]
    v_exp_f32 v205, v205
    v_mfma_f32_16x16x32_bf16 v[132:135], a[148:151], v[196:199], v[132:135]
    v_exp_f32 v206, v206
    v_mfma_f32_16x16x32_bf16 v[100:103], a[148:151], v[188:191], v[100:103]
    v_exp_f32 v207, v207
    v_mfma_f32_16x16x32_bf16 v[68:71], a[148:151], v[180:183], v[68:71]
    v_cvt_pk_bf16_f32 v168, v204, v205
    v_mfma_f32_16x16x32_bf16 v[36:39], a[148:151], v[172:175], v[36:39]
    v_cvt_pk_bf16_f32 v169, v206, v207
    v_mul_f32 v0, v0, v224
    v_mfma_f32_16x16x32_bf16 v[4:7], a[148:151], v[164:167], v[4:7]
    v_exp_f32 v208, v208
    v_smfmac_f32_16x16x64_bf16 a[128:131], a[132:135], v[192:199], v238
    v_mul_f32 v1, v1, v224
    v_mfma_f32_16x16x32_bf16 v[212:215], a[92:95], a[60:63], -4.0
    v_exp_f32 v209, v209
    v_mfma_f32_16x16x32_bf16 v[212:215], a[88:91], a[56:59], v[212:215]
    v_exp_f32 v210, v210
    v_mfma_f32_16x16x32_bf16 v[212:215], a[84:87], a[52:55], v[212:215]
    v_exp_f32 v211, v211
    v_mfma_f32_16x16x32_bf16 v[212:215], a[80:83], a[48:51], v[212:215]
    v_cvt_pk_bf16_f32 v176, v208, v209
    v_cvt_pk_bf16_f32 v177, v210, v211
    v_mfma_f32_16x16x32_bf16 v[200:203], a[80:83], a[64:67], -4.0
    ds_read_b128 a[80:83], v228 offset:4096
    v_mul_f32 v2, v2, v224
    v_mfma_f32_16x16x32_bf16 v[200:203], a[84:87], a[68:71], v[200:203]
    ds_read_b128 a[84:87], v228 offset:4352
    v_mul_f32 v3, v3, v224
    v_mfma_f32_16x16x32_bf16 v[200:203], a[88:91], a[72:75], v[200:203]
    ds_read_b128 a[88:91], v228 offset:4608
    v_cvt_pk_bf16_f32 v216, v0, v1
    v_mfma_f32_16x16x32_bf16 v[200:203], a[92:95], a[76:79], v[200:203]
    v_exp_f32 v212, v212
    s_waitcnt lgkmcnt(3)
    v_mfma_f32_16x16x32_bf16 v[8:11], a[104:107], v[164:167], v[8:11]
    ds_read_b128 a[92:95], v228 offset:4864
    v_cvt_pk_bf16_f32 v217, v2, v3
    v_mfma_f32_16x16x32_bf16 v[40:43], a[104:107], v[172:175], v[40:43]
    v_exp_f32 v213, v213
    v_mfma_f32_16x16x32_bf16 v[72:75], a[104:107], v[180:183], v[72:75]
    v_exp_f32 v214, v214
    v_mfma_f32_16x16x32_bf16 v[104:107], a[104:107], v[188:191], v[104:107]
    v_exp_f32 v215, v215
    v_mfma_f32_16x16x32_bf16 v[136:139], a[104:107], v[196:199], v[136:139]
    v_cvt_pk_bf16_f32 v184, v212, v213
    ds_read_b64_tr_b16 a[104:105], v235 offset:57344
    ds_read_b64_tr_b16 a[106:107], v235 offset:61440
    v_mfma_f32_16x16x32_bf16 v[140:143], a[108:111], v[196:199], v[140:143]
    v_cvt_pk_bf16_f32 v185, v214, v215
    v_mul_f32 v4, v4, v224
    v_mfma_f32_16x16x32_bf16 v[108:111], a[108:111], v[188:191], v[108:111]
    v_exp_f32 v200, v200
    v_mfma_f32_16x16x32_bf16 v[76:79], a[108:111], v[180:183], v[76:79]
    v_exp_f32 v201, v201
    v_mfma_f32_16x16x32_bf16 v[44:47], a[108:111], v[172:175], v[44:47]
    v_exp_f32 v202, v202
    v_mfma_f32_16x16x32_bf16 v[12:15], a[108:111], v[164:167], v[12:15]
    s_waitcnt lgkmcnt(2)
    v_exp_f32 v203, v203
    ds_read_b64_tr_b16 a[108:109], v235 offset:57352
    ds_read_b64_tr_b16 a[110:111], v235 offset:61448
    v_mfma_f32_16x16x32_bf16 v[204:207], a[80:83], a[0:3], -4.0
    v_cvt_pk_bf16_f32 v192, v200, v201
    v_mfma_f32_16x16x32_bf16 v[204:207], a[84:87], a[4:7], v[204:207]
    v_cvt_pk_bf16_f32 v193, v202, v203
    v_mul_f32 v5, v5, v224
    v_mfma_f32_16x16x32_bf16 v[204:207], a[88:91], a[8:11], v[204:207]
    v_mul_f32 v6, v6, v224
    v_mul_f32 v7, v7, v224
    v_mfma_f32_16x16x32_bf16 v[204:207], a[92:95], a[12:15], v[204:207]
    v_cvt_pk_bf16_f32 v218, v4, v5
    v_cvt_pk_bf16_f32 v219, v6, v7
    v_mfma_f32_16x16x32_bf16 v[208:211], a[92:95], a[28:31], -4.0
    v_mul_f32_dpp v8, v8, v246 row_ror:8 row_mask:0xf bank_mask:0xf
    v_mul_f32_dpp v9, v9, v246 row_ror:8 row_mask:0xf bank_mask:0xf
    v_mfma_f32_16x16x32_bf16 v[208:211], a[88:91], a[24:27], v[208:211]
    v_mul_f32_dpp v10, v10, v246 row_ror:8 row_mask:0xf bank_mask:0xf
    v_mul_f32_dpp v11, v11, v246 row_ror:8 row_mask:0xf bank_mask:0xf
    v_mfma_f32_16x16x32_bf16 v[208:211], a[84:87], a[20:23], v[208:211]
    v_exp_f32 v204, v204
    v_mfma_f32_16x16x32_bf16 v[208:211], a[80:83], a[16:19], v[208:211]
    v_exp_f32 v205, v205
    v_mfma_f32_16x16x32_bf16 v[212:215], a[80:83], a[32:35], -4.0
    v_exp_f32 v206, v206
    v_mfma_f32_16x16x32_bf16 v[212:215], a[84:87], a[36:39], v[212:215]
    v_exp_f32 v207, v207
    v_mfma_f32_16x16x32_bf16 v[212:215], a[88:91], a[40:43], v[212:215]
    v_cvt_pk_bf16_f32 v162, v204, v205
    v_cvt_pk_bf16_f32 v163, v206, v207
    v_mfma_f32_16x16x32_bf16 v[212:215], a[92:95], a[44:47], v[212:215]
    v_exp_f32 v208, v208
    v_mfma_f32_16x16x32_bf16 v[16:19], a[96:99], v[164:167], v[16:19]
    v_exp_f32 v209, v209
    v_mfma_f32_16x16x32_bf16 v[48:51], a[96:99], v[172:175], v[48:51]
    v_exp_f32 v210, v210
    v_mfma_f32_16x16x32_bf16 v[80:83], a[96:99], v[180:183], v[80:83]
    v_exp_f32 v211, v211
    v_mfma_f32_16x16x32_bf16 v[112:115], a[96:99], v[188:191], v[112:115]
    v_cvt_pk_bf16_f32 v170, v208, v209
    v_cvt_pk_bf16_f32 v171, v210, v211
    v_mfma_f32_16x16x32_bf16 v[144:147], a[96:99], v[196:199], v[144:147]
    v_exp_f32 v212, v212
    v_mfma_f32_16x16x32_bf16 v[148:151], a[100:103], v[196:199], v[148:151]
    v_exp_f32 v213, v213
    v_mfma_f32_16x16x32_bf16 v[116:119], a[100:103], v[188:191], v[116:119]
    v_exp_f32 v214, v214
    v_mfma_f32_16x16x32_bf16 v[84:87], a[100:103], v[180:183], v[84:87]
    v_exp_f32 v215, v215
    v_mfma_f32_16x16x32_bf16 v[52:55], a[100:103], v[172:175], v[52:55]
    ds_read_b128 a[96:99], v236 offset:32768
    v_cvt_pk_bf16_f32 v178, v212, v213
    v_mfma_f32_16x16x32_bf16 v[20:23], a[100:103], v[164:167], v[20:23]
    ds_read_b128 a[100:103], v236 offset:33792
    v_cvt_pk_bf16_f32 v179, v214, v215
    v_mfma_f32_16x16x32_bf16 v[200:203], a[92:95], a[60:63], -4.0
    v_cvt_pk_bf16_f32 v220, v8, v9
    v_cvt_pk_bf16_f32 v221, v10, v11
    v_mfma_f32_16x16x32_bf16 v[200:203], a[88:91], a[56:59], v[200:203]
    v_mul_f32_dpp v12, v12, v246 row_ror:8 row_mask:0xf bank_mask:0xf
    v_mul_f32_dpp v13, v13, v246 row_ror:8 row_mask:0xf bank_mask:0xf
    v_mfma_f32_16x16x32_bf16 v[200:203], a[84:87], a[52:55], v[200:203]
    v_mul_f32_dpp v14, v14, v246 row_ror:8 row_mask:0xf bank_mask:0xf
    v_mul_f32_dpp v15, v15, v246 row_ror:8 row_mask:0xf bank_mask:0xf
    v_mfma_f32_16x16x32_bf16 v[200:203], a[80:83], a[48:51], v[200:203]
    v_cvt_pk_bf16_f32 v222, v12, v13
    v_cvt_pk_bf16_f32 v223, v14, v15
    v_mfma_f32_16x16x32_bf16 v[204:207], a[80:83], a[64:67], -4.0
    ds_read_b128 a[80:83], v228 offset:8192
    v_cndmask_b32 v240, v216, v220, vcc
    v_mfma_f32_16x16x32_bf16 v[204:207], a[84:87], a[68:71], v[204:207]
    ds_read_b128 a[84:87], v228 offset:8448
    v_cndmask_b32 v241, v217, v221, vcc
    v_mfma_f32_16x16x32_bf16 v[204:207], a[88:91], a[72:75], v[204:207]
    ds_read_b128 a[88:91], v228 offset:8704
    v_cndmask_b32 v220, v220, v216, vcc
    v_mfma_f32_16x16x32_bf16 v[204:207], a[92:95], a[76:79], v[204:207]
    v_exp_f32 v200, v200
    s_waitcnt lgkmcnt(4)
    v_mfma_f32_16x16x32_bf16 v[24:27], a[104:107], v[164:167], v[24:27]
    ds_read_b128 a[92:95], v228 offset:8960
    v_cndmask_b32 v221, v221, v217, vcc
    v_mfma_f32_16x16x32_bf16 v[56:59], a[104:107], v[172:175], v[56:59]
    v_exp_f32 v201, v201
    v_mfma_f32_16x16x32_bf16 v[88:91], a[104:107], v[180:183], v[88:91]
    v_exp_f32 v202, v202
    v_mfma_f32_16x16x32_bf16 v[120:123], a[104:107], v[188:191], v[120:123]
    v_exp_f32 v203, v203
    v_mfma_f32_16x16x32_bf16 v[152:155], a[104:107], v[196:199], v[152:155]
    ds_read_b128 a[104:107], v230 offset:32768
    v_cvt_pk_bf16_f32 v186, v200, v201
    v_mfma_f32_16x16x32_bf16 v[156:159], a[108:111], v[196:199], v[156:159]
    v_cvt_pk_bf16_f32 v187, v202, v203
    v_mul_f32 v16, v16, v224
    v_mfma_f32_16x16x32_bf16 v[124:127], a[108:111], v[188:191], v[124:127]
    v_exp_f32 v204, v204
    v_mfma_f32_16x16x32_bf16 v[92:95], a[108:111], v[180:183], v[92:95]
    v_exp_f32 v205, v205
    v_mfma_f32_16x16x32_bf16 v[60:63], a[108:111], v[172:175], v[60:63]
    v_exp_f32 v206, v206
    v_mfma_f32_16x16x32_bf16 v[28:31], a[108:111], v[164:167], v[28:31]
    v_exp_f32 v207, v207
    s_mov_b32 s28, 3
L_loop:
    v_smfmac_f32_16x16x64_bf16 a[116:119], a[132:135], v[168:175], v238
    s_waitcnt lgkmcnt(1)
    v_cvt_pk_bf16_f32 v194, v204, v205
    v_mfma_f32_16x16x32_bf16 v[208:211], a[80:83], a[0:3], -4.0
    ds_write_b64 v236, a[152:153] offset:49152
    v_mfma_f32_16x16x32_bf16 v[208:211], a[84:87], a[4:7], v[208:211]
    ds_read_b128 a[108:111], v230 offset:33792
    v_cvt_pk_bf16_f32 v195, v206, v207
    v_mfma_f32_16x16x32_bf16 v[208:211], a[88:91], a[8:11], v[208:211]
    ds_write_b64 v236, a[154:155] offset:49160
    v_mfma_f32_16x16x32_bf16 v[208:211], a[92:95], a[12:15], v[208:211]
    v_mul_f32 v17, v17, v224
    v_mul_f32 v18, v18, v224
    v_mfma_f32_16x16x32_bf16 v[212:215], a[92:95], a[28:31], -4.0
    ds_write_b64 v236, a[156:157] offset:50176
    v_mfma_f32_16x16x32_bf16 v[212:215], a[88:91], a[24:27], v[212:215]
    v_mul_f32 v19, v19, v224
    v_cvt_pk_bf16_f32 v216, v16, v17
    v_mfma_f32_16x16x32_bf16 v[212:215], a[84:87], a[20:23], v[212:215]
    v_exp_f32 v208, v208
    v_mfma_f32_16x16x32_bf16 v[212:215], a[80:83], a[16:19], v[212:215]
    v_exp_f32 v209, v209
    v_mfma_f32_16x16x32_bf16 v[200:203], a[80:83], a[32:35], -4.0
    v_exp_f32 v210, v210
    v_mfma_f32_16x16x32_bf16 v[200:203], a[84:87], a[36:39], v[200:203]
    v_exp_f32 v211, v211
    v_mfma_f32_16x16x32_bf16 v[200:203], a[88:91], a[40:43], v[200:203]
    v_cvt_pk_bf16_f32 v164, v208, v209
    v_cvt_pk_bf16_f32 v165, v210, v211
    v_mfma_f32_16x16x32_bf16 v[200:203], a[92:95], a[44:47], v[200:203]
    v_exp_f32 v212, v212
    v_mfma_f32_16x16x32_bf16 v[0:3], a[96:99], v[160:163], 0
    v_exp_f32 v213, v213
    v_mfma_f32_16x16x32_bf16 v[32:35], a[96:99], v[168:171], v[32:35]
    v_exp_f32 v214, v214
    v_mfma_f32_16x16x32_bf16 v[64:67], a[96:99], v[176:179], v[64:67]
    v_exp_f32 v215, v215
    v_mfma_f32_16x16x32_bf16 v[96:99], a[96:99], v[184:187], v[96:99]
    v_cvt_pk_bf16_f32 v172, v212, v213
    v_cvt_pk_bf16_f32 v173, v214, v215
    v_mfma_f32_16x16x32_bf16 v[128:131], a[96:99], v[192:195], v[128:131]
    v_exp_f32 v200, v200
    v_mfma_f32_16x16x32_bf16 v[132:135], a[100:103], v[192:195], v[132:135]
    v_exp_f32 v201, v201
    v_mfma_f32_16x16x32_bf16 v[100:103], a[100:103], v[184:187], v[100:103]
    v_exp_f32 v202, v202
    v_mfma_f32_16x16x32_bf16 v[68:71], a[100:103], v[176:179], v[68:71]
    v_exp_f32 v203, v203
    v_mfma_f32_16x16x32_bf16 v[36:39], a[100:103], v[168:171], v[36:39]
    ds_read_b128 a[96:99], v231 offset:32768
    v_cvt_pk_bf16_f32 v180, v200, v201
    v_mfma_f32_16x16x32_bf16 v[4:7], a[100:103], v[160:163], 0
    ds_read_b128 a[100:103], v231 offset:33792
    v_cvt_pk_bf16_f32 v181, v202, v203
    v_smfmac_f32_16x16x64_bf16 a[124:127], a[132:135], v[184:191], v238
    ds_write_b64 v236, a[158:159] offset:50184
    v_mfma_f32_16x16x32_bf16 v[204:207], a[92:95], a[60:63], -4.0
    v_cvt_pk_bf16_f32 v217, v18, v19
    v_cndmask_b32 v242, v218, v222, vcc
    v_mfma_f32_16x16x32_bf16 v[204:207], a[88:91], a[56:59], v[204:207]
    v_cndmask_b32 v243, v219, v223, vcc
    v_cndmask_b32 v222, v222, v218, vcc
    v_mfma_f32_16x16x32_bf16 v[204:207], a[84:87], a[52:55], v[204:207]
    buffer_store_dwordx4 v[240:243], v244, s[16:19], s26 offen nt
    v_mfma_f32_16x16x32_bf16 v[204:207], a[80:83], a[48:51], v[204:207]
    v_cndmask_b32 v223, v223, v219, vcc
    v_mul_f32 v20, v20, v224
    v_mfma_f32_16x16x32_bf16 v[208:211], a[80:83], a[64:67], -4.0
    ds_read_b128 a[80:83], v228 offset:12288
    v_mul_f32 v21, v21, v224
    v_mfma_f32_16x16x32_bf16 v[208:211], a[84:87], a[68:71], v[208:211]
    ds_read_b128 a[84:87], v228 offset:12544
    v_mul_f32 v22, v22, v224
    v_mfma_f32_16x16x32_bf16 v[208:211], a[88:91], a[72:75], v[208:211]
    ds_read_b128 a[88:91], v228 offset:12800
    v_mul_f32 v23, v23, v224
    v_mfma_f32_16x16x32_bf16 v[208:211], a[92:95], a[76:79], v[208:211]
    s_waitcnt lgkmcnt(3)
    v_exp_f32 v204, v204
    v_mfma_f32_16x16x32_bf16 v[8:11], a[104:107], v[160:163], 0
    ds_read_b128 a[92:95], v228 offset:13056
    v_cvt_pk_bf16_f32 v218, v20, v21
    v_mfma_f32_16x16x32_bf16 v[40:43], a[104:107], v[168:171], v[40:43]
    buffer_store_dwordx4 v[220:223], v245, s[16:19], s26 offen nt
    v_mfma_f32_16x16x32_bf16 v[72:75], a[104:107], v[176:179], v[72:75]
    v_exp_f32 v205, v205
    v_mfma_f32_16x16x32_bf16 v[104:107], a[104:107], v[184:187], v[104:107]
    s_add_u32 s26, s26, 16384
    v_exp_f32 v206, v206
    v_mfma_f32_16x16x32_bf16 v[136:139], a[104:107], v[192:195], v[136:139]
    v_exp_f32 v207, v207
    v_mfma_f32_16x16x32_bf16 v[140:143], a[108:111], v[192:195], v[140:143]
    ds_read_b128 a[104:107], v239 offset:32768
    v_cvt_pk_bf16_f32 v188, v204, v205
    v_mfma_f32_16x16x32_bf16 v[108:111], a[108:111], v[184:187], v[108:111]
    v_cvt_pk_bf16_f32 v189, v206, v207
    v_cvt_pk_bf16_f32 v219, v22, v23
    v_mfma_f32_16x16x32_bf16 v[76:79], a[108:111], v[176:179], v[76:79]
    v_exp_f32 v208, v208
    v_mfma_f32_16x16x32_bf16 v[44:47], a[108:111], v[168:171], v[44:47]
    v_exp_f32 v209, v209
    v_mfma_f32_16x16x32_bf16 v[12:15], a[108:111], v[160:163], 0
    s_waitcnt lgkmcnt(1)
    v_exp_f32 v210, v210
    v_mfma_f32_16x16x32_bf16 v[212:215], a[80:83], a[0:3], -4.0
    v_exp_f32 v211, v211
    v_mfma_f32_16x16x32_bf16 v[212:215], a[84:87], a[4:7], v[212:215]
    ds_read_b128 a[108:111], v239 offset:33792
    v_cvt_pk_bf16_f32 v196, v208, v209
    v_mfma_f32_16x16x32_bf16 v[212:215], a[88:91], a[8:11], v[212:215]
    v_cvt_pk_bf16_f32 v197, v210, v211
    v_mul_f32_dpp v24, v24, v246 row_ror:8 row_mask:0xf bank_mask:0xf
    v_mfma_f32_16x16x32_bf16 v[212:215], a[92:95], a[12:15], v[212:215]
    v_mul_f32_dpp v25, v25, v246 row_ror:8 row_mask:0xf bank_mask:0xf
    v_mul_f32_dpp v26, v26, v246 row_ror:8 row_mask:0xf bank_mask:0xf
    v_mfma_f32_16x16x32_bf16 v[200:203], a[92:95], a[28:31], -4.0
    v_mul_f32_dpp v27, v27, v246 row_ror:8 row_mask:0xf bank_mask:0xf
    v_cvt_pk_bf16_f32 v232, v24, v25
    v_mfma_f32_16x16x32_bf16 v[200:203], a[88:91], a[24:27], v[200:203]
    v_cvt_pk_bf16_f32 v233, v26, v27
    v_mul_f32_dpp v28, v28, v246 row_ror:8 row_mask:0xf bank_mask:0xf
    v_mfma_f32_16x16x32_bf16 v[200:203], a[84:87], a[20:23], v[200:203]
    v_exp_f32 v212, v212
    v_mfma_f32_16x16x32_bf16 v[200:203], a[80:83], a[16:19], v[200:203]
    v_exp_f32 v213, v213
    v_mfma_f32_16x16x32_bf16 v[204:207], a[80:83], a[32:35], -4.0
    v_exp_f32 v214, v214
    v_mfma_f32_16x16x32_bf16 v[204:207], a[84:87], a[36:39], v[204:207]
    v_exp_f32 v215, v215
    v_mfma_f32_16x16x32_bf16 v[204:207], a[88:91], a[40:43], v[204:207]
    v_cvt_pk_bf16_f32 v166, v212, v213
    v_cvt_pk_bf16_f32 v167, v214, v215
    v_mfma_f32_16x16x32_bf16 v[204:207], a[92:95], a[44:47], v[204:207]
    v_mul_f32_dpp v29, v29, v246 row_ror:8 row_mask:0xf bank_mask:0xf
    v_mul_f32_dpp v30, v30, v246 row_ror:8 row_mask:0xf bank_mask:0xf
    v_mfma_f32_16x16x32_bf16 v[16:19], a[96:99], v[160:163], 0
    v_mul_f32_dpp v31, v31, v246 row_ror:8 row_mask:0xf bank_mask:0xf
    v_cvt_pk_bf16_f32 v234, v28, v29
    v_mfma_f32_16x16x32_bf16 v[48:51], a[96:99], v[168:171], v[48:51]
    v_cvt_pk_bf16_f32 v235, v30, v31
    v_cndmask_b32 v240, v216, v232, vcc
    v_mfma_f32_16x16x32_bf16 v[80:83], a[96:99], v[176:179], v[80:83]
    v_exp_f32 v204, v204
    v_mfma_f32_16x16x32_bf16 v[112:115], a[96:99], v[184:187], v[112:115]
    v_exp_f32 v205, v205
    v_mfma_f32_16x16x32_bf16 v[144:147], a[96:99], v[192:195], v[144:147]
    v_exp_f32 v206, v206
    v_mfma_f32_16x16x32_bf16 v[148:151], a[100:103], v[192:195], v[148:151]
    v_exp_f32 v207, v207
    v_mfma_f32_16x16x32_bf16 v[116:119], a[100:103], v[184:187], v[116:119]
    ds_read_b128 a[96:99], v236 offset:40960
    v_cvt_pk_bf16_f32 v182, v204, v205
    v_mfma_f32_16x16x32_bf16 v[84:87], a[100:103], v[176:179], v[84:87]
    v_cvt_pk_bf16_f32 v183, v206, v207
    v_cndmask_b32 v241, v217, v233, vcc
    v_mfma_f32_16x16x32_bf16 v[52:55], a[100:103], v[168:171], v[52:55]
    v_exp_f32 v200, v200
    v_mfma_f32_16x16x32_bf16 v[20:23], a[100:103], v[160:163], 0
    v_exp_f32 v201, v201
    v_smfmac_f32_16x16x64_bf16 a[112:115], a[132:135], v[160:167], v238
    ds_read_b128 a[100:103], v236 offset:41984
    v_cvt_pk_bf16_f32 v174, v200, v201
    v_mfma_f32_16x16x32_bf16 v[208:211], a[92:95], a[60:63], -4.0
    v_exp_f32 v202, v202
    v_mfma_f32_16x16x32_bf16 v[208:211], a[88:91], a[56:59], v[208:211]
    v_exp_f32 v203, v203
    v_mfma_f32_16x16x32_bf16 v[208:211], a[84:87], a[52:55], v[208:211]
    v_cvt_pk_bf16_f32 v175, v202, v203
    v_cndmask_b32 v242, v218, v234, vcc
    v_mfma_f32_16x16x32_bf16 v[208:211], a[80:83], a[48:51], v[208:211]
    v_cndmask_b32 v243, v219, v235, vcc
    v_cndmask_b32 v232, v232, v216, vcc
    v_mfma_f32_16x16x32_bf16 v[212:215], a[80:83], a[64:67], -4.0
    ds_read_b128 a[80:83], v228 offset:16384
    v_cndmask_b32 v233, v233, v217, vcc
    v_mfma_f32_16x16x32_bf16 v[212:215], a[84:87], a[68:71], v[212:215]
    ds_read_b128 a[84:87], v228 offset:16640
    v_cndmask_b32 v234, v234, v218, vcc
    v_mfma_f32_16x16x32_bf16 v[212:215], a[88:91], a[72:75], v[212:215]
    buffer_store_dwordx4 v[240:243], v244, s[16:19], s42 offen nt
    v_mfma_f32_16x16x32_bf16 v[212:215], a[92:95], a[76:79], v[212:215]
    s_waitcnt lgkmcnt(3)
    v_exp_f32 v208, v208
    v_mfma_f32_16x16x32_bf16 v[24:27], a[104:107], v[160:163], 0
    ds_read_b128 a[88:91], v228 offset:16896
    v_cndmask_b32 v235, v235, v219, vcc
    v_mfma_f32_16x16x32_bf16 v[56:59], a[104:107], v[168:171], v[56:59]
    ds_read_b128 a[92:95], v228 offset:17152
    v_mfma_f32_16x16x32_bf16 v[88:91], a[104:107], v[176:179], v[88:91]
    buffer_store_dwordx4 v[232:235], v245, s[16:19], s42 offen nt
    v_mfma_f32_16x16x32_bf16 v[120:123], a[104:107], v[184:187], v[120:123]
    v_exp_f32 v209, v209
    v_mfma_f32_16x16x32_bf16 v[152:155], a[104:107], v[192:195], v[152:155]
    s_add_u32 s42, s42, 16384
    v_exp_f32 v210, v210
    v_mfma_f32_16x16x32_bf16 v[156:159], a[108:111], v[192:195], v[156:159]
    v_exp_f32 v211, v211
    v_mfma_f32_16x16x32_bf16 v[124:127], a[108:111], v[184:187], v[124:127]
    ds_read_b128 a[104:107], v230 offset:40960
    v_cvt_pk_bf16_f32 v190, v208, v209
    v_mfma_f32_16x16x32_bf16 v[92:95], a[108:111], v[176:179], v[92:95]
    v_cvt_pk_bf16_f32 v191, v210, v211
    v_mfma_f32_16x16x32_bf16 v[60:63], a[108:111], v[168:171], v[60:63]
    v_exp_f32 v212, v212
    v_mfma_f32_16x16x32_bf16 v[28:31], a[108:111], v[160:163], 0
    v_exp_f32 v213, v213
    v_smfmac_f32_16x16x64_bf16 a[120:123], a[132:135], v[176:183], v238
    s_waitcnt lgkmcnt(1)
    v_cvt_pk_bf16_f32 v198, v212, v213
    v_mfma_f32_16x16x32_bf16 v[200:203], a[80:83], a[0:3], -4.0
    v_exp_f32 v214, v214
    v_mfma_f32_16x16x32_bf16 v[200:203], a[84:87], a[4:7], v[200:203]
    v_exp_f32 v215, v215
    v_mfma_f32_16x16x32_bf16 v[200:203], a[88:91], a[8:11], v[200:203]
    ds_read_b128 a[108:111], v230 offset:41984
    v_cvt_pk_bf16_f32 v199, v214, v215
    v_mfma_f32_16x16x32_bf16 v[200:203], a[92:95], a[12:15], v[200:203]
    v_mfma_f32_16x16x32_bf16 v[204:207], a[92:95], a[28:31], -4.0
    v_mfma_f32_16x16x32_bf16 v[204:207], a[88:91], a[24:27], v[204:207]
    v_mfma_f32_16x16x32_bf16 v[204:207], a[84:87], a[20:23], v[204:207]
    v_mfma_f32_16x16x32_bf16 v[204:207], a[80:83], a[16:19], v[204:207]
    v_mfma_f32_16x16x32_bf16 v[208:211], a[80:83], a[32:35], -4.0
    v_mfma_f32_16x16x32_bf16 v[208:211], a[84:87], a[36:39], v[208:211]
    v_mfma_f32_16x16x32_bf16 v[208:211], a[88:91], a[40:43], v[208:211]
    v_mfma_f32_16x16x32_bf16 v[208:211], a[92:95], a[44:47], v[208:211]
    v_exp_f32 v200, v200
    v_mfma_f32_16x16x32_bf16 v[0:3], a[96:99], v[164:167], v[0:3]
    v_exp_f32 v201, v201
    v_mfma_f32_16x16x32_bf16 v[32:35], a[96:99], v[172:175], v[32:35]
    v_exp_f32 v202, v202
    v_mfma_f32_16x16x32_bf16 v[64:67], a[96:99], v[180:183], v[64:67]
    v_exp_f32 v203, v203
    v_mfma_f32_16x16x32_bf16 v[96:99], a[96:99], v[188:191], v[96:99]
    v_cvt_pk_bf16_f32 v160, v200, v201
    v_cvt_pk_bf16_f32 v161, v202, v203
    v_mfma_f32_16x16x32_bf16 v[128:131], a[96:99], v[196:199], v[128:131]
    v_exp_f32 v204, v204
    v_mfma_f32_16x16x32_bf16 v[132:135], a[100:103], v[196:199], v[132:135]
    v_exp_f32 v205, v205
    v_mfma_f32_16x16x32_bf16 v[100:103], a[100:103], v[188:191], v[100:103]
    v_exp_f32 v206, v206
    v_mfma_f32_16x16x32_bf16 v[68:71], a[100:103], v[180:183], v[68:71]
    v_exp_f32 v207, v207
    v_mfma_f32_16x16x32_bf16 v[36:39], a[100:103], v[172:175], v[36:39]
    ds_read_b128 a[96:99], v231 offset:40960
    v_cvt_pk_bf16_f32 v168, v204, v205
    v_mfma_f32_16x16x32_bf16 v[4:7], a[100:103], v[164:167], v[4:7]
    ds_read_b128 a[100:103], v231 offset:41984
    v_cvt_pk_bf16_f32 v169, v206, v207
    v_smfmac_f32_16x16x64_bf16 a[128:131], a[132:135], v[192:199], v238
    v_mfma_f32_16x16x32_bf16 v[212:215], a[92:95], a[60:63], -4.0
    v_exp_f32 v208, v208
    v_mfma_f32_16x16x32_bf16 v[212:215], a[88:91], a[56:59], v[212:215]
    v_exp_f32 v209, v209
    v_mfma_f32_16x16x32_bf16 v[212:215], a[84:87], a[52:55], v[212:215]
    v_exp_f32 v210, v210
    v_mfma_f32_16x16x32_bf16 v[212:215], a[80:83], a[48:51], v[212:215]
    v_exp_f32 v211, v211
    v_mfma_f32_16x16x32_bf16 v[200:203], a[80:83], a[64:67], -4.0
    ds_read_b128 a[80:83], v228 offset:20480
    v_cvt_pk_bf16_f32 v176, v208, v209
    v_mfma_f32_16x16x32_bf16 v[200:203], a[84:87], a[68:71], v[200:203]
    ds_read_b128 a[84:87], v228 offset:20736
    v_cvt_pk_bf16_f32 v177, v210, v211
    v_mfma_f32_16x16x32_bf16 v[200:203], a[88:91], a[72:75], v[200:203]
    ds_read_b128 a[88:91], v228 offset:20992
    v_mfma_f32_16x16x32_bf16 v[200:203], a[92:95], a[76:79], v[200:203]
    s_waitcnt lgkmcnt(4)
    v_exp_f32 v212, v212
    v_mfma_f32_16x16x32_bf16 v[8:11], a[104:107], v[164:167], v[8:11]
    ds_read_b128 a[92:95], v228 offset:21248
    v_mfma_f32_16x16x32_bf16 v[40:43], a[104:107], v[172:175], v[40:43]
    v_exp_f32 v213, v213
    v_mfma_f32_16x16x32_bf16 v[72:75], a[104:107], v[180:183], v[72:75]
    v_exp_f32 v214, v214
    v_mfma_f32_16x16x32_bf16 v[104:107], a[104:107], v[188:191], v[104:107]
    v_exp_f32 v215, v215
    v_mfma_f32_16x16x32_bf16 v[136:139], a[104:107], v[196:199], v[136:139]
    ds_read_b128 a[104:107], v239 offset:40960
    v_cvt_pk_bf16_f32 v184, v212, v213
    v_mfma_f32_16x16x32_bf16 v[140:143], a[108:111], v[196:199], v[140:143]
    v_cvt_pk_bf16_f32 v185, v214, v215
    v_mfma_f32_16x16x32_bf16 v[108:111], a[108:111], v[188:191], v[108:111]
    v_exp_f32 v200, v200
    v_mfma_f32_16x16x32_bf16 v[76:79], a[108:111], v[180:183], v[76:79]
    v_exp_f32 v201, v201
    v_mfma_f32_16x16x32_bf16 v[44:47], a[108:111], v[172:175], v[44:47]
    v_exp_f32 v202, v202
    v_mfma_f32_16x16x32_bf16 v[12:15], a[108:111], v[164:167], v[12:15]
    s_waitcnt lgkmcnt(2)
    v_exp_f32 v203, v203
    v_mfma_f32_16x16x32_bf16 v[204:207], a[80:83], a[0:3], -4.0
    ds_read_b128 a[108:111], v239 offset:41984
    v_cvt_pk_bf16_f32 v192, v200, v201
    v_mfma_f32_16x16x32_bf16 v[204:207], a[84:87], a[4:7], v[204:207]
    v_cvt_pk_bf16_f32 v193, v202, v203
    v_mfma_f32_16x16x32_bf16 v[204:207], a[88:91], a[8:11], v[204:207]
    s_waitcnt lgkmcnt(2)
    v_mfma_f32_16x16x32_bf16 v[204:207], a[92:95], a[12:15], v[204:207]
    v_mfma_f32_16x16x32_bf16 v[208:211], a[92:95], a[28:31], -4.0
    s_waitcnt vmcnt(4)
    v_accvgpr_mov_b32 a28, a252
    v_accvgpr_mov_b32 a29, a253
    v_mfma_f32_16x16x32_bf16 v[208:211], a[88:91], a[24:27], v[208:211]
    v_accvgpr_mov_b32 a30, a254
    v_accvgpr_mov_b32 a31, a255
    v_mfma_f32_16x16x32_bf16 v[208:211], a[84:87], a[20:23], v[208:211]
    v_exp_f32 v204, v204
    v_mfma_f32_16x16x32_bf16 v[208:211], a[80:83], a[16:19], v[208:211]
    v_exp_f32 v205, v205
    v_mfma_f32_16x16x32_bf16 v[212:215], a[80:83], a[32:35], -4.0
    v_exp_f32 v206, v206
    v_mfma_f32_16x16x32_bf16 v[212:215], a[84:87], a[36:39], v[212:215]
    v_exp_f32 v207, v207
    v_mfma_f32_16x16x32_bf16 v[212:215], a[88:91], a[40:43], v[212:215]
    v_cvt_pk_bf16_f32 v162, v204, v205
    v_cvt_pk_bf16_f32 v163, v206, v207
    v_mfma_f32_16x16x32_bf16 v[212:215], a[92:95], a[44:47], v[212:215]
    v_exp_f32 v208, v208
    v_mfma_f32_16x16x32_bf16 v[16:19], a[96:99], v[164:167], v[16:19]
    v_exp_f32 v209, v209
    v_mfma_f32_16x16x32_bf16 v[48:51], a[96:99], v[172:175], v[48:51]
    v_exp_f32 v210, v210
    v_mfma_f32_16x16x32_bf16 v[80:83], a[96:99], v[180:183], v[80:83]
    v_exp_f32 v211, v211
    v_mfma_f32_16x16x32_bf16 v[112:115], a[96:99], v[188:191], v[112:115]
    v_cvt_pk_bf16_f32 v170, v208, v209
    v_cvt_pk_bf16_f32 v171, v210, v211
    v_mfma_f32_16x16x32_bf16 v[144:147], a[96:99], v[196:199], v[144:147]
    v_exp_f32 v212, v212
    v_mfma_f32_16x16x32_bf16 v[148:151], a[100:103], v[196:199], v[148:151]
    v_exp_f32 v213, v213
    v_mfma_f32_16x16x32_bf16 v[116:119], a[100:103], v[188:191], v[116:119]
    v_exp_f32 v214, v214
    v_mfma_f32_16x16x32_bf16 v[84:87], a[100:103], v[180:183], v[84:87]
    v_exp_f32 v215, v215
    v_mfma_f32_16x16x32_bf16 v[52:55], a[100:103], v[172:175], v[52:55]
    v_cvt_pk_bf16_f32 v178, v212, v213
    v_cvt_pk_bf16_f32 v179, v214, v215
    v_mfma_f32_16x16x32_bf16 v[20:23], a[100:103], v[164:167], v[20:23]
    v_accvgpr_mov_b32 a24, a248
    v_accvgpr_mov_b32 a25, a249
    v_mfma_f32_16x16x32_bf16 v[200:203], a[92:95], a[60:63], -4.0
    v_accvgpr_mov_b32 a26, a250
    v_accvgpr_mov_b32 a27, a251
    v_mfma_f32_16x16x32_bf16 v[200:203], a[88:91], a[56:59], v[200:203]
    v_accvgpr_mov_b32 a20, a244
    v_accvgpr_mov_b32 a21, a245
    v_mfma_f32_16x16x32_bf16 v[200:203], a[84:87], a[52:55], v[200:203]
    v_accvgpr_mov_b32 a22, a246
    v_accvgpr_mov_b32 a23, a247
    v_mfma_f32_16x16x32_bf16 v[200:203], a[80:83], a[48:51], v[200:203]
    v_accvgpr_mov_b32 a16, a240
    v_accvgpr_mov_b32 a17, a241
    v_mfma_f32_16x16x32_bf16 v[204:207], a[80:83], a[64:67], -4.0
    ds_read_b128 a[80:83], v228 offset:24576
    v_accvgpr_mov_b32 a18, a242
    v_mfma_f32_16x16x32_bf16 v[204:207], a[84:87], a[68:71], v[204:207]
    ds_read_b128 a[84:87], v228 offset:24832
    v_accvgpr_mov_b32 a19, a243
    v_mfma_f32_16x16x32_bf16 v[204:207], a[88:91], a[72:75], v[204:207]
    ds_read_b128 a[88:91], v228 offset:25088
    v_mfma_f32_16x16x32_bf16 v[204:207], a[92:95], a[76:79], v[204:207]
    s_waitcnt lgkmcnt(3)
    v_exp_f32 v200, v200
    v_mfma_f32_16x16x32_bf16 v[24:27], a[104:107], v[164:167], v[24:27]
    ds_read_b128 a[92:95], v228 offset:25344
    v_mfma_f32_16x16x32_bf16 v[56:59], a[104:107], v[172:175], v[56:59]
    v_exp_f32 v201, v201
    v_mfma_f32_16x16x32_bf16 v[88:91], a[104:107], v[180:183], v[88:91]
    v_exp_f32 v202, v202
    v_mfma_f32_16x16x32_bf16 v[120:123], a[104:107], v[188:191], v[120:123]
    v_exp_f32 v203, v203
    v_mfma_f32_16x16x32_bf16 v[152:155], a[104:107], v[196:199], v[152:155]
    v_cvt_pk_bf16_f32 v186, v200, v201
    v_cvt_pk_bf16_f32 v187, v202, v203
    v_mfma_f32_16x16x32_bf16 v[156:159], a[108:111], v[196:199], v[156:159]
    v_exp_f32 v204, v204
    v_mfma_f32_16x16x32_bf16 v[124:127], a[108:111], v[188:191], v[124:127]
    v_exp_f32 v205, v205
    v_mfma_f32_16x16x32_bf16 v[92:95], a[108:111], v[180:183], v[92:95]
    v_exp_f32 v206, v206
    v_mfma_f32_16x16x32_bf16 v[60:63], a[108:111], v[172:175], v[60:63]
    v_exp_f32 v207, v207
    v_mfma_f32_16x16x32_bf16 v[28:31], a[108:111], v[164:167], v[28:31]
    v_cvt_pk_bf16_f32 v194, v204, v205
    v_cvt_pk_bf16_f32 v195, v206, v207
    v_smfmac_f32_16x16x64_bf16 a[116:119], a[132:135], v[168:175], v238
    s_waitcnt lgkmcnt(0)
    s_add_u32 s4, s4, 16384
    s_addc_u32 s5, s5, 0
    v_mfma_f32_16x16x32_bf16 v[208:211], a[80:83], a[0:3], -4.0
    global_load_dwordx4 a[240:243], v237, s[4:5] offset:0
    v_mfma_f32_16x16x32_bf16 v[208:211], a[84:87], a[4:7], v[208:211]
    global_load_dwordx4 a[244:247], v237, s[4:5] offset:64
    v_mfma_f32_16x16x32_bf16 v[208:211], a[88:91], a[8:11], v[208:211]
    v_accvgpr_read_b32 v225, a116
    v_accvgpr_read_b32 v226, a117
    v_mfma_f32_16x16x32_bf16 v[208:211], a[92:95], a[12:15], v[208:211]
    v_add_f32 v226, v226, v225
    v_accvgpr_write_b32 a116, 0
    v_mfma_f32_16x16x32_bf16 v[212:215], a[92:95], a[28:31], -4.0
    v_rcp_f32 v225, v226
    v_mfma_f32_16x16x32_bf16 v[212:215], a[88:91], a[24:27], v[212:215]
    global_load_dwordx4 a[248:251], v237, s[4:5] offset:128
    v_mfma_f32_16x16x32_bf16 v[212:215], a[84:87], a[20:23], v[212:215]
    global_load_dwordx4 a[252:255], v237, s[4:5] offset:192
    v_mfma_f32_16x16x32_bf16 v[212:215], a[80:83], a[16:19], v[212:215]
    s_barrier
    v_mfma_f32_16x16x32_bf16 v[200:203], a[80:83], a[32:35], -4.0
    ds_write_b64 v236, a[160:161] offset:57344
    v_mfma_f32_16x16x32_bf16 v[200:203], a[84:87], a[36:39], v[200:203]
    ds_read_b128 a[104:107], v230 offset:49152
    v_mov_b32_dpp v246, v225 row_ror:8 row_mask:0xf bank_mask:0xf
    v_mfma_f32_16x16x32_bf16 v[200:203], a[88:91], a[40:43], v[200:203]
    v_exp_f32 v208, v208
    v_mfma_f32_16x16x32_bf16 v[200:203], a[92:95], a[44:47], v[200:203]
    v_exp_f32 v209, v209
    v_mfma_f32_16x16x32_bf16 v[0:3], a[152:155], v[160:163], v[0:3]
    v_exp_f32 v210, v210
    v_mfma_f32_16x16x32_bf16 v[32:35], a[152:155], v[168:171], v[32:35]
    v_exp_f32 v211, v211
    v_mfma_f32_16x16x32_bf16 v[64:67], a[152:155], v[176:179], v[64:67]
    ds_read_b128 a[108:111], v230 offset:50176
    v_cvt_pk_bf16_f32 v164, v208, v209
    v_mfma_f32_16x16x32_bf16 v[96:99], a[152:155], v[184:187], v[96:99]
    ds_read_b128 a[96:99], v231 offset:49152
    v_cvt_pk_bf16_f32 v165, v210, v211
    v_mfma_f32_16x16x32_bf16 v[128:131], a[152:155], v[192:195], v[128:131]
    ds_write_b64 v236, a[162:163] offset:57352
    v_mfma_f32_16x16x32_bf16 v[132:135], a[156:159], v[192:195], v[132:135]
    v_exp_f32 v212, v212
    v_mfma_f32_16x16x32_bf16 v[100:103], a[156:159], v[184:187], v[100:103]
    v_exp_f32 v213, v213
    v_mfma_f32_16x16x32_bf16 v[68:71], a[156:159], v[176:179], v[68:71]
    v_exp_f32 v214, v214
    v_mfma_f32_16x16x32_bf16 v[36:39], a[156:159], v[168:171], v[36:39]
    v_exp_f32 v215, v215
    v_mfma_f32_16x16x32_bf16 v[4:7], a[156:159], v[160:163], v[4:7]
    ds_read_b128 a[100:103], v231 offset:50176
    v_cvt_pk_bf16_f32 v172, v212, v213
    v_smfmac_f32_16x16x64_bf16 a[124:127], a[132:135], v[184:191], v238
    v_cvt_pk_bf16_f32 v173, v214, v215
    v_mfma_f32_16x16x32_bf16 v[204:207], a[92:95], a[60:63], -4.0
    v_exp_f32 v200, v200
    v_mfma_f32_16x16x32_bf16 v[204:207], a[88:91], a[56:59], v[204:207]
    v_exp_f32 v201, v201
    v_mfma_f32_16x16x32_bf16 v[204:207], a[84:87], a[52:55], v[204:207]
    v_exp_f32 v202, v202
    v_mfma_f32_16x16x32_bf16 v[204:207], a[80:83], a[48:51], v[204:207]
    v_exp_f32 v203, v203
    v_mfma_f32_16x16x32_bf16 v[208:211], a[80:83], a[64:67], -4.0
    ds_read_b128 a[80:83], v228 offset:28672
    v_cvt_pk_bf16_f32 v180, v200, v201
    v_mfma_f32_16x16x32_bf16 v[208:211], a[84:87], a[68:71], v[208:211]
    ds_read_b128 a[84:87], v228 offset:28928
    v_cvt_pk_bf16_f32 v181, v202, v203
    v_mfma_f32_16x16x32_bf16 v[208:211], a[88:91], a[72:75], v[208:211]
    ds_read_b128 a[88:91], v228 offset:29184
    v_mul_f32 v32, v32, v225
    v_mfma_f32_16x16x32_bf16 v[208:211], a[92:95], a[76:79], v[208:211]
    s_waitcnt lgkmcnt(4)
    v_exp_f32 v204, v204
    v_mfma_f32_16x16x32_bf16 v[8:11], a[104:107], v[160:163], v[8:11]
    ds_read_b128 a[92:95], v228 offset:29440
    v_mul_f32 v33, v33, v225
    v_mfma_f32_16x16x32_bf16 v[40:43], a[104:107], v[168:171], v[40:43]
    ds_write_b64 v236, a[164:165] offset:58368
    v_mfma_f32_16x16x32_bf16 v[72:75], a[104:107], v[176:179], v[72:75]
    v_exp_f32 v205, v205
    v_mfma_f32_16x16x32_bf16 v[104:107], a[104:107], v[184:187], v[104:107]
    v_exp_f32 v206, v206
    v_mfma_f32_16x16x32_bf16 v[136:139], a[104:107], v[192:195], v[136:139]
    v_exp_f32 v207, v207
    v_mfma_f32_16x16x32_bf16 v[140:143], a[108:111], v[192:195], v[140:143]
    ds_read_b128 a[104:107], v239 offset:49152
    v_cvt_pk_bf16_f32 v188, v204, v205
    v_mfma_f32_16x16x32_bf16 v[108:111], a[108:111], v[184:187], v[108:111]
    v_cvt_pk_bf16_f32 v189, v206, v207
    v_mul_f32 v34, v34, v225
    v_mfma_f32_16x16x32_bf16 v[76:79], a[108:111], v[176:179], v[76:79]
    ds_write_b64 v236, a[166:167] offset:58376
    v_mfma_f32_16x16x32_bf16 v[44:47], a[108:111], v[168:171], v[44:47]
    v_exp_f32 v208, v208
    v_mfma_f32_16x16x32_bf16 v[12:15], a[108:111], v[160:163], v[12:15]
    s_waitcnt lgkmcnt(3)
    v_exp_f32 v209, v209
    v_mfma_f32_16x16x32_bf16 v[212:215], a[80:83], a[0:3], -4.0
    v_exp_f32 v210, v210
    v_mfma_f32_16x16x32_bf16 v[212:215], a[84:87], a[4:7], v[212:215]
    v_exp_f32 v211, v211
    v_mfma_f32_16x16x32_bf16 v[212:215], a[88:91], a[8:11], v[212:215]
    ds_read_b128 a[108:111], v239 offset:50176
    v_cvt_pk_bf16_f32 v196, v208, v209
    v_mfma_f32_16x16x32_bf16 v[212:215], a[92:95], a[12:15], v[212:215]
    v_cvt_pk_bf16_f32 v197, v210, v211
    v_mul_f32 v35, v35, v225
    v_mfma_f32_16x16x32_bf16 v[200:203], a[92:95], a[28:31], -4.0
    v_cvt_pk_bf16_f32 v216, v32, v33
    v_cvt_pk_bf16_f32 v217, v34, v35
    v_mfma_f32_16x16x32_bf16 v[200:203], a[88:91], a[24:27], v[200:203]
    v_mul_f32 v36, v36, v225
    v_mul_f32 v37, v37, v225
    v_mfma_f32_16x16x32_bf16 v[200:203], a[84:87], a[20:23], v[200:203]
    v_exp_f32 v212, v212
    v_mfma_f32_16x16x32_bf16 v[200:203], a[80:83], a[16:19], v[200:203]
    v_exp_f32 v213, v213
    v_mfma_f32_16x16x32_bf16 v[204:207], a[80:83], a[32:35], -4.0
    v_exp_f32 v214, v214
    v_mfma_f32_16x16x32_bf16 v[204:207], a[84:87], a[36:39], v[204:207]
    v_exp_f32 v215, v215
    v_mfma_f32_16x16x32_bf16 v[204:207], a[88:91], a[40:43], v[204:207]
    v_cvt_pk_bf16_f32 v166, v212, v213
    v_cvt_pk_bf16_f32 v167, v214, v215
    v_mfma_f32_16x16x32_bf16 v[204:207], a[92:95], a[44:47], v[204:207]
    v_exp_f32 v200, v200
    v_mfma_f32_16x16x32_bf16 v[16:19], a[96:99], v[160:163], v[16:19]
    v_exp_f32 v201, v201
    v_mfma_f32_16x16x32_bf16 v[48:51], a[96:99], v[168:171], v[48:51]
    v_exp_f32 v202, v202
    v_mfma_f32_16x16x32_bf16 v[80:83], a[96:99], v[176:179], v[80:83]
    v_exp_f32 v203, v203
    v_mfma_f32_16x16x32_bf16 v[112:115], a[96:99], v[184:187], v[112:115]
    v_exp_f32 v204, v204
    v_mfma_f32_16x16x32_bf16 v[144:147], a[96:99], v[192:195], v[144:147]
    v_exp_f32 v205, v205
    v_mfma_f32_16x16x32_bf16 v[148:151], a[100:103], v[192:195], v[148:151]
    v_exp_f32 v206, v206
    v_mfma_f32_16x16x32_bf16 v[116:119], a[100:103], v[184:187], v[116:119]
    v_exp_f32 v207, v207
    v_mfma_f32_16x16x32_bf16 v[84:87], a[100:103], v[176:179], v[84:87]
    v_cvt_pk_bf16_f32 v182, v204, v205
    v_cvt_pk_bf16_f32 v183, v206, v207
    v_mfma_f32_16x16x32_bf16 v[52:55], a[100:103], v[168:171], v[52:55]
    v_cvt_pk_bf16_f32 v174, v200, v201
    v_cvt_pk_bf16_f32 v175, v202, v203
    v_mfma_f32_16x16x32_bf16 v[20:23], a[100:103], v[160:163], v[20:23]
    v_mul_f32 v38, v38, v225
    v_mul_f32 v39, v39, v225
    v_smfmac_f32_16x16x64_bf16 a[112:115], a[132:135], v[160:167], v238
    v_cvt_pk_bf16_f32 v218, v36, v37
    v_mfma_f32_16x16x32_bf16 v[208:211], a[92:95], a[60:63], -4.0
    v_cvt_pk_bf16_f32 v219, v38, v39
    v_mul_f32_dpp v40, v40, v246 row_ror:8 row_mask:0xf bank_mask:0xf
    v_mfma_f32_16x16x32_bf16 v[208:211], a[88:91], a[56:59], v[208:211]
    s_waitcnt lgkmcnt(0)
    v_mul_f32_dpp v41, v41, v246 row_ror:8 row_mask:0xf bank_mask:0xf
    v_mul_f32_dpp v42, v42, v246 row_ror:8 row_mask:0xf bank_mask:0xf
    v_mfma_f32_16x16x32_bf16 v[208:211], a[84:87], a[52:55], v[208:211]
    s_barrier
    v_mfma_f32_16x16x32_bf16 v[208:211], a[80:83], a[48:51], v[208:211]
    ds_write_b64 v236, a[168:169] offset:49152
    v_mfma_f32_16x16x32_bf16 v[212:215], a[80:83], a[64:67], -4.0
    ds_read_b128 a[80:83], v228 offset:32768
    v_mul_f32_dpp v43, v43, v246 row_ror:8 row_mask:0xf bank_mask:0xf
    v_mfma_f32_16x16x32_bf16 v[212:215], a[84:87], a[68:71], v[212:215]
    ds_read_b128 a[84:87], v228 offset:33024
    v_cvt_pk_bf16_f32 v220, v40, v41
    v_mfma_f32_16x16x32_bf16 v[212:215], a[88:91], a[72:75], v[212:215]
    ds_read_b128 a[88:91], v228 offset:33280
    v_cvt_pk_bf16_f32 v221, v42, v43
    v_mfma_f32_16x16x32_bf16 v[212:215], a[92:95], a[76:79], v[212:215]
    ds_read_b128 a[92:95], v228 offset:33536
    v_mul_f32_dpp v44, v44, v246 row_ror:8 row_mask:0xf bank_mask:0xf
    v_mfma_f32_16x16x32_bf16 v[24:27], a[104:107], v[160:163], v[24:27]
    v_exp_f32 v208, v208
    v_mfma_f32_16x16x32_bf16 v[56:59], a[104:107], v[168:171], v[56:59]
    v_exp_f32 v209, v209
    v_mfma_f32_16x16x32_bf16 v[88:91], a[104:107], v[176:179], v[88:91]
    v_exp_f32 v210, v210
    v_mfma_f32_16x16x32_bf16 v[120:123], a[104:107], v[184:187], v[120:123]
    v_exp_f32 v211, v211
    v_mfma_f32_16x16x32_bf16 v[152:155], a[104:107], v[192:195], v[152:155]
    ds_read_b128 a[104:107], v230 offset:57344
    v_cvt_pk_bf16_f32 v190, v208, v209
    v_mfma_f32_16x16x32_bf16 v[156:159], a[108:111], v[192:195], v[156:159]
    ds_read_b128 a[96:99], v231 offset:57344
    v_cvt_pk_bf16_f32 v191, v210, v211
    v_mfma_f32_16x16x32_bf16 v[124:127], a[108:111], v[184:187], v[124:127]
    ds_write_b64 v236, a[170:171] offset:49160
    v_mfma_f32_16x16x32_bf16 v[92:95], a[108:111], v[176:179], v[92:95]
    v_exp_f32 v212, v212
    v_mfma_f32_16x16x32_bf16 v[60:63], a[108:111], v[168:171], v[60:63]
    v_exp_f32 v213, v213
    v_mfma_f32_16x16x32_bf16 v[28:31], a[108:111], v[160:163], v[28:31]
    v_exp_f32 v214, v214
    v_smfmac_f32_16x16x64_bf16 a[120:123], a[132:135], v[176:183], v238
    s_waitcnt lgkmcnt(3)
    v_cvt_pk_bf16_f32 v198, v212, v213
    v_mfma_f32_16x16x32_bf16 v[200:203], a[80:83], a[0:3], -4.0
    v_exp_f32 v215, v215
    v_mfma_f32_16x16x32_bf16 v[200:203], a[84:87], a[4:7], v[200:203]
    ds_read_b128 a[108:111], v230 offset:58368
    v_cvt_pk_bf16_f32 v199, v214, v215
    v_mfma_f32_16x16x32_bf16 v[200:203], a[88:91], a[8:11], v[200:203]
    ds_write_b64 v236, a[172:173] offset:50176
    v_mfma_f32_16x16x32_bf16 v[200:203], a[92:95], a[12:15], v[200:203]
    ds_read_b128 a[100:103], v231 offset:58368
    v_mul_f32_dpp v45, v45, v246 row_ror:8 row_mask:0xf bank_mask:0xf
    v_mfma_f32_16x16x32_bf16 v[204:207], a[92:95], a[28:31], -4.0
    ds_write_b64 v236, a[174:175] offset:50184
    v_mfma_f32_16x16x32_bf16 v[204:207], a[88:91], a[24:27], v[204:207]
    v_mul_f32_dpp v46, v46, v246 row_ror:8 row_mask:0xf bank_mask:0xf
    v_mul_f32_dpp v47, v47, v246 row_ror:8 row_mask:0xf bank_mask:0xf
    v_mfma_f32_16x16x32_bf16 v[204:207], a[84:87], a[20:23], v[204:207]
    v_exp_f32 v200, v200
    v_mfma_f32_16x16x32_bf16 v[204:207], a[80:83], a[16:19], v[204:207]
    v_exp_f32 v201, v201
    v_mfma_f32_16x16x32_bf16 v[208:211], a[80:83], a[32:35], -4.0
    v_exp_f32 v202, v202
    v_mfma_f32_16x16x32_bf16 v[208:211], a[84:87], a[36:39], v[208:211]
    v_exp_f32 v203, v203
    v_mfma_f32_16x16x32_bf16 v[208:211], a[88:91], a[40:43], v[208:211]
    v_cvt_pk_bf16_f32 v160, v200, v201
    v_cvt_pk_bf16_f32 v161, v202, v203
    v_mfma_f32_16x16x32_bf16 v[208:211], a[92:95], a[44:47], v[208:211]
    v_cvt_pk_bf16_f32 v222, v44, v45
    v_cvt_pk_bf16_f32 v223, v46, v47
    v_mfma_f32_16x16x32_bf16 v[0:3], a[160:163], v[164:167], v[0:3]
    v_exp_f32 v204, v204
    v_mfma_f32_16x16x32_bf16 v[32:35], a[160:163], v[172:175], 0
    v_exp_f32 v205, v205
    v_mfma_f32_16x16x32_bf16 v[64:67], a[160:163], v[180:183], v[64:67]
    v_exp_f32 v206, v206
    v_mfma_f32_16x16x32_bf16 v[96:99], a[160:163], v[188:191], v[96:99]
    v_exp_f32 v207, v207
    v_mfma_f32_16x16x32_bf16 v[128:131], a[160:163], v[196:199], v[128:131]
    v_cvt_pk_bf16_f32 v168, v204, v205
    v_cvt_pk_bf16_f32 v169, v206, v207
    v_mfma_f32_16x16x32_bf16 v[132:135], a[164:167], v[196:199], v[132:135]
    v_exp_f32 v208, v208
    v_mfma_f32_16x16x32_bf16 v[100:103], a[164:167], v[188:191], v[100:103]
    v_exp_f32 v209, v209
    v_mfma_f32_16x16x32_bf16 v[68:71], a[164:167], v[180:183], v[68:71]
    v_exp_f32 v210, v210
    v_mfma_f32_16x16x32_bf16 v[36:39], a[164:167], v[172:175], 0
    v_exp_f32 v211, v211
    v_mfma_f32_16x16x32_bf16 v[4:7], a[164:167], v[164:167], v[4:7]
    v_cvt_pk_bf16_f32 v176, v208, v209
    v_cvt_pk_bf16_f32 v177, v210, v211
    v_smfmac_f32_16x16x64_bf16 a[128:131], a[132:135], v[192:199], v238
    v_cndmask_b32 v240, v216, v220, vcc
    v_mfma_f32_16x16x32_bf16 v[212:215], a[92:95], a[60:63], -4.0
    v_cndmask_b32 v241, v217, v221, vcc
    v_cndmask_b32 v220, v220, v216, vcc
    v_mfma_f32_16x16x32_bf16 v[212:215], a[88:91], a[56:59], v[212:215]
    v_cndmask_b32 v221, v221, v217, vcc
    v_mul_f32 v48, v48, v225
    v_mfma_f32_16x16x32_bf16 v[212:215], a[84:87], a[52:55], v[212:215]
    v_mul_f32 v49, v49, v225
    v_mul_f32 v50, v50, v225
    v_mfma_f32_16x16x32_bf16 v[212:215], a[80:83], a[48:51], v[212:215]
    v_mul_f32 v51, v51, v225
    v_cvt_pk_bf16_f32 v216, v48, v49
    v_mfma_f32_16x16x32_bf16 v[200:203], a[80:83], a[64:67], -4.0
    ds_read_b128 a[80:83], v228 offset:36864
    v_cvt_pk_bf16_f32 v217, v50, v51
    v_mfma_f32_16x16x32_bf16 v[200:203], a[84:87], a[68:71], v[200:203]
    ds_read_b128 a[84:87], v228 offset:37120
    v_cndmask_b32 v242, v218, v222, vcc
    v_mfma_f32_16x16x32_bf16 v[200:203], a[88:91], a[72:75], v[200:203]
    ds_read_b128 a[88:91], v228 offset:37376
    v_cndmask_b32 v243, v219, v223, vcc
    v_mfma_f32_16x16x32_bf16 v[200:203], a[92:95], a[76:79], v[200:203]
    s_waitcnt lgkmcnt(3)
    v_exp_f32 v212, v212
    v_mfma_f32_16x16x32_bf16 v[8:11], a[104:107], v[164:167], v[8:11]
    ds_read_b128 a[92:95], v228 offset:37632
    v_cndmask_b32 v222, v222, v218, vcc
    v_mfma_f32_16x16x32_bf16 v[40:43], a[104:107], v[172:175], 0
    v_exp_f32 v213, v213
    v_mfma_f32_16x16x32_bf16 v[72:75], a[104:107], v[180:183], v[72:75]
    v_exp_f32 v214, v214
    v_mfma_f32_16x16x32_bf16 v[104:107], a[104:107], v[188:191], v[104:107]
    v_exp_f32 v215, v215
    v_mfma_f32_16x16x32_bf16 v[136:139], a[104:107], v[196:199], v[136:139]
    ds_read_b128 a[104:107], v239 offset:57344
    v_cvt_pk_bf16_f32 v184, v212, v213
    v_mfma_f32_16x16x32_bf16 v[140:143], a[108:111], v[196:199], v[140:143]
    v_cvt_pk_bf16_f32 v185, v214, v215
    v_cndmask_b32 v223, v223, v219, vcc
    v_mfma_f32_16x16x32_bf16 v[108:111], a[108:111], v[188:191], v[108:111]
    v_mul_f32 v52, v52, v225
    v_mul_f32 v53, v53, v225
    v_mfma_f32_16x16x32_bf16 v[76:79], a[108:111], v[180:183], v[76:79]
    v_mul_f32 v54, v54, v225
    v_mul_f32 v55, v55, v225
    v_mfma_f32_16x16x32_bf16 v[44:47], a[108:111], v[172:175], 0
    v_cvt_pk_bf16_f32 v218, v52, v53
    v_cvt_pk_bf16_f32 v219, v54, v55
    v_mfma_f32_16x16x32_bf16 v[12:15], a[108:111], v[164:167], v[12:15]
    s_waitcnt lgkmcnt(2)
    v_exp_f32 v200, v200
    v_mfma_f32_16x16x32_bf16 v[204:207], a[80:83], a[0:3], -4.0
    v_exp_f32 v201, v201
    v_mfma_f32_16x16x32_bf16 v[204:207], a[84:87], a[4:7], v[204:207]
    v_exp_f32 v202, v202
    v_mfma_f32_16x16x32_bf16 v[204:207], a[88:91], a[8:11], v[204:207]
    s_waitcnt lgkmcnt(1)
    v_exp_f32 v203, v203
    v_mfma_f32_16x16x32_bf16 v[204:207], a[92:95], a[12:15], v[204:207]
    ds_read_b128 a[108:111], v239 offset:58368
    v_cvt_pk_bf16_f32 v192, v200, v201
    v_mfma_f32_16x16x32_bf16 v[208:211], a[92:95], a[28:31], -4.0
    v_cvt_pk_bf16_f32 v193, v202, v203
    v_mul_f32_dpp v56, v56, v246 row_ror:8 row_mask:0xf bank_mask:0xf
    v_mfma_f32_16x16x32_bf16 v[208:211], a[88:91], a[24:27], v[208:211]
    v_mul_f32_dpp v57, v57, v246 row_ror:8 row_mask:0xf bank_mask:0xf
    v_mul_f32_dpp v58, v58, v246 row_ror:8 row_mask:0xf bank_mask:0xf
    v_mfma_f32_16x16x32_bf16 v[208:211], a[84:87], a[20:23], v[208:211]
    v_exp_f32 v204, v204
    v_mfma_f32_16x16x32_bf16 v[208:211], a[80:83], a[16:19], v[208:211]
    v_exp_f32 v205, v205
    v_mfma_f32_16x16x32_bf16 v[212:215], a[80:83], a[32:35], -4.0
    v_exp_f32 v206, v206
    v_mfma_f32_16x16x32_bf16 v[212:215], a[84:87], a[36:39], v[212:215]
    v_exp_f32 v207, v207
    v_mfma_f32_16x16x32_bf16 v[212:215], a[88:91], a[40:43], v[212:215]
    v_cvt_pk_bf16_f32 v162, v204, v205
    v_cvt_pk_bf16_f32 v163, v206, v207
    v_mfma_f32_16x16x32_bf16 v[212:215], a[92:95], a[44:47], v[212:215]
    v_mul_f32_dpp v59, v59, v246 row_ror:8 row_mask:0xf bank_mask:0xf
    v_cvt_pk_bf16_f32 v232, v56, v57
    v_mfma_f32_16x16x32_bf16 v[16:19], a[96:99], v[164:167], v[16:19]
    v_cvt_pk_bf16_f32 v233, v58, v59
    v_mul_f32_dpp v60, v60, v246 row_ror:8 row_mask:0xf bank_mask:0xf
    v_mfma_f32_16x16x32_bf16 v[48:51], a[96:99], v[172:175], 0
    v_mul_f32_dpp v61, v61, v246 row_ror:8 row_mask:0xf bank_mask:0xf
    v_mul_f32_dpp v62, v62, v246 row_ror:8 row_mask:0xf bank_mask:0xf
    v_mfma_f32_16x16x32_bf16 v[80:83], a[96:99], v[180:183], v[80:83]
    v_mul_f32_dpp v63, v63, v246 row_ror:8 row_mask:0xf bank_mask:0xf
    v_cvt_pk_bf16_f32 v234, v60, v61
    v_mfma_f32_16x16x32_bf16 v[112:115], a[96:99], v[188:191], v[112:115]
    v_cvt_pk_bf16_f32 v235, v62, v63
    v_accvgpr_write_b32 a117, 0
    v_mfma_f32_16x16x32_bf16 v[144:147], a[96:99], v[196:199], v[144:147]
    v_exp_f32 v208, v208
    v_mfma_f32_16x16x32_bf16 v[148:151], a[100:103], v[196:199], v[148:151]
    v_exp_f32 v209, v209
    v_mfma_f32_16x16x32_bf16 v[116:119], a[100:103], v[188:191], v[116:119]
    v_exp_f32 v210, v210
    v_mfma_f32_16x16x32_bf16 v[84:87], a[100:103], v[180:183], v[84:87]
    v_exp_f32 v211, v211
    v_mfma_f32_16x16x32_bf16 v[52:55], a[100:103], v[172:175], 0
    v_cvt_pk_bf16_f32 v170, v208, v209
    v_cvt_pk_bf16_f32 v171, v210, v211
    v_mfma_f32_16x16x32_bf16 v[20:23], a[100:103], v[164:167], v[20:23]
    v_exp_f32 v212, v212
    v_mfma_f32_16x16x32_bf16 v[200:203], a[92:95], a[60:63], -4.0
    v_exp_f32 v213, v213
    v_mfma_f32_16x16x32_bf16 v[200:203], a[88:91], a[56:59], v[200:203]
    v_exp_f32 v214, v214
    v_mfma_f32_16x16x32_bf16 v[200:203], a[84:87], a[52:55], v[200:203]
    v_exp_f32 v215, v215
    v_mfma_f32_16x16x32_bf16 v[200:203], a[80:83], a[48:51], v[200:203]
    v_cvt_pk_bf16_f32 v178, v212, v213
    v_cvt_pk_bf16_f32 v179, v214, v215
    v_mfma_f32_16x16x32_bf16 v[204:207], a[80:83], a[64:67], -4.0
    ds_read_b128 a[80:83], v228 offset:40960
    v_max3_f32 v227, v226, v225, v227
    v_mfma_f32_16x16x32_bf16 v[204:207], a[84:87], a[68:71], v[204:207]
    ds_read_b128 a[84:87], v228 offset:41216
    v_mfma_f32_16x16x32_bf16 v[204:207], a[88:91], a[72:75], v[204:207]
    ds_read_b128 a[88:91], v228 offset:41472
    v_mfma_f32_16x16x32_bf16 v[204:207], a[92:95], a[76:79], v[204:207]
    s_waitcnt lgkmcnt(3)
    v_exp_f32 v200, v200
    v_mfma_f32_16x16x32_bf16 v[24:27], a[104:107], v[164:167], v[24:27]
    ds_read_b128 a[92:95], v228 offset:41728
    v_mfma_f32_16x16x32_bf16 v[56:59], a[104:107], v[172:175], 0
    v_exp_f32 v201, v201
    v_mfma_f32_16x16x32_bf16 v[88:91], a[104:107], v[180:183], v[88:91]
    v_exp_f32 v202, v202
    v_mfma_f32_16x16x32_bf16 v[120:123], a[104:107], v[188:191], v[120:123]
    v_exp_f32 v203, v203
    v_mfma_f32_16x16x32_bf16 v[152:155], a[104:107], v[196:199], v[152:155]
    v_cvt_pk_bf16_f32 v186, v200, v201
    v_cvt_pk_bf16_f32 v187, v202, v203
    v_mfma_f32_16x16x32_bf16 v[156:159], a[108:111], v[196:199], v[156:159]
    v_exp_f32 v204, v204
    v_mfma_f32_16x16x32_bf16 v[124:127], a[108:111], v[188:191], v[124:127]
    v_exp_f32 v205, v205
    v_mfma_f32_16x16x32_bf16 v[92:95], a[108:111], v[180:183], v[92:95]
    v_exp_f32 v206, v206
    v_mfma_f32_16x16x32_bf16 v[60:63], a[108:111], v[172:175], 0
    v_exp_f32 v207, v207
    v_mfma_f32_16x16x32_bf16 v[28:31], a[108:111], v[164:167], v[28:31]
    v_cvt_pk_bf16_f32 v194, v204, v205
    v_cvt_pk_bf16_f32 v195, v206, v207
    v_smfmac_f32_16x16x64_bf16 a[116:119], a[132:135], v[168:175], v238
    s_waitcnt lgkmcnt(0)
    v_mfma_f32_16x16x32_bf16 v[208:211], a[80:83], a[0:3], -4.0
    s_barrier
    v_mfma_f32_16x16x32_bf16 v[208:211], a[84:87], a[4:7], v[208:211]
    buffer_store_dwordx4 v[240:243], v244, s[16:19], s26 offen nt
    v_mfma_f32_16x16x32_bf16 v[208:211], a[88:91], a[8:11], v[208:211]
    ds_write_b64 v236, a[176:177] offset:57344
    v_mfma_f32_16x16x32_bf16 v[208:211], a[92:95], a[12:15], v[208:211]
    ds_read_b128 a[104:107], v230 offset:49152
    v_cndmask_b32 v240, v216, v232, vcc
    v_mfma_f32_16x16x32_bf16 v[212:215], a[92:95], a[28:31], -4.0
    ds_write_b64 v236, a[178:179] offset:57352
    v_mfma_f32_16x16x32_bf16 v[212:215], a[88:91], a[24:27], v[212:215]
    buffer_store_dwordx4 v[220:223], v245, s[16:19], s26 offen nt
    v_mfma_f32_16x16x32_bf16 v[212:215], a[84:87], a[20:23], v[212:215]
    ds_read_b128 a[108:111], v230 offset:50176
    v_cndmask_b32 v241, v217, v233, vcc
    v_mfma_f32_16x16x32_bf16 v[212:215], a[80:83], a[16:19], v[212:215]
    s_add_u32 s26, s26, 16384
    v_exp_f32 v208, v208
    v_mfma_f32_16x16x32_bf16 v[200:203], a[80:83], a[32:35], -4.0
    v_exp_f32 v209, v209
    v_mfma_f32_16x16x32_bf16 v[200:203], a[84:87], a[36:39], v[200:203]
    v_exp_f32 v210, v210
    v_mfma_f32_16x16x32_bf16 v[200:203], a[88:91], a[40:43], v[200:203]
    v_exp_f32 v211, v211
    v_mfma_f32_16x16x32_bf16 v[200:203], a[92:95], a[44:47], v[200:203]
    ds_read_b128 a[96:99], v231 offset:49152
    v_cvt_pk_bf16_f32 v164, v208, v209
    v_mfma_f32_16x16x32_bf16 v[0:3], a[168:171], v[160:163], v[0:3]
    ds_read_b128 a[100:103], v231 offset:50176
    v_cvt_pk_bf16_f32 v165, v210, v211
    v_mfma_f32_16x16x32_bf16 v[32:35], a[168:171], v[168:171], v[32:35]
    ds_write_b64 v236, a[180:181] offset:58368
    v_mfma_f32_16x16x32_bf16 v[64:67], a[168:171], v[176:179], v[64:67]
    v_exp_f32 v212, v212
    v_mfma_f32_16x16x32_bf16 v[96:99], a[168:171], v[184:187], v[96:99]
    v_exp_f32 v213, v213
    v_mfma_f32_16x16x32_bf16 v[128:131], a[168:171], v[192:195], v[128:131]
    v_exp_f32 v214, v214
    v_mfma_f32_16x16x32_bf16 v[132:135], a[172:175], v[192:195], v[132:135]
    v_exp_f32 v215, v215
    v_mfma_f32_16x16x32_bf16 v[100:103], a[172:175], v[184:187], v[100:103]
    v_cvt_pk_bf16_f32 v172, v212, v213
    v_cvt_pk_bf16_f32 v173, v214, v215
    v_mfma_f32_16x16x32_bf16 v[68:71], a[172:175], v[176:179], v[68:71]
    v_exp_f32 v200, v200
    v_mfma_f32_16x16x32_bf16 v[36:39], a[172:175], v[168:171], v[36:39]
    v_exp_f32 v201, v201
    v_mfma_f32_16x16x32_bf16 v[4:7], a[172:175], v[160:163], v[4:7]
    v_exp_f32 v202, v202
    v_smfmac_f32_16x16x64_bf16 a[124:127], a[132:135], v[184:191], v238
    v_cvt_pk_bf16_f32 v180, v200, v201
    v_mfma_f32_16x16x32_bf16 v[204:207], a[92:95], a[60:63], -4.0
    v_exp_f32 v203, v203
    v_mfma_f32_16x16x32_bf16 v[204:207], a[88:91], a[56:59], v[204:207]
    v_cvt_pk_bf16_f32 v181, v202, v203
    v_cndmask_b32 v242, v218, v234, vcc
    v_mfma_f32_16x16x32_bf16 v[204:207], a[84:87], a[52:55], v[204:207]
    ds_write_b64 v236, a[182:183] offset:58376
    v_mfma_f32_16x16x32_bf16 v[204:207], a[80:83], a[48:51], v[204:207]
    v_cndmask_b32 v243, v219, v235, vcc
    v_cndmask_b32 v232, v232, v216, vcc
    v_mfma_f32_16x16x32_bf16 v[208:211], a[80:83], a[64:67], -4.0
    ds_read_b128 a[80:83], v228 offset:45056
    v_cndmask_b32 v233, v233, v217, vcc
    v_mfma_f32_16x16x32_bf16 v[208:211], a[84:87], a[68:71], v[208:211]
    ds_read_b128 a[84:87], v228 offset:45312
    v_cndmask_b32 v234, v234, v218, vcc
    v_mfma_f32_16x16x32_bf16 v[208:211], a[88:91], a[72:75], v[208:211]
    ds_read_b128 a[88:91], v228 offset:45568
    v_cndmask_b32 v235, v235, v219, vcc
    v_mfma_f32_16x16x32_bf16 v[208:211], a[92:95], a[76:79], v[208:211]
    s_waitcnt lgkmcnt(4)
    v_exp_f32 v204, v204
    v_mfma_f32_16x16x32_bf16 v[8:11], a[104:107], v[160:163], v[8:11]
    buffer_store_dwordx4 v[240:243], v244, s[16:19], s42 offen nt
    v_mfma_f32_16x16x32_bf16 v[40:43], a[104:107], v[168:171], v[40:43]
    ds_read_b128 a[92:95], v228 offset:45824
    v_mfma_f32_16x16x32_bf16 v[72:75], a[104:107], v[176:179], v[72:75]
    v_exp_f32 v205, v205
    v_mfma_f32_16x16x32_bf16 v[104:107], a[104:107], v[184:187], v[104:107]
    v_exp_f32 v206, v206
    v_mfma_f32_16x16x32_bf16 v[136:139], a[104:107], v[192:195], v[136:139]
    buffer_store_dwordx4 v[232:235], v245, s[16:19], s42 offen nt
    v_mfma_f32_16x16x32_bf16 v[140:143], a[108:111], v[192:195], v[140:143]
    v_exp_f32 v207, v207
    v_mfma_f32_16x16x32_bf16 v[108:111], a[108:111], v[184:187], v[108:111]
    ds_read_b128 a[104:107], v239 offset:49152
    v_cvt_pk_bf16_f32 v188, v204, v205
    v_mfma_f32_16x16x32_bf16 v[76:79], a[108:111], v[176:179], v[76:79]
    s_add_u32 s42, s42, 16384
    v_cvt_pk_bf16_f32 v189, v206, v207
    v_mfma_f32_16x16x32_bf16 v[44:47], a[108:111], v[168:171], v[44:47]
    v_exp_f32 v208, v208
    v_mfma_f32_16x16x32_bf16 v[12:15], a[108:111], v[160:163], v[12:15]
    s_waitcnt lgkmcnt(2)
    v_exp_f32 v209, v209
    v_mfma_f32_16x16x32_bf16 v[212:215], a[80:83], a[0:3], -4.0
    v_exp_f32 v210, v210
    v_mfma_f32_16x16x32_bf16 v[212:215], a[84:87], a[4:7], v[212:215]
    v_exp_f32 v211, v211
    v_mfma_f32_16x16x32_bf16 v[212:215], a[88:91], a[8:11], v[212:215]
    s_waitcnt lgkmcnt(1)
    v_cvt_pk_bf16_f32 v196, v208, v209
    v_cvt_pk_bf16_f32 v197, v210, v211
    v_mfma_f32_16x16x32_bf16 v[212:215], a[92:95], a[12:15], v[212:215]
    ds_read_b128 a[108:111], v239 offset:50176
    v_mfma_f32_16x16x32_bf16 v[200:203], a[92:95], a[28:31], -4.0
    v_mfma_f32_16x16x32_bf16 v[200:203], a[88:91], a[24:27], v[200:203]
    v_mfma_f32_16x16x32_bf16 v[200:203], a[84:87], a[20:23], v[200:203]
    v_mfma_f32_16x16x32_bf16 v[200:203], a[80:83], a[16:19], v[200:203]
    v_mfma_f32_16x16x32_bf16 v[204:207], a[80:83], a[32:35], -4.0
    s_waitcnt vmcnt(7)
    v_accvgpr_mov_b32 a32, a240
    v_accvgpr_mov_b32 a33, a241
    v_mfma_f32_16x16x32_bf16 v[204:207], a[84:87], a[36:39], v[204:207]
    v_exp_f32 v212, v212
    v_mfma_f32_16x16x32_bf16 v[204:207], a[88:91], a[40:43], v[204:207]
    v_exp_f32 v213, v213
    v_mfma_f32_16x16x32_bf16 v[204:207], a[92:95], a[44:47], v[204:207]
    v_exp_f32 v214, v214
    v_mfma_f32_16x16x32_bf16 v[16:19], a[96:99], v[160:163], v[16:19]
    v_exp_f32 v215, v215
    v_mfma_f32_16x16x32_bf16 v[48:51], a[96:99], v[168:171], v[48:51]
    v_cvt_pk_bf16_f32 v166, v212, v213
    v_cvt_pk_bf16_f32 v167, v214, v215
    v_mfma_f32_16x16x32_bf16 v[80:83], a[96:99], v[176:179], v[80:83]
    v_exp_f32 v200, v200
    v_mfma_f32_16x16x32_bf16 v[112:115], a[96:99], v[184:187], v[112:115]
    v_exp_f32 v204, v204
    v_mfma_f32_16x16x32_bf16 v[144:147], a[96:99], v[192:195], v[144:147]
    v_exp_f32 v205, v205
    v_mfma_f32_16x16x32_bf16 v[148:151], a[100:103], v[192:195], v[148:151]
    v_exp_f32 v206, v206
    v_mfma_f32_16x16x32_bf16 v[116:119], a[100:103], v[184:187], v[116:119]
    v_exp_f32 v207, v207
    v_mfma_f32_16x16x32_bf16 v[84:87], a[100:103], v[176:179], v[84:87]
    v_cvt_pk_bf16_f32 v182, v204, v205
    v_cvt_pk_bf16_f32 v183, v206, v207
    v_mfma_f32_16x16x32_bf16 v[52:55], a[100:103], v[168:171], v[52:55]
    v_exp_f32 v201, v201
    v_mfma_f32_16x16x32_bf16 v[20:23], a[100:103], v[160:163], v[20:23]
    v_exp_f32 v202, v202
    v_smfmac_f32_16x16x64_bf16 a[112:115], a[132:135], v[160:167], v238
    v_cvt_pk_bf16_f32 v174, v200, v201
    v_mfma_f32_16x16x32_bf16 v[208:211], a[92:95], a[60:63], -4.0
    v_exp_f32 v203, v203
    v_mfma_f32_16x16x32_bf16 v[208:211], a[88:91], a[56:59], v[208:211]
    v_cvt_pk_bf16_f32 v175, v202, v203
    v_accvgpr_mov_b32 a34, a242
    v_mfma_f32_16x16x32_bf16 v[208:211], a[84:87], a[52:55], v[208:211]
    v_accvgpr_mov_b32 a35, a243
    v_mfma_f32_16x16x32_bf16 v[208:211], a[80:83], a[48:51], v[208:211]
    s_waitcnt vmcnt(6)
    v_accvgpr_mov_b32 a36, a244
    v_accvgpr_mov_b32 a37, a245
    v_mfma_f32_16x16x32_bf16 v[212:215], a[80:83], a[64:67], -4.0
    ds_read_b128 a[80:83], v228 offset:49152
    v_accvgpr_mov_b32 a38, a246
    v_mfma_f32_16x16x32_bf16 v[212:215], a[84:87], a[68:71], v[212:215]
    ds_read_b128 a[84:87], v228 offset:49408
    v_accvgpr_mov_b32 a39, a247
    v_mfma_f32_16x16x32_bf16 v[212:215], a[88:91], a[72:75], v[212:215]
    ds_read_b128 a[88:91], v228 offset:49664
    v_mfma_f32_16x16x32_bf16 v[212:215], a[92:95], a[76:79], v[212:215]
    s_waitcnt lgkmcnt(3)
    v_exp_f32 v208, v208
    v_mfma_f32_16x16x32_bf16 v[24:27], a[104:107], v[160:163], v[24:27]
    ds_read_b128 a[92:95], v228 offset:49920
    v_mfma_f32_16x16x32_bf16 v[56:59], a[104:107], v[168:171], v[56:59]
    v_exp_f32 v209, v209
    v_mfma_f32_16x16x32_bf16 v[88:91], a[104:107], v[176:179], v[88:91]
    v_exp_f32 v210, v210
    v_mfma_f32_16x16x32_bf16 v[120:123], a[104:107], v[184:187], v[120:123]
    v_exp_f32 v211, v211
    v_mfma_f32_16x16x32_bf16 v[152:155], a[104:107], v[192:195], v[152:155]
    v_cvt_pk_bf16_f32 v190, v208, v209
    v_cvt_pk_bf16_f32 v191, v210, v211
    v_mfma_f32_16x16x32_bf16 v[156:159], a[108:111], v[192:195], v[156:159]
    s_waitcnt vmcnt(5)
    v_accvgpr_mov_b32 a40, a248
    v_accvgpr_mov_b32 a41, a249
    v_mfma_f32_16x16x32_bf16 v[124:127], a[108:111], v[184:187], v[124:127]
    v_accvgpr_mov_b32 a42, a250
    v_accvgpr_mov_b32 a43, a251
    v_mfma_f32_16x16x32_bf16 v[92:95], a[108:111], v[176:179], v[92:95]
    s_waitcnt vmcnt(4)
    v_accvgpr_mov_b32 a44, a252
    v_accvgpr_mov_b32 a45, a253
    v_mfma_f32_16x16x32_bf16 v[60:63], a[108:111], v[168:171], v[60:63]
    v_accvgpr_mov_b32 a46, a254
    v_accvgpr_mov_b32 a47, a255
    v_mfma_f32_16x16x32_bf16 v[28:31], a[108:111], v[160:163], v[28:31]
    v_exp_f32 v212, v212
    v_smfmac_f32_16x16x64_bf16 a[120:123], a[132:135], v[176:183], v238
    s_waitcnt lgkmcnt(0)
    s_add_u32 s4, s4, 16384
    s_addc_u32 s5, s5, 0
    v_mfma_f32_16x16x32_bf16 v[200:203], a[80:83], a[0:3], -4.0
    global_load_dwordx4 a[240:243], v237, s[4:5] offset:0
    v_mfma_f32_16x16x32_bf16 v[200:203], a[84:87], a[4:7], v[200:203]
    global_load_dwordx4 a[244:247], v237, s[4:5] offset:64
    v_mfma_f32_16x16x32_bf16 v[200:203], a[88:91], a[8:11], v[200:203]
    v_accvgpr_read_b32 v224, a120
    v_accvgpr_read_b32 v226, a121
    v_mfma_f32_16x16x32_bf16 v[200:203], a[92:95], a[12:15], v[200:203]
    v_add_f32 v226, v226, v224
    v_accvgpr_write_b32 a120, 0
    v_mfma_f32_16x16x32_bf16 v[204:207], a[92:95], a[28:31], -4.0
    v_rcp_f32 v224, v226
    v_mfma_f32_16x16x32_bf16 v[204:207], a[88:91], a[24:27], v[204:207]
    global_load_dwordx4 a[248:251], v237, s[4:5] offset:128
    v_mfma_f32_16x16x32_bf16 v[204:207], a[84:87], a[20:23], v[204:207]
    global_load_dwordx4 a[252:255], v237, s[4:5] offset:192
    v_mfma_f32_16x16x32_bf16 v[204:207], a[80:83], a[16:19], v[204:207]
    v_exp_f32 v213, v213
    v_mfma_f32_16x16x32_bf16 v[208:211], a[80:83], a[32:35], -4.0
    v_exp_f32 v214, v214
    v_mfma_f32_16x16x32_bf16 v[208:211], a[84:87], a[36:39], v[208:211]
    v_exp_f32 v215, v215
    v_mfma_f32_16x16x32_bf16 v[208:211], a[88:91], a[40:43], v[208:211]
    v_cvt_pk_bf16_f32 v198, v212, v213
    v_cvt_pk_bf16_f32 v199, v214, v215
    v_mfma_f32_16x16x32_bf16 v[208:211], a[92:95], a[44:47], v[208:211]
    s_barrier
    v_mfma_f32_16x16x32_bf16 v[0:3], a[176:179], v[164:167], v[0:3]
    ds_read_b128 a[104:107], v230 offset:57344
    v_mov_b32_dpp v246, v224 row_ror:8 row_mask:0xf bank_mask:0xf
    v_mfma_f32_16x16x32_bf16 v[32:35], a[176:179], v[172:175], v[32:35]
    ds_write_b64 v236, a[184:185] offset:49152
    v_mfma_f32_16x16x32_bf16 v[64:67], a[176:179], v[180:183], v[64:67]
    v_exp_f32 v200, v200
    v_mfma_f32_16x16x32_bf16 v[96:99], a[176:179], v[188:191], v[96:99]
    v_exp_f32 v201, v201
    v_mfma_f32_16x16x32_bf16 v[128:131], a[176:179], v[196:199], v[128:131]
    v_exp_f32 v202, v202
    v_mfma_f32_16x16x32_bf16 v[132:135], a[180:183], v[196:199], v[132:135]
    v_exp_f32 v203, v203
    v_mfma_f32_16x16x32_bf16 v[100:103], a[180:183], v[188:191], v[100:103]
    ds_read_b128 a[108:111], v230 offset:58368
    v_cvt_pk_bf16_f32 v160, v200, v201
    v_mfma_f32_16x16x32_bf16 v[68:71], a[180:183], v[180:183], v[68:71]
    ds_read_b128 a[96:99], v231 offset:57344
    v_cvt_pk_bf16_f32 v161, v202, v203
    v_mfma_f32_16x16x32_bf16 v[36:39], a[180:183], v[172:175], v[36:39]
    ds_write_b64 v236, a[186:187] offset:49160
    v_mfma_f32_16x16x32_bf16 v[4:7], a[180:183], v[164:167], v[4:7]
    v_exp_f32 v204, v204
    v_smfmac_f32_16x16x64_bf16 a[128:131], a[132:135], v[192:199], v238
    ds_write_b64 v236, a[188:189] offset:50176
    v_mfma_f32_16x16x32_bf16 v[212:215], a[92:95], a[60:63], -4.0
    v_exp_f32 v205, v205
    v_mfma_f32_16x16x32_bf16 v[212:215], a[88:91], a[56:59], v[212:215]
    v_exp_f32 v206, v206
    v_mfma_f32_16x16x32_bf16 v[212:215], a[84:87], a[52:55], v[212:215]
    v_exp_f32 v207, v207
    v_mfma_f32_16x16x32_bf16 v[212:215], a[80:83], a[48:51], v[212:215]
    ds_read_b128 a[100:103], v231 offset:58368
    v_cvt_pk_bf16_f32 v168, v204, v205
    v_mfma_f32_16x16x32_bf16 v[200:203], a[80:83], a[64:67], -4.0
    ds_read_b128 a[80:83], v228 offset:53248
    v_cvt_pk_bf16_f32 v169, v206, v207
    v_mfma_f32_16x16x32_bf16 v[200:203], a[84:87], a[68:71], v[200:203]
    ds_read_b128 a[84:87], v228 offset:53504
    v_mul_f32 v64, v64, v224
    v_mfma_f32_16x16x32_bf16 v[200:203], a[88:91], a[72:75], v[200:203]
    ds_read_b128 a[88:91], v228 offset:53760
    v_mul_f32 v65, v65, v224
    v_mfma_f32_16x16x32_bf16 v[200:203], a[92:95], a[76:79], v[200:203]
    s_waitcnt lgkmcnt(5)
    v_exp_f32 v208, v208
    v_mfma_f32_16x16x32_bf16 v[8:11], a[104:107], v[164:167], v[8:11]
    ds_read_b128 a[92:95], v228 offset:54016
    v_mul_f32 v66, v66, v224
    v_mfma_f32_16x16x32_bf16 v[40:43], a[104:107], v[172:175], v[40:43]
    v_exp_f32 v209, v209
    v_mfma_f32_16x16x32_bf16 v[72:75], a[104:107], v[180:183], v[72:75]
    v_exp_f32 v210, v210
    v_mfma_f32_16x16x32_bf16 v[104:107], a[104:107], v[188:191], v[104:107]
    v_exp_f32 v211, v211
    v_mfma_f32_16x16x32_bf16 v[136:139], a[104:107], v[196:199], v[136:139]
    ds_read_b128 a[104:107], v239 offset:57344
    v_cvt_pk_bf16_f32 v176, v208, v209
    v_mfma_f32_16x16x32_bf16 v[140:143], a[108:111], v[196:199], v[140:143]
    v_cvt_pk_bf16_f32 v177, v210, v211
    v_mul_f32 v67, v67, v224
    v_mfma_f32_16x16x32_bf16 v[108:111], a[108:111], v[188:191], v[108:111]
    v_exp_f32 v212, v212
    v_mfma_f32_16x16x32_bf16 v[76:79], a[108:111], v[180:183], v[76:79]
    v_exp_f32 v213, v213
    v_mfma_f32_16x16x32_bf16 v[44:47], a[108:111], v[172:175], v[44:47]
    v_exp_f32 v214, v214
    v_mfma_f32_16x16x32_bf16 v[12:15], a[108:111], v[164:167], v[12:15]
    s_waitcnt lgkmcnt(2)
    v_exp_f32 v215, v215
    v_mfma_f32_16x16x32_bf16 v[204:207], a[80:83], a[0:3], -4.0
    ds_read_b128 a[108:111], v239 offset:58368
    v_cvt_pk_bf16_f32 v184, v212, v213
    v_mfma_f32_16x16x32_bf16 v[204:207], a[84:87], a[4:7], v[204:207]
    v_cvt_pk_bf16_f32 v185, v214, v215
    v_cvt_pk_bf16_f32 v216, v64, v65
    v_mfma_f32_16x16x32_bf16 v[204:207], a[88:91], a[8:11], v[204:207]
    s_waitcnt lgkmcnt(2)
    v_exp_f32 v200, v200
    v_mfma_f32_16x16x32_bf16 v[204:207], a[92:95], a[12:15], v[204:207]
    ds_write_b64 v236, a[190:191] offset:50184
    v_mfma_f32_16x16x32_bf16 v[208:211], a[92:95], a[28:31], -4.0
    v_exp_f32 v201, v201
    v_mfma_f32_16x16x32_bf16 v[208:211], a[88:91], a[24:27], v[208:211]
    v_exp_f32 v202, v202
    v_mfma_f32_16x16x32_bf16 v[208:211], a[84:87], a[20:23], v[208:211]
    v_exp_f32 v203, v203
    v_mfma_f32_16x16x32_bf16 v[208:211], a[80:83], a[16:19], v[208:211]
    v_cvt_pk_bf16_f32 v192, v200, v201
    v_cvt_pk_bf16_f32 v193, v202, v203
    v_mfma_f32_16x16x32_bf16 v[212:215], a[80:83], a[32:35], -4.0
    v_exp_f32 v204, v204
    v_mfma_f32_16x16x32_bf16 v[212:215], a[84:87], a[36:39], v[212:215]
    v_exp_f32 v205, v205
    v_mfma_f32_16x16x32_bf16 v[212:215], a[88:91], a[40:43], v[212:215]
    v_exp_f32 v206, v206
    v_mfma_f32_16x16x32_bf16 v[212:215], a[92:95], a[44:47], v[212:215]
    v_exp_f32 v207, v207
    v_mfma_f32_16x16x32_bf16 v[16:19], a[96:99], v[164:167], v[16:19]
    v_cvt_pk_bf16_f32 v162, v204, v205
    v_cvt_pk_bf16_f32 v163, v206, v207
    v_mfma_f32_16x16x32_bf16 v[48:51], a[96:99], v[172:175], v[48:51]
    v_exp_f32 v208, v208
    v_mfma_f32_16x16x32_bf16 v[80:83], a[96:99], v[180:183], v[80:83]
    v_exp_f32 v209, v209
    v_mfma_f32_16x16x32_bf16 v[112:115], a[96:99], v[188:191], v[112:115]
    v_exp_f32 v210, v210
    v_mfma_f32_16x16x32_bf16 v[144:147], a[96:99], v[196:199], v[144:147]
    v_exp_f32 v211, v211
    v_mfma_f32_16x16x32_bf16 v[148:151], a[100:103], v[196:199], v[148:151]
    v_cvt_pk_bf16_f32 v170, v208, v209
    v_cvt_pk_bf16_f32 v171, v210, v211
    v_mfma_f32_16x16x32_bf16 v[116:119], a[100:103], v[188:191], v[116:119]
    v_exp_f32 v212, v212
    v_mfma_f32_16x16x32_bf16 v[84:87], a[100:103], v[180:183], v[84:87]
    v_exp_f32 v213, v213
    v_mfma_f32_16x16x32_bf16 v[52:55], a[100:103], v[172:175], v[52:55]
    v_exp_f32 v214, v214
    v_mfma_f32_16x16x32_bf16 v[20:23], a[100:103], v[164:167], v[20:23]
    v_exp_f32 v215, v215
    v_mfma_f32_16x16x32_bf16 v[200:203], a[92:95], a[60:63], -4.0
    v_cvt_pk_bf16_f32 v178, v212, v213
    v_cvt_pk_bf16_f32 v179, v214, v215
    v_mfma_f32_16x16x32_bf16 v[200:203], a[88:91], a[56:59], v[200:203]
    v_cvt_pk_bf16_f32 v217, v66, v67
    v_mul_f32 v68, v68, v224
    v_mfma_f32_16x16x32_bf16 v[200:203], a[84:87], a[52:55], v[200:203]
    v_mul_f32 v69, v69, v224
    v_mul_f32 v70, v70, v224
    v_mfma_f32_16x16x32_bf16 v[200:203], a[80:83], a[48:51], v[200:203]
    v_mul_f32 v71, v71, v224
    v_cvt_pk_bf16_f32 v218, v68, v69
    v_mfma_f32_16x16x32_bf16 v[204:207], a[80:83], a[64:67], -4.0
    ds_read_b128 a[80:83], v228 offset:57344
    v_cvt_pk_bf16_f32 v219, v70, v71
    v_mfma_f32_16x16x32_bf16 v[204:207], a[84:87], a[68:71], v[204:207]
    ds_read_b128 a[84:87], v228 offset:57600
    v_mul_f32_dpp v72, v72, v246 row_ror:8 row_mask:0xf bank_mask:0xf
    v_mfma_f32_16x16x32_bf16 v[204:207], a[88:91], a[72:75], v[204:207]
    ds_read_b128 a[88:91], v228 offset:57856
    v_mul_f32_dpp v73, v73, v246 row_ror:8 row_mask:0xf bank_mask:0xf
    v_mfma_f32_16x16x32_bf16 v[204:207], a[92:95], a[76:79], v[204:207]
    s_waitcnt lgkmcnt(3)
    v_exp_f32 v200, v200
    v_mfma_f32_16x16x32_bf16 v[24:27], a[104:107], v[164:167], v[24:27]
    ds_read_b128 a[92:95], v228 offset:58112
    v_mul_f32_dpp v74, v74, v246 row_ror:8 row_mask:0xf bank_mask:0xf
    v_mfma_f32_16x16x32_bf16 v[56:59], a[104:107], v[172:175], v[56:59]
    v_exp_f32 v201, v201
    v_mfma_f32_16x16x32_bf16 v[88:91], a[104:107], v[180:183], v[88:91]
    v_exp_f32 v202, v202
    v_mfma_f32_16x16x32_bf16 v[120:123], a[104:107], v[188:191], v[120:123]
    v_exp_f32 v203, v203
    v_mfma_f32_16x16x32_bf16 v[152:155], a[104:107], v[196:199], v[152:155]
    v_cvt_pk_bf16_f32 v186, v200, v201
    v_cvt_pk_bf16_f32 v187, v202, v203
    v_mfma_f32_16x16x32_bf16 v[156:159], a[108:111], v[196:199], v[156:159]
    v_exp_f32 v204, v204
    v_mfma_f32_16x16x32_bf16 v[124:127], a[108:111], v[188:191], v[124:127]
    v_exp_f32 v205, v205
    v_mfma_f32_16x16x32_bf16 v[92:95], a[108:111], v[180:183], v[92:95]
    v_exp_f32 v206, v206
    v_mfma_f32_16x16x32_bf16 v[60:63], a[108:111], v[172:175], v[60:63]
    v_exp_f32 v207, v207
    v_mfma_f32_16x16x32_bf16 v[28:31], a[108:111], v[164:167], v[28:31]
    v_cvt_pk_bf16_f32 v194, v204, v205
    v_cvt_pk_bf16_f32 v195, v206, v207
    v_smfmac_f32_16x16x64_bf16 a[116:119], a[132:135], v[168:175], v238
    s_waitcnt lgkmcnt(0)
    v_mul_f32_dpp v75, v75, v246 row_ror:8 row_mask:0xf bank_mask:0xf
    v_mfma_f32_16x16x32_bf16 v[208:211], a[80:83], a[0:3], -4.0
    s_barrier
    v_mfma_f32_16x16x32_bf16 v[208:211], a[84:87], a[4:7], v[208:211]
    ds_write_b64 v236, a[192:193] offset:57344
    v_mfma_f32_16x16x32_bf16 v[208:211], a[88:91], a[8:11], v[208:211]
    ds_read_b128 a[104:107], v230 offset:49152
    v_cvt_pk_bf16_f32 v220, v72, v73
    v_mfma_f32_16x16x32_bf16 v[208:211], a[92:95], a[12:15], v[208:211]
    ds_write_b64 v236, a[194:195] offset:57352
    v_mfma_f32_16x16x32_bf16 v[212:215], a[92:95], a[28:31], -4.0
    ds_read_b128 a[108:111], v230 offset:50176
    v_cvt_pk_bf16_f32 v221, v74, v75
    v_mfma_f32_16x16x32_bf16 v[212:215], a[88:91], a[24:27], v[212:215]
    ds_read_b128 a[96:99], v231 offset:49152
    v_mul_f32_dpp v76, v76, v246 row_ror:8 row_mask:0xf bank_mask:0xf
    v_mfma_f32_16x16x32_bf16 v[212:215], a[84:87], a[20:23], v[212:215]
    v_exp_f32 v208, v208
    v_mfma_f32_16x16x32_bf16 v[212:215], a[80:83], a[16:19], v[212:215]
    v_exp_f32 v209, v209
    v_mfma_f32_16x16x32_bf16 v[200:203], a[80:83], a[32:35], -4.0
    v_exp_f32 v210, v210
    v_mfma_f32_16x16x32_bf16 v[200:203], a[84:87], a[36:39], v[200:203]
    v_exp_f32 v211, v211
    v_mfma_f32_16x16x32_bf16 v[200:203], a[88:91], a[40:43], v[200:203]
    ds_read_b128 a[100:103], v231 offset:50176
    v_cvt_pk_bf16_f32 v164, v208, v209
    v_mfma_f32_16x16x32_bf16 v[200:203], a[92:95], a[44:47], v[200:203]
    v_cvt_pk_bf16_f32 v165, v210, v211
    v_mul_f32_dpp v77, v77, v246 row_ror:8 row_mask:0xf bank_mask:0xf
    v_mfma_f32_16x16x32_bf16 v[0:3], a[184:187], v[160:163], v[0:3]
    v_mul_f32_dpp v78, v78, v246 row_ror:8 row_mask:0xf bank_mask:0xf
    v_mul_f32_dpp v79, v79, v246 row_ror:8 row_mask:0xf bank_mask:0xf
    v_mfma_f32_16x16x32_bf16 v[32:35], a[184:187], v[168:171], v[32:35]
    ds_write_b64 v236, a[196:197] offset:58368
    v_mfma_f32_16x16x32_bf16 v[64:67], a[184:187], v[176:179], 0
    v_cvt_pk_bf16_f32 v222, v76, v77
    v_cvt_pk_bf16_f32 v223, v78, v79
    v_mfma_f32_16x16x32_bf16 v[96:99], a[184:187], v[184:187], v[96:99]
    v_exp_f32 v212, v212
    v_mfma_f32_16x16x32_bf16 v[128:131], a[184:187], v[192:195], v[128:131]
    v_exp_f32 v213, v213
    v_mfma_f32_16x16x32_bf16 v[132:135], a[188:191], v[192:195], v[132:135]
    v_exp_f32 v214, v214
    v_mfma_f32_16x16x32_bf16 v[100:103], a[188:191], v[184:187], v[100:103]
    v_exp_f32 v215, v215
    v_mfma_f32_16x16x32_bf16 v[68:71], a[188:191], v[176:179], 0
    v_cvt_pk_bf16_f32 v172, v212, v213
    v_cvt_pk_bf16_f32 v173, v214, v215
    v_mfma_f32_16x16x32_bf16 v[36:39], a[188:191], v[168:171], v[36:39]
    v_exp_f32 v200, v200
    v_mfma_f32_16x16x32_bf16 v[4:7], a[188:191], v[160:163], v[4:7]
    v_exp_f32 v201, v201
    v_smfmac_f32_16x16x64_bf16 a[124:127], a[132:135], v[184:191], v238
    v_cvt_pk_bf16_f32 v180, v200, v201
    v_mfma_f32_16x16x32_bf16 v[204:207], a[92:95], a[60:63], -4.0
    v_exp_f32 v202, v202
    v_mfma_f32_16x16x32_bf16 v[204:207], a[88:91], a[56:59], v[204:207]
    v_exp_f32 v203, v203
    v_mfma_f32_16x16x32_bf16 v[204:207], a[84:87], a[52:55], v[204:207]
    v_cvt_pk_bf16_f32 v181, v202, v203
    v_cndmask_b32 v240, v216, v220, vcc
    v_mfma_f32_16x16x32_bf16 v[204:207], a[80:83], a[48:51], v[204:207]
    ds_write_b64 v236, a[198:199] offset:58376
    v_mfma_f32_16x16x32_bf16 v[208:211], a[80:83], a[64:67], -4.0
    ds_read_b128 a[80:83], v228 offset:61440
    v_cndmask_b32 v241, v217, v221, vcc
    v_mfma_f32_16x16x32_bf16 v[208:211], a[84:87], a[68:71], v[208:211]
    ds_read_b128 a[84:87], v228 offset:61696
    v_cndmask_b32 v220, v220, v216, vcc
    v_mfma_f32_16x16x32_bf16 v[208:211], a[88:91], a[72:75], v[208:211]
    ds_read_b128 a[88:91], v228 offset:61952
    v_cndmask_b32 v221, v221, v217, vcc
    v_mfma_f32_16x16x32_bf16 v[208:211], a[92:95], a[76:79], v[208:211]
    s_waitcnt lgkmcnt(4)
    v_exp_f32 v204, v204
    v_mfma_f32_16x16x32_bf16 v[8:11], a[104:107], v[160:163], v[8:11]
    ds_read_b128 a[92:95], v228 offset:62208
    v_mul_f32 v80, v80, v224
    v_mfma_f32_16x16x32_bf16 v[40:43], a[104:107], v[168:171], v[40:43]
    v_exp_f32 v205, v205
    v_mfma_f32_16x16x32_bf16 v[72:75], a[104:107], v[176:179], 0
    v_exp_f32 v206, v206
    v_mfma_f32_16x16x32_bf16 v[104:107], a[104:107], v[184:187], v[104:107]
    v_exp_f32 v207, v207
    v_mfma_f32_16x16x32_bf16 v[136:139], a[104:107], v[192:195], v[136:139]
    ds_read_b128 a[104:107], v239 offset:49152
    v_cvt_pk_bf16_f32 v188, v204, v205
    v_mfma_f32_16x16x32_bf16 v[140:143], a[108:111], v[192:195], v[140:143]
    v_cvt_pk_bf16_f32 v189, v206, v207
    v_mul_f32 v81, v81, v224
    v_mfma_f32_16x16x32_bf16 v[108:111], a[108:111], v[184:187], v[108:111]
    v_mul_f32 v82, v82, v224
    v_mul_f32 v83, v83, v224
    v_mfma_f32_16x16x32_bf16 v[76:79], a[108:111], v[176:179], 0
    v_cvt_pk_bf16_f32 v216, v80, v81
    v_cvt_pk_bf16_f32 v217, v82, v83
    v_mfma_f32_16x16x32_bf16 v[44:47], a[108:111], v[168:171], v[44:47]
    v_cndmask_b32 v242, v218, v222, vcc
    v_cndmask_b32 v243, v219, v223, vcc
    v_mfma_f32_16x16x32_bf16 v[12:15], a[108:111], v[160:163], v[12:15]
    s_waitcnt lgkmcnt(2)
    v_cndmask_b32 v222, v222, v218, vcc
    v_cndmask_b32 v223, v223, v219, vcc
    v_mfma_f32_16x16x32_bf16 v[212:215], a[80:83], a[0:3], -4.0
    ds_read_b128 a[108:111], v239 offset:50176
    v_mul_f32 v84, v84, v224
    v_mfma_f32_16x16x32_bf16 v[212:215], a[84:87], a[4:7], v[212:215]
    v_mul_f32 v85, v85, v224
    v_mul_f32 v86, v86, v224
    v_mfma_f32_16x16x32_bf16 v[212:215], a[88:91], a[8:11], v[212:215]
    s_waitcnt lgkmcnt(2)
    v_mul_f32 v87, v87, v224
    v_cvt_pk_bf16_f32 v218, v84, v85
    v_mfma_f32_16x16x32_bf16 v[212:215], a[92:95], a[12:15], v[212:215]
    v_cvt_pk_bf16_f32 v219, v86, v87
    v_mul_f32_dpp v88, v88, v246 row_ror:8 row_mask:0xf bank_mask:0xf
    v_mfma_f32_16x16x32_bf16 v[200:203], a[92:95], a[28:31], -4.0
    v_exp_f32 v208, v208
    v_mfma_f32_16x16x32_bf16 v[200:203], a[88:91], a[24:27], v[200:203]
    v_exp_f32 v209, v209
    v_mfma_f32_16x16x32_bf16 v[200:203], a[84:87], a[20:23], v[200:203]
    v_exp_f32 v210, v210
    v_mfma_f32_16x16x32_bf16 v[200:203], a[80:83], a[16:19], v[200:203]
    v_exp_f32 v212, v212
    v_mfma_f32_16x16x32_bf16 v[204:207], a[80:83], a[32:35], -4.0
    v_exp_f32 v213, v213
    v_mfma_f32_16x16x32_bf16 v[204:207], a[84:87], a[36:39], v[204:207]
    v_exp_f32 v214, v214
    v_mfma_f32_16x16x32_bf16 v[204:207], a[88:91], a[40:43], v[204:207]
    v_exp_f32 v215, v215
    v_mfma_f32_16x16x32_bf16 v[204:207], a[92:95], a[44:47], v[204:207]
    v_cvt_pk_bf16_f32 v166, v212, v213
    v_cvt_pk_bf16_f32 v167, v214, v215
    v_mfma_f32_16x16x32_bf16 v[16:19], a[96:99], v[160:163], v[16:19]
    v_exp_f32 v211, v211
    v_mfma_f32_16x16x32_bf16 v[48:51], a[96:99], v[168:171], v[48:51]
    v_cvt_pk_bf16_f32 v196, v208, v209
    v_cvt_pk_bf16_f32 v197, v210, v211
    v_mfma_f32_16x16x32_bf16 v[80:83], a[96:99], v[176:179], 0
    v_mul_f32_dpp v89, v89, v246 row_ror:8 row_mask:0xf bank_mask:0xf
    v_mul_f32_dpp v90, v90, v246 row_ror:8 row_mask:0xf bank_mask:0xf
    v_mfma_f32_16x16x32_bf16 v[112:115], a[96:99], v[184:187], v[112:115]
    v_mul_f32_dpp v91, v91, v246 row_ror:8 row_mask:0xf bank_mask:0xf
    v_cvt_pk_bf16_f32 v232, v88, v89
    v_mfma_f32_16x16x32_bf16 v[144:147], a[96:99], v[192:195], v[144:147]
    v_cvt_pk_bf16_f32 v233, v90, v91
    v_mul_f32_dpp v92, v92, v246 row_ror:8 row_mask:0xf bank_mask:0xf
    v_mfma_f32_16x16x32_bf16 v[148:151], a[100:103], v[192:195], v[148:151]
    v_mul_f32_dpp v93, v93, v246 row_ror:8 row_mask:0xf bank_mask:0xf
    v_mul_f32_dpp v94, v94, v246 row_ror:8 row_mask:0xf bank_mask:0xf
    v_mfma_f32_16x16x32_bf16 v[116:119], a[100:103], v[184:187], v[116:119]
    v_mul_f32_dpp v95, v95, v246 row_ror:8 row_mask:0xf bank_mask:0xf
    v_cvt_pk_bf16_f32 v234, v92, v93
    v_mfma_f32_16x16x32_bf16 v[84:87], a[100:103], v[176:179], 0
    v_cvt_pk_bf16_f32 v235, v94, v95
    v_accvgpr_write_b32 a121, 0
    v_mfma_f32_16x16x32_bf16 v[52:55], a[100:103], v[168:171], v[52:55]
    v_exp_f32 v204, v204
    v_mfma_f32_16x16x32_bf16 v[20:23], a[100:103], v[160:163], v[20:23]
    v_exp_f32 v205, v205
    v_smfmac_f32_16x16x64_bf16 a[112:115], a[132:135], v[160:167], v238
    v_cvt_pk_bf16_f32 v182, v204, v205
    v_mfma_f32_16x16x32_bf16 v[208:211], a[92:95], a[60:63], -4.0
    v_exp_f32 v206, v206
    v_mfma_f32_16x16x32_bf16 v[208:211], a[88:91], a[56:59], v[208:211]
    v_exp_f32 v207, v207
    v_mfma_f32_16x16x32_bf16 v[208:211], a[84:87], a[52:55], v[208:211]
    v_cvt_pk_bf16_f32 v183, v206, v207
    v_max3_f32 v227, v226, v224, v227
    v_mfma_f32_16x16x32_bf16 v[208:211], a[80:83], a[48:51], v[208:211]
    v_exp_f32 v200, v200
    v_mfma_f32_16x16x32_bf16 v[212:215], a[80:83], a[64:67], -4.0
    ds_read_b128 a[80:83], v229 offset:0
    v_mfma_f32_16x16x32_bf16 v[212:215], a[84:87], a[68:71], v[212:215]
    ds_read_b128 a[84:87], v229 offset:256
    v_mfma_f32_16x16x32_bf16 v[212:215], a[88:91], a[72:75], v[212:215]
    ds_read_b128 a[88:91], v229 offset:512
    v_mfma_f32_16x16x32_bf16 v[212:215], a[92:95], a[76:79], v[212:215]
    s_waitcnt lgkmcnt(3)
    v_exp_f32 v201, v201
    v_mfma_f32_16x16x32_bf16 v[24:27], a[104:107], v[160:163], v[24:27]
    ds_read_b128 a[92:95], v229 offset:768
    v_cvt_pk_bf16_f32 v174, v200, v201
    v_mfma_f32_16x16x32_bf16 v[56:59], a[104:107], v[168:171], v[56:59]
    v_exp_f32 v202, v202
    v_mfma_f32_16x16x32_bf16 v[88:91], a[104:107], v[176:179], 0
    v_exp_f32 v203, v203
    v_mfma_f32_16x16x32_bf16 v[120:123], a[104:107], v[184:187], v[120:123]
    v_cvt_pk_bf16_f32 v175, v202, v203
    v_mfma_f32_16x16x32_bf16 v[152:155], a[104:107], v[192:195], v[152:155]
    v_exp_f32 v208, v208
    v_mfma_f32_16x16x32_bf16 v[156:159], a[108:111], v[192:195], v[156:159]
    v_exp_f32 v209, v209
    v_mfma_f32_16x16x32_bf16 v[124:127], a[108:111], v[184:187], v[124:127]
    v_exp_f32 v210, v210
    v_mfma_f32_16x16x32_bf16 v[92:95], a[108:111], v[176:179], 0
    v_exp_f32 v211, v211
    v_mfma_f32_16x16x32_bf16 v[60:63], a[108:111], v[168:171], v[60:63]
    v_cvt_pk_bf16_f32 v190, v208, v209
    v_cvt_pk_bf16_f32 v191, v210, v211
    v_mfma_f32_16x16x32_bf16 v[28:31], a[108:111], v[160:163], v[28:31]
    v_exp_f32 v212, v212
    v_smfmac_f32_16x16x64_bf16 a[120:123], a[132:135], v[176:183], v238
    s_waitcnt lgkmcnt(0)
    v_mfma_f32_16x16x32_bf16 v[200:203], a[80:83], a[0:3], -4.0
    v_exp_f32 v213, v213
    v_mfma_f32_16x16x32_bf16 v[200:203], a[84:87], a[4:7], v[200:203]
    v_exp_f32 v214, v214
    v_mfma_f32_16x16x32_bf16 v[200:203], a[88:91], a[8:11], v[200:203]
    v_exp_f32 v215, v215
    v_mfma_f32_16x16x32_bf16 v[200:203], a[92:95], a[12:15], v[200:203]
    v_cvt_pk_bf16_f32 v198, v212, v213
    v_cvt_pk_bf16_f32 v199, v214, v215
    v_mfma_f32_16x16x32_bf16 v[204:207], a[92:95], a[28:31], -4.0
    s_barrier
    v_mfma_f32_16x16x32_bf16 v[204:207], a[88:91], a[24:27], v[204:207]
    buffer_store_dwordx4 v[240:243], v244, s[16:19], s26 offen nt
    v_mfma_f32_16x16x32_bf16 v[204:207], a[84:87], a[20:23], v[204:207]
    ds_write_b64 v236, a[200:201] offset:49152
    v_mfma_f32_16x16x32_bf16 v[204:207], a[80:83], a[16:19], v[204:207]
    ds_read_b128 a[104:107], v230 offset:57344
    v_cndmask_b32 v240, v216, v232, vcc
    v_mfma_f32_16x16x32_bf16 v[208:211], a[80:83], a[32:35], -4.0
    v_exp_f32 v200, v200
    v_mfma_f32_16x16x32_bf16 v[208:211], a[84:87], a[36:39], v[208:211]
    buffer_store_dwordx4 v[220:223], v245, s[16:19], s26 offen nt
    v_mfma_f32_16x16x32_bf16 v[208:211], a[88:91], a[40:43], v[208:211]
    v_exp_f32 v201, v201
    v_mfma_f32_16x16x32_bf16 v[208:211], a[92:95], a[44:47], v[208:211]
    s_add_u32 s26, s26, 16384
    v_exp_f32 v202, v202
    v_mfma_f32_16x16x32_bf16 v[0:3], a[192:195], v[164:167], v[0:3]
    v_exp_f32 v203, v203
    v_mfma_f32_16x16x32_bf16 v[32:35], a[192:195], v[172:175], v[32:35]
    ds_read_b128 a[108:111], v230 offset:58368
    v_cvt_pk_bf16_f32 v160, v200, v201
    v_mfma_f32_16x16x32_bf16 v[64:67], a[192:195], v[180:183], v[64:67]
    ds_read_b128 a[96:99], v231 offset:57344
    v_cvt_pk_bf16_f32 v161, v202, v203
    v_mfma_f32_16x16x32_bf16 v[96:99], a[192:195], v[188:191], v[96:99]
    ds_write_b64 v236, a[202:203] offset:49160
    v_mfma_f32_16x16x32_bf16 v[128:131], a[192:195], v[196:199], v[128:131]
    v_exp_f32 v204, v204
    v_mfma_f32_16x16x32_bf16 v[132:135], a[196:199], v[196:199], v[132:135]
    v_exp_f32 v205, v205
    v_mfma_f32_16x16x32_bf16 v[100:103], a[196:199], v[188:191], v[100:103]
    v_exp_f32 v206, v206
    v_mfma_f32_16x16x32_bf16 v[68:71], a[196:199], v[180:183], v[68:71]
    v_exp_f32 v207, v207
    v_mfma_f32_16x16x32_bf16 v[36:39], a[196:199], v[172:175], v[36:39]
    ds_read_b128 a[100:103], v231 offset:58368
    v_cvt_pk_bf16_f32 v168, v204, v205
    v_mfma_f32_16x16x32_bf16 v[4:7], a[196:199], v[164:167], v[4:7]
    v_cvt_pk_bf16_f32 v169, v206, v207
    v_cndmask_b32 v241, v217, v233, vcc
    v_smfmac_f32_16x16x64_bf16 a[128:131], a[132:135], v[192:199], v238
    ds_write_b64 v236, a[204:205] offset:50176
    v_mfma_f32_16x16x32_bf16 v[212:215], a[92:95], a[60:63], -4.0
    v_exp_f32 v208, v208
    v_mfma_f32_16x16x32_bf16 v[212:215], a[88:91], a[56:59], v[212:215]
    v_exp_f32 v209, v209
    v_mfma_f32_16x16x32_bf16 v[212:215], a[84:87], a[52:55], v[212:215]
    v_exp_f32 v210, v210
    v_mfma_f32_16x16x32_bf16 v[212:215], a[80:83], a[48:51], v[212:215]
    v_exp_f32 v211, v211
    v_mfma_f32_16x16x32_bf16 v[200:203], a[80:83], a[64:67], -4.0
    ds_read_b128 a[80:83], v229 offset:4096
    v_cvt_pk_bf16_f32 v176, v208, v209
    v_mfma_f32_16x16x32_bf16 v[200:203], a[84:87], a[68:71], v[200:203]
    ds_read_b128 a[84:87], v229 offset:4352
    v_cvt_pk_bf16_f32 v177, v210, v211
    v_mfma_f32_16x16x32_bf16 v[200:203], a[88:91], a[72:75], v[200:203]
    ds_read_b128 a[88:91], v229 offset:4608
    v_cndmask_b32 v242, v218, v234, vcc
    v_mfma_f32_16x16x32_bf16 v[200:203], a[92:95], a[76:79], v[200:203]
    s_waitcnt lgkmcnt(4)
    v_exp_f32 v212, v212
    v_mfma_f32_16x16x32_bf16 v[8:11], a[104:107], v[164:167], v[8:11]
    ds_read_b128 a[92:95], v229 offset:4864
    v_cndmask_b32 v243, v219, v235, vcc
    v_mfma_f32_16x16x32_bf16 v[40:43], a[104:107], v[172:175], v[40:43]
    buffer_store_dwordx4 v[240:243], v244, s[16:19], s42 offen nt
    v_mfma_f32_16x16x32_bf16 v[72:75], a[104:107], v[180:183], v[72:75]
    v_exp_f32 v213, v213
    v_mfma_f32_16x16x32_bf16 v[104:107], a[104:107], v[188:191], v[104:107]
    v_exp_f32 v214, v214
    v_mfma_f32_16x16x32_bf16 v[136:139], a[104:107], v[196:199], v[136:139]
    v_exp_f32 v215, v215
    v_mfma_f32_16x16x32_bf16 v[140:143], a[108:111], v[196:199], v[140:143]
    ds_read_b128 a[104:107], v239 offset:57344
    v_cvt_pk_bf16_f32 v184, v212, v213
    v_mfma_f32_16x16x32_bf16 v[108:111], a[108:111], v[188:191], v[108:111]
    v_cvt_pk_bf16_f32 v185, v214, v215
    v_cndmask_b32 v232, v232, v216, vcc
    v_mfma_f32_16x16x32_bf16 v[76:79], a[108:111], v[180:183], v[76:79]
    ds_write_b64 v236, a[206:207] offset:50184
    v_mfma_f32_16x16x32_bf16 v[44:47], a[108:111], v[172:175], v[44:47]
    v_exp_f32 v200, v200
    v_mfma_f32_16x16x32_bf16 v[12:15], a[108:111], v[164:167], v[12:15]
    s_waitcnt lgkmcnt(2)
    v_exp_f32 v201, v201
    v_mfma_f32_16x16x32_bf16 v[204:207], a[80:83], a[0:3], -4.0
    v_exp_f32 v202, v202
    v_mfma_f32_16x16x32_bf16 v[204:207], a[84:87], a[4:7], v[204:207]
    v_exp_f32 v203, v203
    v_mfma_f32_16x16x32_bf16 v[204:207], a[88:91], a[8:11], v[204:207]
    ds_read_b128 a[108:111], v239 offset:58368
    v_cvt_pk_bf16_f32 v192, v200, v201
    v_mfma_f32_16x16x32_bf16 v[204:207], a[92:95], a[12:15], v[204:207]
    v_cvt_pk_bf16_f32 v193, v202, v203
    v_cndmask_b32 v233, v233, v217, vcc
    v_mfma_f32_16x16x32_bf16 v[208:211], a[92:95], a[28:31], -4.0
    v_cndmask_b32 v234, v234, v218, vcc
    v_cndmask_b32 v235, v235, v219, vcc
    v_mfma_f32_16x16x32_bf16 v[208:211], a[88:91], a[24:27], v[208:211]
    buffer_store_dwordx4 v[232:235], v245, s[16:19], s42 offen nt
    v_mfma_f32_16x16x32_bf16 v[208:211], a[84:87], a[20:23], v[208:211]
    v_exp_f32 v204, v204
    v_mfma_f32_16x16x32_bf16 v[208:211], a[80:83], a[16:19], v[208:211]
    s_add_u32 s42, s42, 16384
    v_exp_f32 v205, v205
    v_mfma_f32_16x16x32_bf16 v[212:215], a[80:83], a[32:35], -4.0
    v_exp_f32 v206, v206
    v_mfma_f32_16x16x32_bf16 v[212:215], a[84:87], a[36:39], v[212:215]
    v_exp_f32 v207, v207
    v_mfma_f32_16x16x32_bf16 v[212:215], a[88:91], a[40:43], v[212:215]
    v_cvt_pk_bf16_f32 v162, v204, v205
    v_cvt_pk_bf16_f32 v163, v206, v207
    v_mfma_f32_16x16x32_bf16 v[212:215], a[92:95], a[44:47], v[212:215]
    v_exp_f32 v208, v208
    v_mfma_f32_16x16x32_bf16 v[16:19], a[96:99], v[164:167], v[16:19]
    v_exp_f32 v209, v209
    v_mfma_f32_16x16x32_bf16 v[48:51], a[96:99], v[172:175], v[48:51]
    v_exp_f32 v210, v210
    v_mfma_f32_16x16x32_bf16 v[80:83], a[96:99], v[180:183], v[80:83]
    v_exp_f32 v211, v211
    v_mfma_f32_16x16x32_bf16 v[112:115], a[96:99], v[188:191], v[112:115]
    v_cvt_pk_bf16_f32 v170, v208, v209
    v_cvt_pk_bf16_f32 v171, v210, v211
    v_mfma_f32_16x16x32_bf16 v[144:147], a[96:99], v[196:199], v[144:147]
    v_exp_f32 v212, v212
    v_mfma_f32_16x16x32_bf16 v[148:151], a[100:103], v[196:199], v[148:151]
    v_exp_f32 v213, v213
    v_mfma_f32_16x16x32_bf16 v[116:119], a[100:103], v[188:191], v[116:119]
    v_exp_f32 v214, v214
    v_mfma_f32_16x16x32_bf16 v[84:87], a[100:103], v[180:183], v[84:87]
    v_exp_f32 v215, v215
    v_mfma_f32_16x16x32_bf16 v[52:55], a[100:103], v[172:175], v[52:55]
    v_cvt_pk_bf16_f32 v178, v212, v213
    v_cvt_pk_bf16_f32 v179, v214, v215
    v_mfma_f32_16x16x32_bf16 v[20:23], a[100:103], v[164:167], v[20:23]
    s_waitcnt lgkmcnt(0)
    v_mfma_f32_16x16x32_bf16 v[200:203], a[92:95], a[60:63], -4.0
    s_barrier
    v_mfma_f32_16x16x32_bf16 v[200:203], a[88:91], a[56:59], v[200:203]
    ds_write_b64 v236, a[208:209] offset:57344
    v_mfma_f32_16x16x32_bf16 v[200:203], a[84:87], a[52:55], v[200:203]
    s_waitcnt vmcnt(4)
    v_accvgpr_mov_b32 a60, a252
    v_accvgpr_mov_b32 a61, a253
    v_mfma_f32_16x16x32_bf16 v[200:203], a[80:83], a[48:51], v[200:203]
    ds_write_b64 v236, a[210:211] offset:57352
    v_mfma_f32_16x16x32_bf16 v[204:207], a[80:83], a[64:67], -4.0
    ds_read_b128 a[80:83], v229 offset:8192
    v_accvgpr_mov_b32 a62, a254
    v_mfma_f32_16x16x32_bf16 v[204:207], a[84:87], a[68:71], v[204:207]
    ds_read_b128 a[84:87], v229 offset:8448
    v_accvgpr_mov_b32 a63, a255
    v_mfma_f32_16x16x32_bf16 v[204:207], a[88:91], a[72:75], v[204:207]
    ds_read_b128 a[88:91], v229 offset:8704
    v_accvgpr_mov_b32 a56, a248
    v_mfma_f32_16x16x32_bf16 v[204:207], a[92:95], a[76:79], v[204:207]
    ds_read_b128 a[92:95], v229 offset:8960
    v_accvgpr_mov_b32 a57, a249
    v_mfma_f32_16x16x32_bf16 v[24:27], a[104:107], v[164:167], v[24:27]
    v_exp_f32 v200, v200
    v_mfma_f32_16x16x32_bf16 v[56:59], a[104:107], v[172:175], v[56:59]
    v_exp_f32 v201, v201
    v_mfma_f32_16x16x32_bf16 v[88:91], a[104:107], v[180:183], v[88:91]
    v_exp_f32 v202, v202
    v_mfma_f32_16x16x32_bf16 v[120:123], a[104:107], v[188:191], v[120:123]
    v_exp_f32 v203, v203
    v_mfma_f32_16x16x32_bf16 v[152:155], a[104:107], v[196:199], v[152:155]
    ds_read_b128 a[104:107], v230 offset:49152
    v_cvt_pk_bf16_f32 v186, v200, v201
    v_mfma_f32_16x16x32_bf16 v[156:159], a[108:111], v[196:199], v[156:159]
    ds_read_b128 a[96:99], v231 offset:49152
    v_cvt_pk_bf16_f32 v187, v202, v203
    v_mfma_f32_16x16x32_bf16 v[124:127], a[108:111], v[188:191], v[124:127]
    v_exp_f32 v204, v204
    v_mfma_f32_16x16x32_bf16 v[92:95], a[108:111], v[180:183], v[92:95]
    v_exp_f32 v205, v205
    v_mfma_f32_16x16x32_bf16 v[60:63], a[108:111], v[172:175], v[60:63]
    v_exp_f32 v206, v206
    v_mfma_f32_16x16x32_bf16 v[28:31], a[108:111], v[164:167], v[28:31]
    v_exp_f32 v207, v207
    v_smfmac_f32_16x16x64_bf16 a[116:119], a[132:135], v[168:175], v238
    s_waitcnt lgkmcnt(2)
    s_add_u32 s4, s4, 16384
    s_addc_u32 s5, s5, 0
    v_mfma_f32_16x16x32_bf16 v[208:211], a[80:83], a[0:3], -4.0
    global_load_dwordx4 a[252:255], v237, s[4:5] offset:192
    v_mfma_f32_16x16x32_bf16 v[208:211], a[84:87], a[4:7], v[208:211]
    ds_read_b128 a[108:111], v230 offset:50176
    v_cvt_pk_bf16_f32 v194, v204, v205
    v_mfma_f32_16x16x32_bf16 v[208:211], a[88:91], a[8:11], v[208:211]
    ds_read_b128 a[100:103], v231 offset:50176
    v_cvt_pk_bf16_f32 v195, v206, v207
    v_mfma_f32_16x16x32_bf16 v[208:211], a[92:95], a[12:15], v[208:211]
    ds_write_b64 v236, a[212:213] offset:58368
    v_mfma_f32_16x16x32_bf16 v[212:215], a[92:95], a[28:31], -4.0
    v_accvgpr_mov_b32 a58, a250
    v_accvgpr_mov_b32 a59, a251
    v_mfma_f32_16x16x32_bf16 v[212:215], a[88:91], a[24:27], v[212:215]
    global_load_dwordx4 a[248:251], v237, s[4:5] offset:128
    v_mfma_f32_16x16x32_bf16 v[212:215], a[84:87], a[20:23], v[212:215]
    v_accvgpr_mov_b32 a52, a244
    v_accvgpr_mov_b32 a53, a245
    v_mfma_f32_16x16x32_bf16 v[212:215], a[80:83], a[16:19], v[212:215]
    v_accvgpr_mov_b32 a54, a246
    v_accvgpr_mov_b32 a55, a247
    v_mfma_f32_16x16x32_bf16 v[200:203], a[80:83], a[32:35], -4.0
    global_load_dwordx4 a[244:247], v237, s[4:5] offset:64
    v_mfma_f32_16x16x32_bf16 v[200:203], a[84:87], a[36:39], v[200:203]
    v_accvgpr_mov_b32 a48, a240
    v_accvgpr_mov_b32 a49, a241
    v_mfma_f32_16x16x32_bf16 v[200:203], a[88:91], a[40:43], v[200:203]
    v_accvgpr_mov_b32 a50, a242
    v_accvgpr_mov_b32 a51, a243
    v_mfma_f32_16x16x32_bf16 v[200:203], a[92:95], a[44:47], v[200:203]
    global_load_dwordx4 a[240:243], v237, s[4:5] offset:0
    v_mfma_f32_16x16x32_bf16 v[0:3], a[200:203], v[160:163], v[0:3]
    v_exp_f32 v208, v208
    v_mfma_f32_16x16x32_bf16 v[32:35], a[200:203], v[168:171], v[32:35]
    v_exp_f32 v209, v209
    v_mfma_f32_16x16x32_bf16 v[64:67], a[200:203], v[176:179], v[64:67]
    v_exp_f32 v210, v210
    v_mfma_f32_16x16x32_bf16 v[96:99], a[200:203], v[184:187], v[96:99]
    v_exp_f32 v211, v211
    v_mfma_f32_16x16x32_bf16 v[128:131], a[200:203], v[192:195], v[128:131]
    v_cvt_pk_bf16_f32 v164, v208, v209
    v_cvt_pk_bf16_f32 v165, v210, v211
    v_mfma_f32_16x16x32_bf16 v[132:135], a[204:207], v[192:195], v[132:135]
    ds_write_b64 v236, a[214:215] offset:58376
    v_mfma_f32_16x16x32_bf16 v[100:103], a[204:207], v[184:187], v[100:103]
    v_exp_f32 v212, v212
    v_mfma_f32_16x16x32_bf16 v[68:71], a[204:207], v[176:179], v[68:71]
    v_exp_f32 v213, v213
    v_mfma_f32_16x16x32_bf16 v[36:39], a[204:207], v[168:171], v[36:39]
    v_exp_f32 v214, v214
    v_mfma_f32_16x16x32_bf16 v[4:7], a[204:207], v[160:163], v[4:7]
    v_exp_f32 v215, v215
    v_smfmac_f32_16x16x64_bf16 a[124:127], a[132:135], v[184:191], v238
    v_cvt_pk_bf16_f32 v172, v212, v213
    v_mfma_f32_16x16x32_bf16 v[204:207], a[92:95], a[60:63], -4.0
    v_cvt_pk_bf16_f32 v173, v214, v215
    v_mfma_f32_16x16x32_bf16 v[204:207], a[88:91], a[56:59], v[204:207]
    v_exp_f32 v200, v200
    v_mfma_f32_16x16x32_bf16 v[204:207], a[84:87], a[52:55], v[204:207]
    v_exp_f32 v201, v201
    v_mfma_f32_16x16x32_bf16 v[204:207], a[80:83], a[48:51], v[204:207]
    v_accvgpr_read_b32 v225, a124
    v_accvgpr_read_b32 v226, a125
    v_mfma_f32_16x16x32_bf16 v[208:211], a[80:83], a[64:67], -4.0
    ds_read_b128 a[80:83], v229 offset:12288
    v_add_f32 v226, v226, v225
    v_mfma_f32_16x16x32_bf16 v[208:211], a[84:87], a[68:71], v[208:211]
    v_rcp_f32 v225, v226
    v_mfma_f32_16x16x32_bf16 v[208:211], a[88:91], a[72:75], v[208:211]
    ds_read_b128 a[84:87], v229 offset:12544
    v_cvt_pk_bf16_f32 v180, v200, v201
    v_mfma_f32_16x16x32_bf16 v[208:211], a[92:95], a[76:79], v[208:211]
    s_waitcnt lgkmcnt(2)
    v_exp_f32 v202, v202
    v_mfma_f32_16x16x32_bf16 v[8:11], a[104:107], v[160:163], v[8:11]
    ds_read_b128 a[88:91], v229 offset:12800
    v_mul_f32 v96, v96, v225
    v_mfma_f32_16x16x32_bf16 v[40:43], a[104:107], v[168:171], v[40:43]
    ds_read_b128 a[92:95], v229 offset:13056
    v_mul_f32 v97, v97, v225
    v_mfma_f32_16x16x32_bf16 v[72:75], a[104:107], v[176:179], v[72:75]
    v_exp_f32 v203, v203
    v_mfma_f32_16x16x32_bf16 v[104:107], a[104:107], v[184:187], v[104:107]
    v_cvt_pk_bf16_f32 v181, v202, v203
    v_mul_f32 v98, v98, v225
    v_mfma_f32_16x16x32_bf16 v[136:139], a[104:107], v[192:195], v[136:139]
    v_exp_f32 v204, v204
    v_mfma_f32_16x16x32_bf16 v[140:143], a[108:111], v[192:195], v[140:143]
    v_exp_f32 v205, v205
    v_mfma_f32_16x16x32_bf16 v[108:111], a[108:111], v[184:187], v[108:111]
    v_exp_f32 v206, v206
    v_mfma_f32_16x16x32_bf16 v[76:79], a[108:111], v[176:179], v[76:79]
    v_exp_f32 v207, v207
    v_mfma_f32_16x16x32_bf16 v[44:47], a[108:111], v[168:171], v[44:47]
    ds_read_b128 a[104:107], v239 offset:49152
    v_cvt_pk_bf16_f32 v188, v204, v205
    v_mfma_f32_16x16x32_bf16 v[12:15], a[108:111], v[160:163], v[12:15]
    s_waitcnt lgkmcnt(3)
    v_cvt_pk_bf16_f32 v189, v206, v207
    v_mul_f32 v99, v99, v225
    v_mfma_f32_16x16x32_bf16 v[212:215], a[80:83], a[0:3], -4.0
    v_exp_f32 v208, v208
    v_mfma_f32_16x16x32_bf16 v[212:215], a[84:87], a[4:7], v[212:215]
    s_waitcnt lgkmcnt(1)
    v_exp_f32 v209, v209
    v_mfma_f32_16x16x32_bf16 v[212:215], a[88:91], a[8:11], v[212:215]
    v_exp_f32 v210, v210
    v_mfma_f32_16x16x32_bf16 v[212:215], a[92:95], a[12:15], v[212:215]
    v_exp_f32 v211, v211
    v_mfma_f32_16x16x32_bf16 v[200:203], a[92:95], a[28:31], -4.0
    ds_read_b128 a[108:111], v239 offset:50176
    v_cvt_pk_bf16_f32 v196, v208, v209
    v_mfma_f32_16x16x32_bf16 v[200:203], a[88:91], a[24:27], v[200:203]
    v_cvt_pk_bf16_f32 v197, v210, v211
    v_cvt_pk_bf16_f32 v216, v96, v97
    v_mfma_f32_16x16x32_bf16 v[200:203], a[84:87], a[20:23], v[200:203]
    v_exp_f32 v212, v212
    v_mfma_f32_16x16x32_bf16 v[200:203], a[80:83], a[16:19], v[200:203]
    v_exp_f32 v213, v213
    v_mfma_f32_16x16x32_bf16 v[204:207], a[80:83], a[32:35], -4.0
    v_exp_f32 v214, v214
    v_mfma_f32_16x16x32_bf16 v[204:207], a[84:87], a[36:39], v[204:207]
    v_exp_f32 v215, v215
    v_mfma_f32_16x16x32_bf16 v[204:207], a[88:91], a[40:43], v[204:207]
    v_cvt_pk_bf16_f32 v166, v212, v213
    v_cvt_pk_bf16_f32 v167, v214, v215
    v_mfma_f32_16x16x32_bf16 v[204:207], a[92:95], a[44:47], v[204:207]
    v_exp_f32 v200, v200
    v_mfma_f32_16x16x32_bf16 v[16:19], a[96:99], v[160:163], v[16:19]
    v_exp_f32 v201, v201
    v_mfma_f32_16x16x32_bf16 v[48:51], a[96:99], v[168:171], v[48:51]
    v_exp_f32 v202, v202
    v_mfma_f32_16x16x32_bf16 v[80:83], a[96:99], v[176:179], v[80:83]
    v_exp_f32 v203, v203
    v_mfma_f32_16x16x32_bf16 v[112:115], a[96:99], v[184:187], v[112:115]
    v_exp_f32 v204, v204
    v_mfma_f32_16x16x32_bf16 v[144:147], a[96:99], v[192:195], v[144:147]
    v_exp_f32 v205, v205
    v_mfma_f32_16x16x32_bf16 v[148:151], a[100:103], v[192:195], v[148:151]
    v_exp_f32 v206, v206
    v_mfma_f32_16x16x32_bf16 v[116:119], a[100:103], v[184:187], v[116:119]
    v_exp_f32 v207, v207
    v_mfma_f32_16x16x32_bf16 v[84:87], a[100:103], v[176:179], v[84:87]
    v_cvt_pk_bf16_f32 v182, v204, v205
    v_cvt_pk_bf16_f32 v183, v206, v207
    v_mfma_f32_16x16x32_bf16 v[52:55], a[100:103], v[168:171], v[52:55]
    v_cvt_pk_bf16_f32 v174, v200, v201
    v_cvt_pk_bf16_f32 v175, v202, v203
    v_mfma_f32_16x16x32_bf16 v[20:23], a[100:103], v[160:163], v[20:23]
    v_cvt_pk_bf16_f32 v217, v98, v99
    v_mul_f32 v100, v100, v225
    v_smfmac_f32_16x16x64_bf16 a[112:115], a[132:135], v[160:167], v238
    v_mul_f32 v101, v101, v225
    v_mfma_f32_16x16x32_bf16 v[208:211], a[92:95], a[60:63], -4.0
    v_mul_f32 v102, v102, v225
    v_mul_f32 v103, v103, v225
    v_mfma_f32_16x16x32_bf16 v[208:211], a[88:91], a[56:59], v[208:211]
    v_cvt_pk_bf16_f32 v218, v100, v101
    v_cvt_pk_bf16_f32 v219, v102, v103
    v_mfma_f32_16x16x32_bf16 v[208:211], a[84:87], a[52:55], v[208:211]
    s_waitcnt lgkmcnt(0)
    v_mov_b32_dpp v246, v225 row_ror:8 row_mask:0xf bank_mask:0xf
    v_mul_f32 v112, v112, v225
    v_mfma_f32_16x16x32_bf16 v[208:211], a[80:83], a[48:51], v[208:211]
    s_barrier
    v_mfma_f32_16x16x32_bf16 v[212:215], a[80:83], a[64:67], -4.0
    ds_read_b128 a[80:83], v229 offset:16384
    v_mul_f32_dpp v104, v104, v246 row_ror:8 row_mask:0xf bank_mask:0xf
    v_mfma_f32_16x16x32_bf16 v[212:215], a[84:87], a[68:71], v[212:215]
    ds_read_b128 a[84:87], v229 offset:16640
    v_mul_f32_dpp v105, v105, v246 row_ror:8 row_mask:0xf bank_mask:0xf
    v_mfma_f32_16x16x32_bf16 v[212:215], a[88:91], a[72:75], v[212:215]
    ds_read_b128 a[88:91], v229 offset:16896
    v_mul_f32_dpp v106, v106, v246 row_ror:8 row_mask:0xf bank_mask:0xf
    v_mfma_f32_16x16x32_bf16 v[212:215], a[92:95], a[76:79], v[212:215]
    ds_read_b128 a[92:95], v229 offset:17152
    v_mul_f32_dpp v107, v107, v246 row_ror:8 row_mask:0xf bank_mask:0xf
    v_mfma_f32_16x16x32_bf16 v[24:27], a[104:107], v[160:163], v[24:27]
    ds_write_b64 v236, a[216:217] offset:49152
    v_mfma_f32_16x16x32_bf16 v[56:59], a[104:107], v[168:171], v[56:59]
    v_exp_f32 v208, v208
    v_mfma_f32_16x16x32_bf16 v[88:91], a[104:107], v[176:179], v[88:91]
    v_exp_f32 v209, v209
    v_mfma_f32_16x16x32_bf16 v[120:123], a[104:107], v[184:187], v[120:123]
    v_exp_f32 v210, v210
    v_mfma_f32_16x16x32_bf16 v[152:155], a[104:107], v[192:195], v[152:155]
    v_exp_f32 v211, v211
    v_mfma_f32_16x16x32_bf16 v[156:159], a[108:111], v[192:195], v[156:159]
    ds_read_b128 a[104:107], v230 offset:57344
    v_cvt_pk_bf16_f32 v190, v208, v209
    v_mfma_f32_16x16x32_bf16 v[124:127], a[108:111], v[184:187], v[124:127]
    ds_read_b128 a[96:99], v231 offset:57344
    v_cvt_pk_bf16_f32 v191, v210, v211
    v_mfma_f32_16x16x32_bf16 v[92:95], a[108:111], v[176:179], v[92:95]
    ds_write_b64 v236, a[218:219] offset:49160
    v_mfma_f32_16x16x32_bf16 v[60:63], a[108:111], v[168:171], v[60:63]
    v_exp_f32 v212, v212
    v_mfma_f32_16x16x32_bf16 v[28:31], a[108:111], v[160:163], v[28:31]
    v_exp_f32 v213, v213
    v_smfmac_f32_16x16x64_bf16 a[120:123], a[132:135], v[176:183], v238
    s_waitcnt lgkmcnt(3)
    v_cvt_pk_bf16_f32 v198, v212, v213
    v_mfma_f32_16x16x32_bf16 v[200:203], a[80:83], a[0:3], -4.0
    v_exp_f32 v214, v214
    v_mfma_f32_16x16x32_bf16 v[200:203], a[84:87], a[4:7], v[200:203]
    v_exp_f32 v215, v215
    v_mfma_f32_16x16x32_bf16 v[200:203], a[88:91], a[8:11], v[200:203]
    ds_read_b128 a[108:111], v230 offset:58368
    v_cvt_pk_bf16_f32 v199, v214, v215
    v_mfma_f32_16x16x32_bf16 v[200:203], a[92:95], a[12:15], v[200:203]
    ds_write_b64 v236, a[220:221] offset:50176
    v_mfma_f32_16x16x32_bf16 v[204:207], a[92:95], a[28:31], -4.0
    ds_read_b128 a[100:103], v231 offset:58368
    v_cvt_pk_bf16_f32 v220, v104, v105
    v_mfma_f32_16x16x32_bf16 v[204:207], a[88:91], a[24:27], v[204:207]
    ds_write_b64 v236, a[222:223] offset:50184
    v_mfma_f32_16x16x32_bf16 v[204:207], a[84:87], a[20:23], v[204:207]
    v_cvt_pk_bf16_f32 v221, v106, v107
    v_mul_f32_dpp v108, v108, v246 row_ror:8 row_mask:0xf bank_mask:0xf
    v_mfma_f32_16x16x32_bf16 v[204:207], a[80:83], a[16:19], v[204:207]
    v_exp_f32 v200, v200
    v_mfma_f32_16x16x32_bf16 v[208:211], a[80:83], a[32:35], -4.0
    v_exp_f32 v201, v201
    v_mfma_f32_16x16x32_bf16 v[208:211], a[84:87], a[36:39], v[208:211]
    v_exp_f32 v202, v202
    v_mfma_f32_16x16x32_bf16 v[208:211], a[88:91], a[40:43], v[208:211]
    v_exp_f32 v203, v203
    v_mfma_f32_16x16x32_bf16 v[208:211], a[92:95], a[44:47], v[208:211]
    v_cvt_pk_bf16_f32 v160, v200, v201
    v_cvt_pk_bf16_f32 v161, v202, v203
    v_mfma_f32_16x16x32_bf16 v[0:3], a[208:211], v[164:167], v[0:3]
    v_mul_f32_dpp v109, v109, v246 row_ror:8 row_mask:0xf bank_mask:0xf
    v_mul_f32_dpp v110, v110, v246 row_ror:8 row_mask:0xf bank_mask:0xf
    v_mfma_f32_16x16x32_bf16 v[32:35], a[208:211], v[172:175], v[32:35]
    v_mul_f32_dpp v111, v111, v246 row_ror:8 row_mask:0xf bank_mask:0xf
    v_cvt_pk_bf16_f32 v222, v108, v109
    v_mfma_f32_16x16x32_bf16 v[64:67], a[208:211], v[180:183], v[64:67]
    v_cvt_pk_bf16_f32 v223, v110, v111
    v_cndmask_b32 v240, v216, v220, vcc
    v_mfma_f32_16x16x32_bf16 v[96:99], a[208:211], v[188:191], 0
    v_exp_f32 v204, v204
    v_mfma_f32_16x16x32_bf16 v[128:131], a[208:211], v[196:199], v[128:131]
    v_exp_f32 v205, v205
    v_mfma_f32_16x16x32_bf16 v[132:135], a[212:215], v[196:199], v[132:135]
    v_exp_f32 v206, v206
    v_mfma_f32_16x16x32_bf16 v[100:103], a[212:215], v[188:191], 0
    v_exp_f32 v207, v207
    v_mfma_f32_16x16x32_bf16 v[68:71], a[212:215], v[180:183], v[68:71]
    v_cvt_pk_bf16_f32 v168, v204, v205
    v_cvt_pk_bf16_f32 v169, v206, v207
    v_mfma_f32_16x16x32_bf16 v[36:39], a[212:215], v[172:175], v[36:39]
    v_exp_f32 v208, v208
    v_mfma_f32_16x16x32_bf16 v[4:7], a[212:215], v[164:167], v[4:7]
    v_exp_f32 v209, v209
    v_smfmac_f32_16x16x64_bf16 a[128:131], a[132:135], v[192:199], v238
    v_cvt_pk_bf16_f32 v176, v208, v209
    v_mfma_f32_16x16x32_bf16 v[212:215], a[92:95], a[60:63], -4.0
    v_exp_f32 v210, v210
    v_mfma_f32_16x16x32_bf16 v[212:215], a[88:91], a[56:59], v[212:215]
    v_exp_f32 v211, v211
    v_mfma_f32_16x16x32_bf16 v[212:215], a[84:87], a[52:55], v[212:215]
    v_cvt_pk_bf16_f32 v177, v210, v211
    v_cndmask_b32 v241, v217, v221, vcc
    v_mfma_f32_16x16x32_bf16 v[212:215], a[80:83], a[48:51], v[212:215]
    v_cndmask_b32 v220, v220, v216, vcc
    v_cndmask_b32 v221, v221, v217, vcc
    v_mfma_f32_16x16x32_bf16 v[200:203], a[80:83], a[64:67], -4.0
    ds_read_b128 a[80:83], v229 offset:20480
    v_mul_f32 v113, v113, v225
    v_mfma_f32_16x16x32_bf16 v[200:203], a[84:87], a[68:71], v[200:203]
    ds_read_b128 a[84:87], v229 offset:20736
    v_mul_f32 v114, v114, v225
    v_mfma_f32_16x16x32_bf16 v[200:203], a[88:91], a[72:75], v[200:203]
    ds_read_b128 a[88:91], v229 offset:20992
    v_mul_f32 v115, v115, v225
    v_mfma_f32_16x16x32_bf16 v[200:203], a[92:95], a[76:79], v[200:203]
    s_waitcnt lgkmcnt(3)
    v_exp_f32 v212, v212
    v_mfma_f32_16x16x32_bf16 v[8:11], a[104:107], v[164:167], v[8:11]
    ds_read_b128 a[92:95], v229 offset:21248
    v_cvt_pk_bf16_f32 v216, v112, v113
    v_mfma_f32_16x16x32_bf16 v[40:43], a[104:107], v[172:175], v[40:43]
    v_exp_f32 v213, v213
    v_mfma_f32_16x16x32_bf16 v[72:75], a[104:107], v[180:183], v[72:75]
    v_exp_f32 v214, v214
    v_mfma_f32_16x16x32_bf16 v[104:107], a[104:107], v[188:191], 0
    v_exp_f32 v215, v215
    v_mfma_f32_16x16x32_bf16 v[136:139], a[104:107], v[196:199], v[136:139]
    ds_read_b128 a[104:107], v239 offset:57344
    v_cvt_pk_bf16_f32 v184, v212, v213
    v_mfma_f32_16x16x32_bf16 v[140:143], a[108:111], v[196:199], v[140:143]
    v_cvt_pk_bf16_f32 v185, v214, v215
    v_cvt_pk_bf16_f32 v217, v114, v115
    v_mfma_f32_16x16x32_bf16 v[108:111], a[108:111], v[188:191], 0
    v_cndmask_b32 v242, v218, v222, vcc
    v_cndmask_b32 v243, v219, v223, vcc
    v_mfma_f32_16x16x32_bf16 v[76:79], a[108:111], v[180:183], v[76:79]
    v_cndmask_b32 v222, v222, v218, vcc
    v_cndmask_b32 v223, v223, v219, vcc
    v_mfma_f32_16x16x32_bf16 v[44:47], a[108:111], v[172:175], v[44:47]
    v_mul_f32 v116, v116, v225
    v_mul_f32 v117, v117, v225
    v_mfma_f32_16x16x32_bf16 v[12:15], a[108:111], v[164:167], v[12:15]
    s_waitcnt lgkmcnt(2)
    v_mul_f32 v118, v118, v225
    v_mul_f32 v119, v119, v225
    v_mfma_f32_16x16x32_bf16 v[204:207], a[80:83], a[0:3], -4.0
    ds_read_b128 a[108:111], v239 offset:58368
    v_cvt_pk_bf16_f32 v218, v116, v117
    v_mfma_f32_16x16x32_bf16 v[204:207], a[84:87], a[4:7], v[204:207]
    v_cvt_pk_bf16_f32 v219, v118, v119
    v_mul_f32_dpp v120, v120, v246 row_ror:8 row_mask:0xf bank_mask:0xf
    v_mfma_f32_16x16x32_bf16 v[204:207], a[88:91], a[8:11], v[204:207]
    s_waitcnt lgkmcnt(2)
    v_exp_f32 v200, v200
    v_mfma_f32_16x16x32_bf16 v[204:207], a[92:95], a[12:15], v[204:207]
    v_exp_f32 v201, v201
    v_mfma_f32_16x16x32_bf16 v[208:211], a[92:95], a[28:31], -4.0
    v_exp_f32 v202, v202
    v_mfma_f32_16x16x32_bf16 v[208:211], a[88:91], a[24:27], v[208:211]
    v_exp_f32 v203, v203
    v_mfma_f32_16x16x32_bf16 v[208:211], a[84:87], a[20:23], v[208:211]
    v_cvt_pk_bf16_f32 v192, v200, v201
    v_cvt_pk_bf16_f32 v193, v202, v203
    v_mfma_f32_16x16x32_bf16 v[208:211], a[80:83], a[16:19], v[208:211]
    v_exp_f32 v204, v204
    v_mfma_f32_16x16x32_bf16 v[212:215], a[80:83], a[32:35], -4.0
    v_exp_f32 v205, v205
    v_mfma_f32_16x16x32_bf16 v[212:215], a[84:87], a[36:39], v[212:215]
    v_exp_f32 v206, v206
    v_mfma_f32_16x16x32_bf16 v[212:215], a[88:91], a[40:43], v[212:215]
    v_exp_f32 v207, v207
    v_mfma_f32_16x16x32_bf16 v[212:215], a[92:95], a[44:47], v[212:215]
    v_cvt_pk_bf16_f32 v162, v204, v205
    v_cvt_pk_bf16_f32 v163, v206, v207
    v_mfma_f32_16x16x32_bf16 v[16:19], a[96:99], v[164:167], v[16:19]
    v_mul_f32_dpp v121, v121, v246 row_ror:8 row_mask:0xf bank_mask:0xf
    v_mul_f32_dpp v122, v122, v246 row_ror:8 row_mask:0xf bank_mask:0xf
    v_mfma_f32_16x16x32_bf16 v[48:51], a[96:99], v[172:175], v[48:51]
    v_mul_f32_dpp v123, v123, v246 row_ror:8 row_mask:0xf bank_mask:0xf
    v_cvt_pk_bf16_f32 v232, v120, v121
    v_mfma_f32_16x16x32_bf16 v[80:83], a[96:99], v[180:183], v[80:83]
    v_cvt_pk_bf16_f32 v233, v122, v123
    v_mul_f32_dpp v124, v124, v246 row_ror:8 row_mask:0xf bank_mask:0xf
    v_mfma_f32_16x16x32_bf16 v[112:115], a[96:99], v[188:191], 0
    v_mul_f32_dpp v125, v125, v246 row_ror:8 row_mask:0xf bank_mask:0xf
    v_mul_f32_dpp v126, v126, v246 row_ror:8 row_mask:0xf bank_mask:0xf
    v_mfma_f32_16x16x32_bf16 v[144:147], a[96:99], v[196:199], v[144:147]
    v_mul_f32_dpp v127, v127, v246 row_ror:8 row_mask:0xf bank_mask:0xf
    v_cvt_pk_bf16_f32 v234, v124, v125
    v_mfma_f32_16x16x32_bf16 v[148:151], a[100:103], v[196:199], v[148:151]
    v_cvt_pk_bf16_f32 v235, v126, v127
    v_accvgpr_write_b32 a124, 0
    v_mfma_f32_16x16x32_bf16 v[116:119], a[100:103], v[188:191], 0
    v_exp_f32 v208, v208
    v_mfma_f32_16x16x32_bf16 v[84:87], a[100:103], v[180:183], v[84:87]
    v_exp_f32 v209, v209
    v_mfma_f32_16x16x32_bf16 v[52:55], a[100:103], v[172:175], v[52:55]
    v_exp_f32 v210, v210
    v_mfma_f32_16x16x32_bf16 v[20:23], a[100:103], v[164:167], v[20:23]
    v_exp_f32 v211, v211
    v_mfma_f32_16x16x32_bf16 v[200:203], a[92:95], a[60:63], -4.0
    v_cvt_pk_bf16_f32 v170, v208, v209
    v_cvt_pk_bf16_f32 v171, v210, v211
    v_mfma_f32_16x16x32_bf16 v[200:203], a[88:91], a[56:59], v[200:203]
    v_exp_f32 v212, v212
    v_mfma_f32_16x16x32_bf16 v[200:203], a[84:87], a[52:55], v[200:203]
    v_exp_f32 v213, v213
    v_mfma_f32_16x16x32_bf16 v[200:203], a[80:83], a[48:51], v[200:203]
    v_exp_f32 v214, v214
    v_mfma_f32_16x16x32_bf16 v[204:207], a[80:83], a[64:67], -4.0
    ds_read_b128 a[80:83], v229 offset:24576
    v_cvt_pk_bf16_f32 v178, v212, v213
    v_mfma_f32_16x16x32_bf16 v[204:207], a[84:87], a[68:71], v[204:207]
    ds_read_b128 a[84:87], v229 offset:24832
    v_accvgpr_write_b32 a125, 0
    v_mfma_f32_16x16x32_bf16 v[204:207], a[88:91], a[72:75], v[204:207]
    ds_read_b128 a[88:91], v229 offset:25088
    v_max3_f32 v227, v226, v225, v227
    v_mfma_f32_16x16x32_bf16 v[204:207], a[92:95], a[76:79], v[204:207]
    s_waitcnt lgkmcnt(3)
    v_exp_f32 v215, v215
    v_mfma_f32_16x16x32_bf16 v[24:27], a[104:107], v[164:167], v[24:27]
    ds_read_b128 a[92:95], v229 offset:25344
    v_cvt_pk_bf16_f32 v179, v214, v215
    v_mfma_f32_16x16x32_bf16 v[56:59], a[104:107], v[172:175], v[56:59]
    v_exp_f32 v200, v200
    v_mfma_f32_16x16x32_bf16 v[88:91], a[104:107], v[180:183], v[88:91]
    v_exp_f32 v201, v201
    v_mfma_f32_16x16x32_bf16 v[120:123], a[104:107], v[188:191], 0
    v_exp_f32 v202, v202
    v_mfma_f32_16x16x32_bf16 v[152:155], a[104:107], v[196:199], v[152:155]
    v_exp_f32 v203, v203
    v_mfma_f32_16x16x32_bf16 v[156:159], a[108:111], v[196:199], v[156:159]
    v_cvt_pk_bf16_f32 v186, v200, v201
    v_cvt_pk_bf16_f32 v187, v202, v203
    v_mfma_f32_16x16x32_bf16 v[124:127], a[108:111], v[188:191], 0
    v_exp_f32 v204, v204
    v_mfma_f32_16x16x32_bf16 v[92:95], a[108:111], v[180:183], v[92:95]
    v_exp_f32 v205, v205
    v_mfma_f32_16x16x32_bf16 v[60:63], a[108:111], v[172:175], v[60:63]
    v_exp_f32 v206, v206
    v_mfma_f32_16x16x32_bf16 v[28:31], a[108:111], v[164:167], v[28:31]
    v_exp_f32 v207, v207
    v_smfmac_f32_16x16x64_bf16 a[116:119], a[132:135], v[168:175], v238
    s_waitcnt lgkmcnt(0)
    v_cvt_pk_bf16_f32 v194, v204, v205
    v_mfma_f32_16x16x32_bf16 v[208:211], a[80:83], a[0:3], -4.0
    v_cvt_pk_bf16_f32 v195, v206, v207
    v_mfma_f32_16x16x32_bf16 v[208:211], a[84:87], a[4:7], v[208:211]
    s_barrier
    v_mfma_f32_16x16x32_bf16 v[208:211], a[88:91], a[8:11], v[208:211]
    buffer_store_dwordx4 v[240:243], v244, s[16:19], s26 offen nt
    v_mfma_f32_16x16x32_bf16 v[208:211], a[92:95], a[12:15], v[208:211]
    ds_write_b64 v236, a[224:225] offset:57344
    v_mfma_f32_16x16x32_bf16 v[212:215], a[92:95], a[28:31], -4.0
    ds_read_b128 a[104:107], v230 offset:49152
    v_cndmask_b32 v240, v216, v232, vcc
    v_mfma_f32_16x16x32_bf16 v[212:215], a[88:91], a[24:27], v[212:215]
    ds_write_b64 v236, a[226:227] offset:57352
    v_mfma_f32_16x16x32_bf16 v[212:215], a[84:87], a[20:23], v[212:215]
    buffer_store_dwordx4 v[220:223], v245, s[16:19], s26 offen nt
    v_mfma_f32_16x16x32_bf16 v[212:215], a[80:83], a[16:19], v[212:215]
    v_exp_f32 v208, v208
    v_mfma_f32_16x16x32_bf16 v[200:203], a[80:83], a[32:35], -4.0
    s_add_u32 s26, s26, 16384
    v_exp_f32 v209, v209
    v_mfma_f32_16x16x32_bf16 v[200:203], a[84:87], a[36:39], v[200:203]
    v_exp_f32 v210, v210
    v_mfma_f32_16x16x32_bf16 v[200:203], a[88:91], a[40:43], v[200:203]
    v_exp_f32 v211, v211
    v_mfma_f32_16x16x32_bf16 v[200:203], a[92:95], a[44:47], v[200:203]
    ds_read_b128 a[108:111], v230 offset:50176
    v_cvt_pk_bf16_f32 v164, v208, v209
    v_mfma_f32_16x16x32_bf16 v[0:3], a[216:219], v[160:163], v[0:3]
    ds_read_b128 a[96:99], v231 offset:49152
    v_cvt_pk_bf16_f32 v165, v210, v211
    v_mfma_f32_16x16x32_bf16 v[32:35], a[216:219], v[168:171], v[32:35]
    ds_write_b64 v236, a[228:229] offset:58368
    v_mfma_f32_16x16x32_bf16 v[64:67], a[216:219], v[176:179], v[64:67]
    v_exp_f32 v212, v212
    v_mfma_f32_16x16x32_bf16 v[96:99], a[216:219], v[184:187], v[96:99]
    v_exp_f32 v213, v213
    v_mfma_f32_16x16x32_bf16 v[128:131], a[216:219], v[192:195], v[128:131]
    v_exp_f32 v214, v214
    v_mfma_f32_16x16x32_bf16 v[132:135], a[220:223], v[192:195], v[132:135]
    v_exp_f32 v215, v215
    v_mfma_f32_16x16x32_bf16 v[100:103], a[220:223], v[184:187], v[100:103]
    ds_read_b128 a[100:103], v231 offset:50176
    v_cvt_pk_bf16_f32 v172, v212, v213
    v_mfma_f32_16x16x32_bf16 v[68:71], a[220:223], v[176:179], v[68:71]
    v_cvt_pk_bf16_f32 v173, v214, v215
    v_cndmask_b32 v241, v217, v233, vcc
    v_mfma_f32_16x16x32_bf16 v[36:39], a[220:223], v[168:171], v[36:39]
    v_exp_f32 v200, v200
    v_mfma_f32_16x16x32_bf16 v[4:7], a[220:223], v[160:163], v[4:7]
    v_exp_f32 v201, v201
    v_smfmac_f32_16x16x64_bf16 a[124:127], a[132:135], v[184:191], v238
    v_cvt_pk_bf16_f32 v180, v200, v201
    v_mfma_f32_16x16x32_bf16 v[204:207], a[92:95], a[60:63], -4.0
    v_exp_f32 v202, v202
    v_mfma_f32_16x16x32_bf16 v[204:207], a[88:91], a[56:59], v[204:207]
    v_exp_f32 v203, v203
    v_mfma_f32_16x16x32_bf16 v[204:207], a[84:87], a[52:55], v[204:207]
    v_cvt_pk_bf16_f32 v181, v202, v203
    v_cndmask_b32 v242, v218, v234, vcc
    v_mfma_f32_16x16x32_bf16 v[204:207], a[80:83], a[48:51], v[204:207]
    ds_write_b64 v236, a[230:231] offset:58376
    v_mfma_f32_16x16x32_bf16 v[208:211], a[80:83], a[64:67], -4.0
    ds_read_b128 a[80:83], v229 offset:28672
    v_cndmask_b32 v243, v219, v235, vcc
    v_mfma_f32_16x16x32_bf16 v[208:211], a[84:87], a[68:71], v[208:211]
    ds_read_b128 a[84:87], v229 offset:28928
    v_cndmask_b32 v232, v232, v216, vcc
    v_mfma_f32_16x16x32_bf16 v[208:211], a[88:91], a[72:75], v[208:211]
    ds_read_b128 a[88:91], v229 offset:29184
    v_cndmask_b32 v233, v233, v217, vcc
    v_mfma_f32_16x16x32_bf16 v[208:211], a[92:95], a[76:79], v[208:211]
    s_waitcnt lgkmcnt(4)
    v_exp_f32 v204, v204
    v_mfma_f32_16x16x32_bf16 v[8:11], a[104:107], v[160:163], v[8:11]
    ds_read_b128 a[92:95], v229 offset:29440
    v_cndmask_b32 v234, v234, v218, vcc
    v_mfma_f32_16x16x32_bf16 v[40:43], a[104:107], v[168:171], v[40:43]
    buffer_store_dwordx4 v[240:243], v244, s[16:19], s42 offen nt
    v_mfma_f32_16x16x32_bf16 v[72:75], a[104:107], v[176:179], v[72:75]
    v_exp_f32 v205, v205
    v_mfma_f32_16x16x32_bf16 v[104:107], a[104:107], v[184:187], v[104:107]
    v_exp_f32 v206, v206
    v_mfma_f32_16x16x32_bf16 v[136:139], a[104:107], v[192:195], v[136:139]
    v_exp_f32 v207, v207
    v_mfma_f32_16x16x32_bf16 v[140:143], a[108:111], v[192:195], v[140:143]
    ds_read_b128 a[104:107], v239 offset:49152
    v_cvt_pk_bf16_f32 v188, v204, v205
    v_mfma_f32_16x16x32_bf16 v[108:111], a[108:111], v[184:187], v[108:111]
    v_cvt_pk_bf16_f32 v189, v206, v207
    v_cndmask_b32 v235, v235, v219, vcc
    v_mfma_f32_16x16x32_bf16 v[76:79], a[108:111], v[176:179], v[76:79]
    buffer_store_dwordx4 v[232:235], v245, s[16:19], s42 offen nt
    v_mfma_f32_16x16x32_bf16 v[44:47], a[108:111], v[168:171], v[44:47]
    v_exp_f32 v208, v208
    v_mfma_f32_16x16x32_bf16 v[12:15], a[108:111], v[160:163], v[12:15]
    s_waitcnt lgkmcnt(1)
    v_exp_f32 v209, v209
    v_mfma_f32_16x16x32_bf16 v[212:215], a[80:83], a[0:3], -4.0
    s_add_u32 s42, s42, 16384
    v_exp_f32 v210, v210
    v_mfma_f32_16x16x32_bf16 v[212:215], a[84:87], a[4:7], v[212:215]
    v_exp_f32 v211, v211
    v_mfma_f32_16x16x32_bf16 v[212:215], a[88:91], a[8:11], v[212:215]
    ds_read_b128 a[108:111], v239 offset:50176
    v_cvt_pk_bf16_f32 v196, v208, v209
    v_mfma_f32_16x16x32_bf16 v[212:215], a[92:95], a[12:15], v[212:215]
    v_cvt_pk_bf16_f32 v197, v210, v211
    v_mfma_f32_16x16x32_bf16 v[200:203], a[92:95], a[28:31], -4.0
    v_mfma_f32_16x16x32_bf16 v[200:203], a[88:91], a[24:27], v[200:203]
    v_mfma_f32_16x16x32_bf16 v[200:203], a[84:87], a[20:23], v[200:203]
    v_mfma_f32_16x16x32_bf16 v[200:203], a[80:83], a[16:19], v[200:203]
    v_mfma_f32_16x16x32_bf16 v[204:207], a[80:83], a[32:35], -4.0
    v_mfma_f32_16x16x32_bf16 v[204:207], a[84:87], a[36:39], v[204:207]
    v_mfma_f32_16x16x32_bf16 v[204:207], a[88:91], a[40:43], v[204:207]
    v_exp_f32 v212, v212
    v_mfma_f32_16x16x32_bf16 v[204:207], a[92:95], a[44:47], v[204:207]
    v_exp_f32 v213, v213
    v_mfma_f32_16x16x32_bf16 v[16:19], a[96:99], v[160:163], v[16:19]
    v_exp_f32 v214, v214
    v_mfma_f32_16x16x32_bf16 v[48:51], a[96:99], v[168:171], v[48:51]
    v_exp_f32 v215, v215
    v_mfma_f32_16x16x32_bf16 v[80:83], a[96:99], v[176:179], v[80:83]
    v_cvt_pk_bf16_f32 v166, v212, v213
    v_cvt_pk_bf16_f32 v167, v214, v215
    v_mfma_f32_16x16x32_bf16 v[112:115], a[96:99], v[184:187], v[112:115]
    v_exp_f32 v204, v204
    v_mfma_f32_16x16x32_bf16 v[144:147], a[96:99], v[192:195], v[144:147]
    v_exp_f32 v205, v205
    v_mfma_f32_16x16x32_bf16 v[148:151], a[100:103], v[192:195], v[148:151]
    v_exp_f32 v206, v206
    v_mfma_f32_16x16x32_bf16 v[116:119], a[100:103], v[184:187], v[116:119]
    v_exp_f32 v207, v207
    v_mfma_f32_16x16x32_bf16 v[84:87], a[100:103], v[176:179], v[84:87]
    v_cvt_pk_bf16_f32 v182, v204, v205
    v_cvt_pk_bf16_f32 v183, v206, v207
    v_mfma_f32_16x16x32_bf16 v[52:55], a[100:103], v[168:171], v[52:55]
    v_exp_f32 v200, v200
    v_mfma_f32_16x16x32_bf16 v[20:23], a[100:103], v[160:163], v[20:23]
    v_exp_f32 v201, v201
    v_smfmac_f32_16x16x64_bf16 a[112:115], a[132:135], v[160:167], v238
    v_cvt_pk_bf16_f32 v174, v200, v201
    v_mfma_f32_16x16x32_bf16 v[208:211], a[92:95], a[60:63], -4.0
    v_exp_f32 v202, v202
    v_mfma_f32_16x16x32_bf16 v[208:211], a[88:91], a[56:59], v[208:211]
    v_exp_f32 v203, v203
    v_mfma_f32_16x16x32_bf16 v[208:211], a[84:87], a[52:55], v[208:211]
    v_cvt_pk_bf16_f32 v175, v202, v203
    v_mfma_f32_16x16x32_bf16 v[208:211], a[80:83], a[48:51], v[208:211]
    s_waitcnt lgkmcnt(0)
    v_mfma_f32_16x16x32_bf16 v[212:215], a[80:83], a[64:67], -4.0
    ds_read_b128 a[80:83], v229 offset:32768
    v_mfma_f32_16x16x32_bf16 v[212:215], a[84:87], a[68:71], v[212:215]
    ds_read_b128 a[84:87], v229 offset:33024
    v_mfma_f32_16x16x32_bf16 v[212:215], a[88:91], a[72:75], v[212:215]
    ds_read_b128 a[88:91], v229 offset:33280
    v_mfma_f32_16x16x32_bf16 v[212:215], a[92:95], a[76:79], v[212:215]
    ds_read_b128 a[92:95], v229 offset:33536
    v_mfma_f32_16x16x32_bf16 v[24:27], a[104:107], v[160:163], v[24:27]
    v_exp_f32 v208, v208
    v_mfma_f32_16x16x32_bf16 v[56:59], a[104:107], v[168:171], v[56:59]
    v_exp_f32 v209, v209
    v_mfma_f32_16x16x32_bf16 v[88:91], a[104:107], v[176:179], v[88:91]
    v_exp_f32 v210, v210
    v_mfma_f32_16x16x32_bf16 v[120:123], a[104:107], v[184:187], v[120:123]
    v_exp_f32 v211, v211
    v_mfma_f32_16x16x32_bf16 v[152:155], a[104:107], v[192:195], v[152:155]
    v_cvt_pk_bf16_f32 v190, v208, v209
    v_cvt_pk_bf16_f32 v191, v210, v211
    v_mfma_f32_16x16x32_bf16 v[156:159], a[108:111], v[192:195], v[156:159]
    v_exp_f32 v212, v212
    v_mfma_f32_16x16x32_bf16 v[124:127], a[108:111], v[184:187], v[124:127]
    v_exp_f32 v213, v213
    v_mfma_f32_16x16x32_bf16 v[92:95], a[108:111], v[176:179], v[92:95]
    v_exp_f32 v214, v214
    v_mfma_f32_16x16x32_bf16 v[60:63], a[108:111], v[168:171], v[60:63]
    v_exp_f32 v215, v215
    v_mfma_f32_16x16x32_bf16 v[28:31], a[108:111], v[160:163], v[28:31]
    v_cvt_pk_bf16_f32 v198, v212, v213
    v_cvt_pk_bf16_f32 v199, v214, v215
    v_smfmac_f32_16x16x64_bf16 a[120:123], a[132:135], v[176:183], v238
    s_waitcnt lgkmcnt(0)
    s_waitcnt vmcnt(4)
    v_accvgpr_mov_b32 a64, a240
    v_mfma_f32_16x16x32_bf16 v[200:203], a[80:83], a[0:3], -4.0
    s_barrier
    v_mfma_f32_16x16x32_bf16 v[200:203], a[84:87], a[4:7], v[200:203]
    ds_write_b64 v236, a[232:233] offset:49152
    v_mfma_f32_16x16x32_bf16 v[200:203], a[88:91], a[8:11], v[200:203]
    ds_read_b128 a[104:107], v230 offset:57344
    v_accvgpr_mov_b32 a65, a241
    v_mfma_f32_16x16x32_bf16 v[200:203], a[92:95], a[12:15], v[200:203]
    ds_write_b64 v236, a[234:235] offset:49160
    v_mfma_f32_16x16x32_bf16 v[204:207], a[92:95], a[28:31], -4.0
    ds_read_b128 a[108:111], v230 offset:58368
    v_accvgpr_mov_b32 a66, a242
    v_mfma_f32_16x16x32_bf16 v[204:207], a[88:91], a[24:27], v[204:207]
    ds_read_b128 a[96:99], v231 offset:57344
    v_accvgpr_mov_b32 a67, a243
    v_mfma_f32_16x16x32_bf16 v[204:207], a[84:87], a[20:23], v[204:207]
    v_exp_f32 v200, v200
    v_mfma_f32_16x16x32_bf16 v[204:207], a[80:83], a[16:19], v[204:207]
    v_exp_f32 v201, v201
    v_mfma_f32_16x16x32_bf16 v[208:211], a[80:83], a[32:35], -4.0
    v_exp_f32 v202, v202
    v_mfma_f32_16x16x32_bf16 v[208:211], a[84:87], a[36:39], v[208:211]
    v_exp_f32 v203, v203
    v_mfma_f32_16x16x32_bf16 v[208:211], a[88:91], a[40:43], v[208:211]
    ds_read_b128 a[100:103], v231 offset:58368
    v_cvt_pk_bf16_f32 v160, v200, v201
    v_mfma_f32_16x16x32_bf16 v[208:211], a[92:95], a[44:47], v[208:211]
    v_cvt_pk_bf16_f32 v161, v202, v203
    v_accvgpr_mov_b32 a68, a244
    v_mfma_f32_16x16x32_bf16 v[0:3], a[224:227], v[164:167], v[0:3]
    v_accvgpr_mov_b32 a69, a245
    v_accvgpr_mov_b32 a70, a246
    v_mfma_f32_16x16x32_bf16 v[32:35], a[224:227], v[172:175], v[32:35]
    v_accvgpr_mov_b32 a71, a247
    v_accvgpr_mov_b32 a72, a248
    v_mfma_f32_16x16x32_bf16 v[64:67], a[224:227], v[180:183], v[64:67]
    v_accvgpr_mov_b32 a73, a249
    v_accvgpr_mov_b32 a74, a250
    v_mfma_f32_16x16x32_bf16 v[96:99], a[224:227], v[188:191], v[96:99]
    v_accvgpr_mov_b32 a75, a251
    v_accvgpr_mov_b32 a76, a252
    v_mfma_f32_16x16x32_bf16 v[128:131], a[224:227], v[196:199], v[128:131]
    v_accvgpr_mov_b32 a77, a253
    v_accvgpr_mov_b32 a78, a254
    v_mfma_f32_16x16x32_bf16 v[132:135], a[228:231], v[196:199], v[132:135]
    v_accvgpr_mov_b32 a79, a255
    v_mfma_f32_16x16x32_bf16 v[100:103], a[228:231], v[188:191], v[100:103]
    ds_write_b64 v236, a[236:237] offset:50176
    v_mfma_f32_16x16x32_bf16 v[68:71], a[228:231], v[180:183], v[68:71]
    v_exp_f32 v204, v204
    v_mfma_f32_16x16x32_bf16 v[36:39], a[228:231], v[172:175], v[36:39]
    v_exp_f32 v205, v205
    v_mfma_f32_16x16x32_bf16 v[4:7], a[228:231], v[164:167], v[4:7]
    v_exp_f32 v206, v206
    v_smfmac_f32_16x16x64_bf16 a[128:131], a[132:135], v[192:199], v238
    v_cvt_pk_bf16_f32 v168, v204, v205
    v_mfma_f32_16x16x32_bf16 v[212:215], a[92:95], a[60:63], -4.0
    v_exp_f32 v207, v207
    v_mfma_f32_16x16x32_bf16 v[212:215], a[88:91], a[56:59], v[212:215]
    v_cvt_pk_bf16_f32 v169, v206, v207
    v_mfma_f32_16x16x32_bf16 v[212:215], a[84:87], a[52:55], v[212:215]
    v_exp_f32 v208, v208
    v_mfma_f32_16x16x32_bf16 v[212:215], a[80:83], a[48:51], v[212:215]
    v_accvgpr_read_b32 v224, a128
    v_accvgpr_read_b32 v226, a129
    v_mfma_f32_16x16x32_bf16 v[200:203], a[80:83], a[64:67], -4.0
    ds_read_b128 a[80:83], v229 offset:36864
    v_add_f32 v226, v226, v224
    v_mfma_f32_16x16x32_bf16 v[200:203], a[84:87], a[68:71], v[200:203]
    v_rcp_f32 v224, v226
    v_mfma_f32_16x16x32_bf16 v[200:203], a[88:91], a[72:75], v[200:203]
    ds_read_b128 a[84:87], v229 offset:37120
    v_mul_f32 v128, v128, v224
    v_mfma_f32_16x16x32_bf16 v[200:203], a[92:95], a[76:79], v[200:203]
    s_waitcnt lgkmcnt(2)
    v_exp_f32 v209, v209
    v_mfma_f32_16x16x32_bf16 v[8:11], a[104:107], v[164:167], v[8:11]
    ds_read_b128 a[88:91], v229 offset:37376
    v_cvt_pk_bf16_f32 v176, v208, v209
    v_mfma_f32_16x16x32_bf16 v[40:43], a[104:107], v[172:175], v[40:43]
    ds_read_b128 a[92:95], v229 offset:37632
    v_mul_f32 v129, v129, v224
    v_mfma_f32_16x16x32_bf16 v[72:75], a[104:107], v[180:183], v[72:75]
    v_exp_f32 v210, v210
    v_mfma_f32_16x16x32_bf16 v[104:107], a[104:107], v[188:191], v[104:107]
    v_exp_f32 v211, v211
    v_mfma_f32_16x16x32_bf16 v[136:139], a[104:107], v[196:199], v[136:139]
    ds_read_b128 a[104:107], v239 offset:57344
    v_cvt_pk_bf16_f32 v177, v210, v211
    v_mfma_f32_16x16x32_bf16 v[140:143], a[108:111], v[196:199], v[140:143]
    v_exp_f32 v212, v212
    v_mfma_f32_16x16x32_bf16 v[108:111], a[108:111], v[188:191], v[108:111]
    v_exp_f32 v213, v213
    v_mfma_f32_16x16x32_bf16 v[76:79], a[108:111], v[180:183], v[76:79]
    v_exp_f32 v214, v214
    v_mfma_f32_16x16x32_bf16 v[44:47], a[108:111], v[172:175], v[44:47]
    v_exp_f32 v215, v215
    v_mfma_f32_16x16x32_bf16 v[12:15], a[108:111], v[164:167], v[12:15]
    s_waitcnt lgkmcnt(3)
    v_cvt_pk_bf16_f32 v184, v212, v213
    v_cvt_pk_bf16_f32 v185, v214, v215
    v_mfma_f32_16x16x32_bf16 v[204:207], a[80:83], a[0:3], -4.0
    ds_write_b64 v236, a[238:239] offset:50184
    v_mfma_f32_16x16x32_bf16 v[204:207], a[84:87], a[4:7], v[204:207]
    s_waitcnt lgkmcnt(2)
    v_exp_f32 v200, v200
    v_mfma_f32_16x16x32_bf16 v[204:207], a[88:91], a[8:11], v[204:207]
    v_exp_f32 v201, v201
    v_mfma_f32_16x16x32_bf16 v[204:207], a[92:95], a[12:15], v[204:207]
    v_exp_f32 v202, v202
    v_mfma_f32_16x16x32_bf16 v[208:211], a[92:95], a[28:31], -4.0
    v_exp_f32 v203, v203
    v_mfma_f32_16x16x32_bf16 v[208:211], a[88:91], a[24:27], v[208:211]
    ds_read_b128 a[108:111], v239 offset:58368
    v_cvt_pk_bf16_f32 v192, v200, v201
    v_mfma_f32_16x16x32_bf16 v[208:211], a[84:87], a[20:23], v[208:211]
    v_cvt_pk_bf16_f32 v193, v202, v203
    v_mul_f32 v130, v130, v224
    v_mfma_f32_16x16x32_bf16 v[208:211], a[80:83], a[16:19], v[208:211]
    v_exp_f32 v204, v204
    v_mfma_f32_16x16x32_bf16 v[212:215], a[80:83], a[32:35], -4.0
    v_exp_f32 v205, v205
    v_mfma_f32_16x16x32_bf16 v[212:215], a[84:87], a[36:39], v[212:215]
    v_exp_f32 v206, v206
    v_mfma_f32_16x16x32_bf16 v[212:215], a[88:91], a[40:43], v[212:215]
    v_exp_f32 v207, v207
    v_mfma_f32_16x16x32_bf16 v[212:215], a[92:95], a[44:47], v[212:215]
    v_cvt_pk_bf16_f32 v162, v204, v205
    v_cvt_pk_bf16_f32 v163, v206, v207
    v_mfma_f32_16x16x32_bf16 v[16:19], a[96:99], v[164:167], v[16:19]
    v_exp_f32 v208, v208
    v_mfma_f32_16x16x32_bf16 v[48:51], a[96:99], v[172:175], v[48:51]
    v_exp_f32 v209, v209
    v_mfma_f32_16x16x32_bf16 v[80:83], a[96:99], v[180:183], v[80:83]
    v_exp_f32 v210, v210
    v_mfma_f32_16x16x32_bf16 v[112:115], a[96:99], v[188:191], v[112:115]
    v_exp_f32 v211, v211
    v_mfma_f32_16x16x32_bf16 v[144:147], a[96:99], v[196:199], v[144:147]
    v_cvt_pk_bf16_f32 v170, v208, v209
    v_cvt_pk_bf16_f32 v171, v210, v211
    v_mfma_f32_16x16x32_bf16 v[148:151], a[100:103], v[196:199], v[148:151]
    v_exp_f32 v212, v212
    v_mfma_f32_16x16x32_bf16 v[116:119], a[100:103], v[188:191], v[116:119]
    v_exp_f32 v213, v213
    v_mfma_f32_16x16x32_bf16 v[84:87], a[100:103], v[180:183], v[84:87]
    v_exp_f32 v214, v214
    v_mfma_f32_16x16x32_bf16 v[52:55], a[100:103], v[172:175], v[52:55]
    v_exp_f32 v215, v215
    v_mfma_f32_16x16x32_bf16 v[20:23], a[100:103], v[164:167], v[20:23]
    v_cvt_pk_bf16_f32 v178, v212, v213
    v_cvt_pk_bf16_f32 v179, v214, v215
    v_mfma_f32_16x16x32_bf16 v[200:203], a[92:95], a[60:63], -4.0
    v_mul_f32 v131, v131, v224
    v_cvt_pk_bf16_f32 v216, v128, v129
    v_mfma_f32_16x16x32_bf16 v[200:203], a[88:91], a[56:59], v[200:203]
    v_cvt_pk_bf16_f32 v217, v130, v131
    v_mul_f32 v132, v132, v224
    v_mfma_f32_16x16x32_bf16 v[200:203], a[84:87], a[52:55], v[200:203]
    v_mul_f32 v133, v133, v224
    v_mul_f32 v134, v134, v224
    v_mfma_f32_16x16x32_bf16 v[200:203], a[80:83], a[48:51], v[200:203]
    v_mul_f32 v135, v135, v224
    v_cvt_pk_bf16_f32 v218, v132, v133
    v_mfma_f32_16x16x32_bf16 v[204:207], a[80:83], a[64:67], -4.0
    ds_read_b128 a[80:83], v229 offset:40960
    v_cvt_pk_bf16_f32 v219, v134, v135
    v_mfma_f32_16x16x32_bf16 v[204:207], a[84:87], a[68:71], v[204:207]
    ds_read_b128 a[84:87], v229 offset:41216
    v_mov_b32_dpp v246, v224 row_ror:8 row_mask:0xf bank_mask:0xf
    v_mfma_f32_16x16x32_bf16 v[204:207], a[88:91], a[72:75], v[204:207]
    ds_read_b128 a[88:91], v229 offset:41472
    v_mul_f32_dpp v136, v136, v246 row_ror:8 row_mask:0xf bank_mask:0xf
    v_mfma_f32_16x16x32_bf16 v[204:207], a[92:95], a[76:79], v[204:207]
    s_waitcnt lgkmcnt(3)
    v_exp_f32 v200, v200
    v_mfma_f32_16x16x32_bf16 v[24:27], a[104:107], v[164:167], v[24:27]
    ds_read_b128 a[92:95], v229 offset:41728
    v_mul_f32_dpp v137, v137, v246 row_ror:8 row_mask:0xf bank_mask:0xf
    v_mfma_f32_16x16x32_bf16 v[56:59], a[104:107], v[172:175], v[56:59]
    v_exp_f32 v201, v201
    v_mfma_f32_16x16x32_bf16 v[88:91], a[104:107], v[180:183], v[88:91]
    v_exp_f32 v202, v202
    v_mfma_f32_16x16x32_bf16 v[120:123], a[104:107], v[188:191], v[120:123]
    v_exp_f32 v203, v203
    v_mfma_f32_16x16x32_bf16 v[152:155], a[104:107], v[196:199], v[152:155]
    v_cvt_pk_bf16_f32 v186, v200, v201
    v_cvt_pk_bf16_f32 v187, v202, v203
    v_mfma_f32_16x16x32_bf16 v[156:159], a[108:111], v[196:199], v[156:159]
    v_exp_f32 v204, v204
    v_mfma_f32_16x16x32_bf16 v[124:127], a[108:111], v[188:191], v[124:127]
    v_exp_f32 v205, v205
    v_mfma_f32_16x16x32_bf16 v[92:95], a[108:111], v[180:183], v[92:95]
    v_exp_f32 v206, v206
    v_mfma_f32_16x16x32_bf16 v[60:63], a[108:111], v[172:175], v[60:63]
    v_exp_f32 v207, v207
    v_mfma_f32_16x16x32_bf16 v[28:31], a[108:111], v[164:167], v[28:31]
    v_cvt_pk_bf16_f32 v194, v204, v205
    v_cvt_pk_bf16_f32 v195, v206, v207
    s_cmp_eq_u32 s28, 0
    s_cbranch_scc1 L_loop_done
    s_sub_u32 s28, s28, 1
    v_smfmac_f32_16x16x64_bf16 a[116:119], a[132:135], v[168:175], v238
    s_waitcnt lgkmcnt(0)
    s_add_u32 s4, s4, 16384
    s_addc_u32 s5, s5, 0
    v_mfma_f32_16x16x32_bf16 v[208:211], a[80:83], a[0:3], -4.0
    global_load_dwordx4 a[240:243], v237, s[4:5] offset:0
    v_mfma_f32_16x16x32_bf16 v[208:211], a[84:87], a[4:7], v[208:211]
    global_load_dwordx4 a[244:247], v237, s[4:5] offset:64
    v_mfma_f32_16x16x32_bf16 v[208:211], a[88:91], a[8:11], v[208:211]
    global_load_dwordx4 a[248:251], v237, s[4:5] offset:128
    v_mfma_f32_16x16x32_bf16 v[208:211], a[92:95], a[12:15], v[208:211]
    global_load_dwordx4 a[252:255], v237, s[4:5] offset:192
    v_mfma_f32_16x16x32_bf16 v[212:215], a[92:95], a[28:31], -4.0
    s_barrier
    v_mfma_f32_16x16x32_bf16 v[212:215], a[88:91], a[24:27], v[212:215]
    ds_write_b64 v236, v[248:249] offset:57344
    v_mfma_f32_16x16x32_bf16 v[212:215], a[84:87], a[20:23], v[212:215]
    ds_read_b128 a[104:107], v230 offset:49152
    v_mul_f32_dpp v138, v138, v246 row_ror:8 row_mask:0xf bank_mask:0xf
    v_mfma_f32_16x16x32_bf16 v[212:215], a[80:83], a[16:19], v[212:215]
    v_exp_f32 v208, v208
    v_mfma_f32_16x16x32_bf16 v[200:203], a[80:83], a[32:35], -4.0
    v_exp_f32 v209, v209
    v_mfma_f32_16x16x32_bf16 v[200:203], a[84:87], a[36:39], v[200:203]
    v_exp_f32 v210, v210
    v_mfma_f32_16x16x32_bf16 v[200:203], a[88:91], a[40:43], v[200:203]
    v_exp_f32 v211, v211
    v_mfma_f32_16x16x32_bf16 v[200:203], a[92:95], a[44:47], v[200:203]
    ds_read_b128 a[108:111], v230 offset:50176
    v_cvt_pk_bf16_f32 v164, v208, v209
    v_mfma_f32_16x16x32_bf16 v[0:3], a[232:235], v[160:163], v[0:3]
    ds_read_b128 a[96:99], v231 offset:49152
    v_cvt_pk_bf16_f32 v165, v210, v211
    v_mfma_f32_16x16x32_bf16 v[32:35], a[232:235], v[168:171], v[32:35]
    ds_write_b64 v236, v[250:251] offset:57352
    v_mfma_f32_16x16x32_bf16 v[64:67], a[232:235], v[176:179], v[64:67]
    ds_read_b128 a[100:103], v231 offset:50176
    v_mul_f32_dpp v139, v139, v246 row_ror:8 row_mask:0xf bank_mask:0xf
    v_mfma_f32_16x16x32_bf16 v[96:99], a[232:235], v[184:187], v[96:99]
    v_cvt_pk_bf16_f32 v220, v136, v137
    v_cvt_pk_bf16_f32 v221, v138, v139
    v_mfma_f32_16x16x32_bf16 v[128:131], a[232:235], v[192:195], 0
    v_mul_f32_dpp v140, v140, v246 row_ror:8 row_mask:0xf bank_mask:0xf
    v_mul_f32_dpp v141, v141, v246 row_ror:8 row_mask:0xf bank_mask:0xf
    v_mfma_f32_16x16x32_bf16 v[132:135], a[236:239], v[192:195], 0
    v_mul_f32_dpp v142, v142, v246 row_ror:8 row_mask:0xf bank_mask:0xf
    v_mul_f32_dpp v143, v143, v246 row_ror:8 row_mask:0xf bank_mask:0xf
    v_mfma_f32_16x16x32_bf16 v[100:103], a[236:239], v[184:187], v[100:103]
    v_cvt_pk_bf16_f32 v222, v140, v141
    v_cvt_pk_bf16_f32 v223, v142, v143
    v_mfma_f32_16x16x32_bf16 v[68:71], a[236:239], v[176:179], v[68:71]
    v_exp_f32 v212, v212
    v_mfma_f32_16x16x32_bf16 v[36:39], a[236:239], v[168:171], v[36:39]
    v_exp_f32 v213, v213
    v_mfma_f32_16x16x32_bf16 v[4:7], a[236:239], v[160:163], v[4:7]
    v_exp_f32 v214, v214
    v_smfmac_f32_16x16x64_bf16 a[124:127], a[132:135], v[184:191], v238
    v_cvt_pk_bf16_f32 v172, v212, v213
    v_mfma_f32_16x16x32_bf16 v[204:207], a[92:95], a[60:63], -4.0
    v_exp_f32 v215, v215
    v_mfma_f32_16x16x32_bf16 v[204:207], a[88:91], a[56:59], v[204:207]
    v_cvt_pk_bf16_f32 v173, v214, v215
    v_cndmask_b32 v240, v216, v220, vcc
    v_mfma_f32_16x16x32_bf16 v[204:207], a[84:87], a[52:55], v[204:207]
    ds_write_b64 v236, v[252:253] offset:58368
    v_mfma_f32_16x16x32_bf16 v[204:207], a[80:83], a[48:51], v[204:207]
    v_exp_f32 v200, v200
    v_mfma_f32_16x16x32_bf16 v[208:211], a[80:83], a[64:67], -4.0
    ds_read_b128 a[80:83], v229 offset:45056
    v_cndmask_b32 v241, v217, v221, vcc
    v_mfma_f32_16x16x32_bf16 v[208:211], a[84:87], a[68:71], v[208:211]
    ds_read_b128 a[84:87], v229 offset:45312
    v_cndmask_b32 v220, v220, v216, vcc
    v_mfma_f32_16x16x32_bf16 v[208:211], a[88:91], a[72:75], v[208:211]
    ds_read_b128 a[88:91], v229 offset:45568
    v_cndmask_b32 v221, v221, v217, vcc
    v_mfma_f32_16x16x32_bf16 v[208:211], a[92:95], a[76:79], v[208:211]
    s_waitcnt lgkmcnt(4)
    v_exp_f32 v201, v201
    v_mfma_f32_16x16x32_bf16 v[8:11], a[104:107], v[160:163], v[8:11]
    ds_read_b128 a[92:95], v229 offset:45824
    v_cvt_pk_bf16_f32 v180, v200, v201
    v_mfma_f32_16x16x32_bf16 v[40:43], a[104:107], v[168:171], v[40:43]
    v_exp_f32 v202, v202
    v_mfma_f32_16x16x32_bf16 v[72:75], a[104:107], v[176:179], v[72:75]
    v_exp_f32 v203, v203
    v_mfma_f32_16x16x32_bf16 v[104:107], a[104:107], v[184:187], v[104:107]
    v_cvt_pk_bf16_f32 v181, v202, v203
    v_mul_f32 v144, v144, v224
    v_mfma_f32_16x16x32_bf16 v[136:139], a[104:107], v[192:195], 0
    v_exp_f32 v204, v204
    v_mfma_f32_16x16x32_bf16 v[140:143], a[108:111], v[192:195], 0
    v_exp_f32 v205, v205
    v_mfma_f32_16x16x32_bf16 v[108:111], a[108:111], v[184:187], v[108:111]
    v_exp_f32 v206, v206
    v_mfma_f32_16x16x32_bf16 v[76:79], a[108:111], v[176:179], v[76:79]
    v_exp_f32 v207, v207
    v_mfma_f32_16x16x32_bf16 v[44:47], a[108:111], v[168:171], v[44:47]
    ds_read_b128 a[104:107], v239 offset:49152
    v_cvt_pk_bf16_f32 v188, v204, v205
    v_mfma_f32_16x16x32_bf16 v[12:15], a[108:111], v[160:163], v[12:15]
    s_waitcnt lgkmcnt(2)
    v_cvt_pk_bf16_f32 v189, v206, v207
    v_mul_f32 v145, v145, v224
    v_mfma_f32_16x16x32_bf16 v[212:215], a[80:83], a[0:3], -4.0
    ds_write_b64 v236, v[254:255] offset:58376
    v_mfma_f32_16x16x32_bf16 v[212:215], a[84:87], a[4:7], v[212:215]
    ds_read_b128 a[108:111], v239 offset:50176
    v_mul_f32 v146, v146, v224
    v_mfma_f32_16x16x32_bf16 v[212:215], a[88:91], a[8:11], v[212:215]
    s_waitcnt lgkmcnt(3)
    v_mul_f32 v147, v147, v224
    v_cndmask_b32 v242, v218, v222, vcc
    v_mfma_f32_16x16x32_bf16 v[212:215], a[92:95], a[12:15], v[212:215]
    v_cndmask_b32 v243, v219, v223, vcc
    v_cvt_pk_bf16_f32 v216, v144, v145
    v_mfma_f32_16x16x32_bf16 v[200:203], a[92:95], a[28:31], -4.0
    v_cvt_pk_bf16_f32 v217, v146, v147
    v_cndmask_b32 v222, v222, v218, vcc
    v_mfma_f32_16x16x32_bf16 v[200:203], a[88:91], a[24:27], v[200:203]
    v_cndmask_b32 v223, v223, v219, vcc
    v_mul_f32 v148, v148, v224
    v_mfma_f32_16x16x32_bf16 v[200:203], a[84:87], a[20:23], v[200:203]
    v_mul_f32 v149, v149, v224
    v_mul_f32 v150, v150, v224
    v_mfma_f32_16x16x32_bf16 v[200:203], a[80:83], a[16:19], v[200:203]
    v_mul_f32 v151, v151, v224
    v_cvt_pk_bf16_f32 v218, v148, v149
    v_mfma_f32_16x16x32_bf16 v[204:207], a[80:83], a[32:35], -4.0
    v_cvt_pk_bf16_f32 v219, v150, v151
    v_mul_f32_dpp v152, v152, v246 row_ror:8 row_mask:0xf bank_mask:0xf
    v_mfma_f32_16x16x32_bf16 v[204:207], a[84:87], a[36:39], v[204:207]
    v_exp_f32 v212, v212
    v_mfma_f32_16x16x32_bf16 v[204:207], a[88:91], a[40:43], v[204:207]
    v_exp_f32 v213, v213
    v_mfma_f32_16x16x32_bf16 v[204:207], a[92:95], a[44:47], v[204:207]
    v_exp_f32 v214, v214
    v_mfma_f32_16x16x32_bf16 v[16:19], a[96:99], v[160:163], v[16:19]
    v_exp_f32 v215, v215
    v_mfma_f32_16x16x32_bf16 v[48:51], a[96:99], v[168:171], v[48:51]
    v_cvt_pk_bf16_f32 v166, v212, v213
    v_cvt_pk_bf16_f32 v167, v214, v215
    v_mfma_f32_16x16x32_bf16 v[80:83], a[96:99], v[176:179], v[80:83]
    v_exp_f32 v208, v208
    v_mfma_f32_16x16x32_bf16 v[112:115], a[96:99], v[184:187], v[112:115]
    v_exp_f32 v209, v209
    v_mfma_f32_16x16x32_bf16 v[144:147], a[96:99], v[192:195], 0
    v_exp_f32 v210, v210
    v_mfma_f32_16x16x32_bf16 v[148:151], a[100:103], v[192:195], 0
    v_exp_f32 v211, v211
    v_mfma_f32_16x16x32_bf16 v[116:119], a[100:103], v[184:187], v[116:119]
    v_cvt_pk_bf16_f32 v196, v208, v209
    v_cvt_pk_bf16_f32 v197, v210, v211
    v_mfma_f32_16x16x32_bf16 v[84:87], a[100:103], v[176:179], v[84:87]
    v_mul_f32_dpp v153, v153, v246 row_ror:8 row_mask:0xf bank_mask:0xf
    v_mul_f32_dpp v154, v154, v246 row_ror:8 row_mask:0xf bank_mask:0xf
    v_mfma_f32_16x16x32_bf16 v[52:55], a[100:103], v[168:171], v[52:55]
    v_mul_f32_dpp v155, v155, v246 row_ror:8 row_mask:0xf bank_mask:0xf
    v_cvt_pk_bf16_f32 v232, v152, v153
    v_mfma_f32_16x16x32_bf16 v[20:23], a[100:103], v[160:163], v[20:23]
    v_cvt_pk_bf16_f32 v233, v154, v155
    v_mul_f32_dpp v156, v156, v246 row_ror:8 row_mask:0xf bank_mask:0xf
    v_smfmac_f32_16x16x64_bf16 a[112:115], a[132:135], v[160:167], v238
    v_mul_f32_dpp v157, v157, v246 row_ror:8 row_mask:0xf bank_mask:0xf
    v_mfma_f32_16x16x32_bf16 v[208:211], a[92:95], a[60:63], -4.0
    v_mul_f32_dpp v158, v158, v246 row_ror:8 row_mask:0xf bank_mask:0xf
    v_mul_f32_dpp v159, v159, v246 row_ror:8 row_mask:0xf bank_mask:0xf
    v_mfma_f32_16x16x32_bf16 v[208:211], a[88:91], a[56:59], v[208:211]
    v_cvt_pk_bf16_f32 v234, v156, v157
    v_cvt_pk_bf16_f32 v235, v158, v159
    v_mfma_f32_16x16x32_bf16 v[208:211], a[84:87], a[52:55], v[208:211]
    v_exp_f32 v204, v204
    v_mfma_f32_16x16x32_bf16 v[208:211], a[80:83], a[48:51], v[208:211]
    v_exp_f32 v205, v205
    v_mfma_f32_16x16x32_bf16 v[212:215], a[80:83], a[64:67], -4.0
    ds_read_b128 a[80:83], v229 offset:49152
    v_cvt_pk_bf16_f32 v182, v204, v205
    v_mfma_f32_16x16x32_bf16 v[212:215], a[84:87], a[68:71], v[212:215]
    ds_read_b128 a[84:87], v229 offset:49408
    v_accvgpr_write_b32 a128, 0
    v_mfma_f32_16x16x32_bf16 v[212:215], a[88:91], a[72:75], v[212:215]
    ds_read_b128 a[88:91], v229 offset:49664
    v_accvgpr_write_b32 a129, 0
    v_mfma_f32_16x16x32_bf16 v[212:215], a[92:95], a[76:79], v[212:215]
    s_waitcnt lgkmcnt(3)
    v_exp_f32 v206, v206
    v_mfma_f32_16x16x32_bf16 v[24:27], a[104:107], v[160:163], v[24:27]
    ds_read_b128 a[92:95], v229 offset:49920
    v_max3_f32 v227, v226, v224, v227
    v_mfma_f32_16x16x32_bf16 v[56:59], a[104:107], v[168:171], v[56:59]
    v_exp_f32 v207, v207
    v_mfma_f32_16x16x32_bf16 v[88:91], a[104:107], v[176:179], v[88:91]
    v_cvt_pk_bf16_f32 v183, v206, v207
    v_mfma_f32_16x16x32_bf16 v[120:123], a[104:107], v[184:187], v[120:123]
    v_exp_f32 v200, v200
    v_mfma_f32_16x16x32_bf16 v[152:155], a[104:107], v[192:195], 0
    v_exp_f32 v201, v201
    v_mfma_f32_16x16x32_bf16 v[156:159], a[108:111], v[192:195], 0
    v_exp_f32 v202, v202
    v_mfma_f32_16x16x32_bf16 v[124:127], a[108:111], v[184:187], v[124:127]
    v_exp_f32 v203, v203
    v_mfma_f32_16x16x32_bf16 v[92:95], a[108:111], v[176:179], v[92:95]
    v_cvt_pk_bf16_f32 v174, v200, v201
    v_cvt_pk_bf16_f32 v175, v202, v203
    v_mfma_f32_16x16x32_bf16 v[60:63], a[108:111], v[168:171], v[60:63]
    v_exp_f32 v208, v208
    v_mfma_f32_16x16x32_bf16 v[28:31], a[108:111], v[160:163], v[28:31]
    v_exp_f32 v209, v209
    v_smfmac_f32_16x16x64_bf16 a[120:123], a[132:135], v[176:183], v238
    s_waitcnt lgkmcnt(0)
    v_cvt_pk_bf16_f32 v190, v208, v209
    v_mfma_f32_16x16x32_bf16 v[200:203], a[80:83], a[0:3], -4.0
    v_exp_f32 v210, v210
    v_mfma_f32_16x16x32_bf16 v[200:203], a[84:87], a[4:7], v[200:203]
    v_exp_f32 v211, v211
    v_mfma_f32_16x16x32_bf16 v[200:203], a[88:91], a[8:11], v[200:203]
    v_cvt_pk_bf16_f32 v191, v210, v211
    v_mfma_f32_16x16x32_bf16 v[200:203], a[92:95], a[12:15], v[200:203]
    v_exp_f32 v212, v212
    v_mfma_f32_16x16x32_bf16 v[204:207], a[92:95], a[28:31], -4.0
    v_exp_f32 v213, v213
    v_mfma_f32_16x16x32_bf16 v[204:207], a[88:91], a[24:27], v[204:207]
    v_exp_f32 v214, v214
    v_mfma_f32_16x16x32_bf16 v[204:207], a[84:87], a[20:23], v[204:207]
    v_exp_f32 v215, v215
    v_mfma_f32_16x16x32_bf16 v[204:207], a[80:83], a[16:19], v[204:207]
    v_cvt_pk_bf16_f32 v198, v212, v213
    v_cvt_pk_bf16_f32 v199, v214, v215
    v_mfma_f32_16x16x32_bf16 v[208:211], a[80:83], a[32:35], -4.0
    s_barrier
    v_mfma_f32_16x16x32_bf16 v[208:211], a[84:87], a[36:39], v[208:211]
    buffer_store_dwordx4 v[240:243], v244, s[16:19], s26 offen nt
    v_mfma_f32_16x16x32_bf16 v[208:211], a[88:91], a[40:43], v[208:211]
    ds_write_b64 v236, a[136:137] offset:49152
    v_mfma_f32_16x16x32_bf16 v[208:211], a[92:95], a[44:47], v[208:211]
    ds_read_b128 a[104:107], v230 offset:57344
    v_cndmask_b32 v240, v216, v232, vcc
    v_mfma_f32_16x16x32_bf16 v[0:3], v[248:251], v[164:167], v[0:3]
    v_exp_f32 v200, v200
    v_mfma_f32_16x16x32_bf16 v[32:35], v[248:251], v[172:175], v[32:35]
    buffer_store_dwordx4 v[220:223], v245, s[16:19], s26 offen nt
    v_mfma_f32_16x16x32_bf16 v[64:67], v[248:251], v[180:183], v[64:67]
    v_exp_f32 v201, v201
    v_mfma_f32_16x16x32_bf16 v[96:99], v[248:251], v[188:191], v[96:99]
    s_add_u32 s26, s26, 16384
    v_exp_f32 v202, v202
    v_mfma_f32_16x16x32_bf16 v[128:131], v[248:251], v[196:199], v[128:131]
    v_exp_f32 v203, v203
    v_mfma_f32_16x16x32_bf16 v[132:135], v[252:255], v[196:199], v[132:135]
    ds_read_b128 a[108:111], v230 offset:58368
    v_cvt_pk_bf16_f32 v160, v200, v201
    v_mfma_f32_16x16x32_bf16 v[100:103], v[252:255], v[188:191], v[100:103]
    ds_read_b128 a[96:99], v231 offset:57344
    v_cvt_pk_bf16_f32 v161, v202, v203
    v_mfma_f32_16x16x32_bf16 v[68:71], v[252:255], v[180:183], v[68:71]
    ds_write_b64 v236, a[138:139] offset:49160
    v_mfma_f32_16x16x32_bf16 v[36:39], v[252:255], v[172:175], v[36:39]
    v_exp_f32 v204, v204
    v_mfma_f32_16x16x32_bf16 v[4:7], v[252:255], v[164:167], v[4:7]
    v_exp_f32 v205, v205
    v_smfmac_f32_16x16x64_bf16 a[128:131], a[132:135], v[192:199], v238
    ds_read_b128 a[100:103], v231 offset:58368
    v_cvt_pk_bf16_f32 v168, v204, v205
    v_mfma_f32_16x16x32_bf16 v[212:215], a[92:95], a[60:63], -4.0
    v_exp_f32 v206, v206
    v_mfma_f32_16x16x32_bf16 v[212:215], a[88:91], a[56:59], v[212:215]
    v_exp_f32 v207, v207
    v_mfma_f32_16x16x32_bf16 v[212:215], a[84:87], a[52:55], v[212:215]
    v_cvt_pk_bf16_f32 v169, v206, v207
    v_cndmask_b32 v241, v217, v233, vcc
    v_mfma_f32_16x16x32_bf16 v[212:215], a[80:83], a[48:51], v[212:215]
    v_exp_f32 v208, v208
    v_mfma_f32_16x16x32_bf16 v[200:203], a[80:83], a[64:67], -4.0
    ds_read_b128 a[80:83], v229 offset:53248
    v_cndmask_b32 v242, v218, v234, vcc
    v_mfma_f32_16x16x32_bf16 v[200:203], a[84:87], a[68:71], v[200:203]
    ds_read_b128 a[84:87], v229 offset:53504
    v_cndmask_b32 v243, v219, v235, vcc
    v_mfma_f32_16x16x32_bf16 v[200:203], a[88:91], a[72:75], v[200:203]
    ds_read_b128 a[88:91], v229 offset:53760
    v_cndmask_b32 v232, v232, v216, vcc
    v_mfma_f32_16x16x32_bf16 v[200:203], a[92:95], a[76:79], v[200:203]
    s_waitcnt lgkmcnt(4)
    v_exp_f32 v209, v209
    v_mfma_f32_16x16x32_bf16 v[8:11], a[104:107], v[164:167], v[8:11]
    ds_read_b128 a[92:95], v229 offset:54016
    v_cvt_pk_bf16_f32 v176, v208, v209
    v_mfma_f32_16x16x32_bf16 v[40:43], a[104:107], v[172:175], v[40:43]
    buffer_store_dwordx4 v[240:243], v244, s[16:19], s42 offen nt
    v_mfma_f32_16x16x32_bf16 v[72:75], a[104:107], v[180:183], v[72:75]
    v_exp_f32 v210, v210
    v_mfma_f32_16x16x32_bf16 v[104:107], a[104:107], v[188:191], v[104:107]
    v_exp_f32 v211, v211
    v_mfma_f32_16x16x32_bf16 v[136:139], a[104:107], v[196:199], v[136:139]
    ds_read_b128 a[104:107], v239 offset:57344
    v_cvt_pk_bf16_f32 v177, v210, v211
    v_mfma_f32_16x16x32_bf16 v[140:143], a[108:111], v[196:199], v[140:143]
    ds_write_b64 v236, a[140:141] offset:50176
    v_mfma_f32_16x16x32_bf16 v[108:111], a[108:111], v[188:191], v[108:111]
    v_exp_f32 v212, v212
    v_mfma_f32_16x16x32_bf16 v[76:79], a[108:111], v[180:183], v[76:79]
    v_exp_f32 v213, v213
    v_mfma_f32_16x16x32_bf16 v[44:47], a[108:111], v[172:175], v[44:47]
    v_exp_f32 v214, v214
    v_mfma_f32_16x16x32_bf16 v[12:15], a[108:111], v[164:167], v[12:15]
    s_waitcnt lgkmcnt(2)
    v_exp_f32 v215, v215
    v_mfma_f32_16x16x32_bf16 v[204:207], a[80:83], a[0:3], -4.0
    ds_read_b128 a[108:111], v239 offset:58368
    v_cvt_pk_bf16_f32 v184, v212, v213
    v_mfma_f32_16x16x32_bf16 v[204:207], a[84:87], a[4:7], v[204:207]
    v_cvt_pk_bf16_f32 v185, v214, v215
    v_cndmask_b32 v233, v233, v217, vcc
    v_mfma_f32_16x16x32_bf16 v[204:207], a[88:91], a[8:11], v[204:207]
    ds_write_b64 v236, a[142:143] offset:50184
    v_mfma_f32_16x16x32_bf16 v[204:207], a[92:95], a[12:15], v[204:207]
    v_exp_f32 v200, v200
    v_mfma_f32_16x16x32_bf16 v[208:211], a[92:95], a[28:31], -4.0
    v_exp_f32 v201, v201
    v_mfma_f32_16x16x32_bf16 v[208:211], a[88:91], a[24:27], v[208:211]
    v_exp_f32 v202, v202
    v_mfma_f32_16x16x32_bf16 v[208:211], a[84:87], a[20:23], v[208:211]
    v_exp_f32 v203, v203
    v_mfma_f32_16x16x32_bf16 v[208:211], a[80:83], a[16:19], v[208:211]
    v_cvt_pk_bf16_f32 v192, v200, v201
    v_cvt_pk_bf16_f32 v193, v202, v203
    v_mfma_f32_16x16x32_bf16 v[212:215], a[80:83], a[32:35], -4.0
    v_exp_f32 v204, v204
    v_mfma_f32_16x16x32_bf16 v[212:215], a[84:87], a[36:39], v[212:215]
    v_exp_f32 v205, v205
    v_mfma_f32_16x16x32_bf16 v[212:215], a[88:91], a[40:43], v[212:215]
    v_exp_f32 v206, v206
    v_mfma_f32_16x16x32_bf16 v[212:215], a[92:95], a[44:47], v[212:215]
    v_exp_f32 v207, v207
    v_mfma_f32_16x16x32_bf16 v[16:19], a[96:99], v[164:167], v[16:19]
    v_cvt_pk_bf16_f32 v162, v204, v205
    v_cvt_pk_bf16_f32 v163, v206, v207
    v_mfma_f32_16x16x32_bf16 v[48:51], a[96:99], v[172:175], v[48:51]
    v_exp_f32 v208, v208
    v_mfma_f32_16x16x32_bf16 v[80:83], a[96:99], v[180:183], v[80:83]
    v_exp_f32 v209, v209
    v_mfma_f32_16x16x32_bf16 v[112:115], a[96:99], v[188:191], v[112:115]
    v_exp_f32 v210, v210
    v_mfma_f32_16x16x32_bf16 v[144:147], a[96:99], v[196:199], v[144:147]
    v_exp_f32 v211, v211
    v_mfma_f32_16x16x32_bf16 v[148:151], a[100:103], v[196:199], v[148:151]
    v_cvt_pk_bf16_f32 v170, v208, v209
    v_cvt_pk_bf16_f32 v171, v210, v211
    v_mfma_f32_16x16x32_bf16 v[116:119], a[100:103], v[188:191], v[116:119]
    v_exp_f32 v212, v212
    v_mfma_f32_16x16x32_bf16 v[84:87], a[100:103], v[180:183], v[84:87]
    v_exp_f32 v213, v213
    v_mfma_f32_16x16x32_bf16 v[52:55], a[100:103], v[172:175], v[52:55]
    v_exp_f32 v214, v214
    v_mfma_f32_16x16x32_bf16 v[20:23], a[100:103], v[164:167], v[20:23]
    v_exp_f32 v215, v215
    v_mfma_f32_16x16x32_bf16 v[200:203], a[92:95], a[60:63], -4.0
    v_cvt_pk_bf16_f32 v178, v212, v213
    v_cvt_pk_bf16_f32 v179, v214, v215
    v_mfma_f32_16x16x32_bf16 v[200:203], a[88:91], a[56:59], v[200:203]
    v_cndmask_b32 v234, v234, v218, vcc
    v_cndmask_b32 v235, v235, v219, vcc
    v_mfma_f32_16x16x32_bf16 v[200:203], a[84:87], a[52:55], v[200:203]
    buffer_store_dwordx4 v[232:235], v245, s[16:19], s42 offen nt
    v_mfma_f32_16x16x32_bf16 v[200:203], a[80:83], a[48:51], v[200:203]
    s_waitcnt lgkmcnt(0)
    s_add_u32 s42, s42, 16384
    v_mfma_f32_16x16x32_bf16 v[204:207], a[80:83], a[64:67], -4.0
    ds_read_b128 a[80:83], v229 offset:57344
    v_mfma_f32_16x16x32_bf16 v[204:207], a[84:87], a[68:71], v[204:207]
    ds_read_b128 a[84:87], v229 offset:57600
    v_mfma_f32_16x16x32_bf16 v[204:207], a[88:91], a[72:75], v[204:207]
    ds_read_b128 a[88:91], v229 offset:57856
    v_mfma_f32_16x16x32_bf16 v[204:207], a[92:95], a[76:79], v[204:207]
    ds_read_b128 a[92:95], v229 offset:58112
    v_mfma_f32_16x16x32_bf16 v[24:27], a[104:107], v[164:167], v[24:27]
    v_exp_f32 v200, v200
    v_mfma_f32_16x16x32_bf16 v[56:59], a[104:107], v[172:175], v[56:59]
    v_exp_f32 v201, v201
    v_mfma_f32_16x16x32_bf16 v[88:91], a[104:107], v[180:183], v[88:91]
    v_exp_f32 v202, v202
    v_mfma_f32_16x16x32_bf16 v[120:123], a[104:107], v[188:191], v[120:123]
    v_exp_f32 v203, v203
    v_mfma_f32_16x16x32_bf16 v[152:155], a[104:107], v[196:199], v[152:155]
    v_cvt_pk_bf16_f32 v186, v200, v201
    v_cvt_pk_bf16_f32 v187, v202, v203
    v_mfma_f32_16x16x32_bf16 v[156:159], a[108:111], v[196:199], v[156:159]
    v_exp_f32 v204, v204
    v_mfma_f32_16x16x32_bf16 v[124:127], a[108:111], v[188:191], v[124:127]
    v_exp_f32 v205, v205
    v_mfma_f32_16x16x32_bf16 v[92:95], a[108:111], v[180:183], v[92:95]
    v_exp_f32 v206, v206
    v_mfma_f32_16x16x32_bf16 v[60:63], a[108:111], v[172:175], v[60:63]
    v_exp_f32 v207, v207
    v_mfma_f32_16x16x32_bf16 v[28:31], a[108:111], v[164:167], v[28:31]
    v_cvt_pk_bf16_f32 v194, v204, v205
    v_cvt_pk_bf16_f32 v195, v206, v207
    v_smfmac_f32_16x16x64_bf16 a[116:119], a[132:135], v[168:175], v238
    s_waitcnt lgkmcnt(0)
    v_mfma_f32_16x16x32_bf16 v[208:211], a[80:83], a[0:3], -4.0
    s_barrier
    v_mfma_f32_16x16x32_bf16 v[208:211], a[84:87], a[4:7], v[208:211]
    ds_write_b64 v236, a[144:145] offset:57344
    v_mfma_f32_16x16x32_bf16 v[208:211], a[88:91], a[8:11], v[208:211]
    ds_read_b128 a[104:107], v230 offset:49152
    v_mfma_f32_16x16x32_bf16 v[208:211], a[92:95], a[12:15], v[208:211]
    ds_write_b64 v236, a[146:147] offset:57352
    v_mfma_f32_16x16x32_bf16 v[212:215], a[92:95], a[28:31], -4.0
    ds_read_b128 a[108:111], v230 offset:50176
    v_mfma_f32_16x16x32_bf16 v[212:215], a[88:91], a[24:27], v[212:215]
    ds_write_b64 v236, a[148:149] offset:58368
    v_mfma_f32_16x16x32_bf16 v[212:215], a[84:87], a[20:23], v[212:215]
    ds_read_b128 a[96:99], v231 offset:49152
    v_mfma_f32_16x16x32_bf16 v[212:215], a[80:83], a[16:19], v[212:215]
    v_exp_f32 v208, v208
    v_mfma_f32_16x16x32_bf16 v[200:203], a[80:83], a[32:35], -4.0
    v_exp_f32 v209, v209
    v_mfma_f32_16x16x32_bf16 v[200:203], a[84:87], a[36:39], v[200:203]
    v_exp_f32 v210, v210
    v_mfma_f32_16x16x32_bf16 v[200:203], a[88:91], a[40:43], v[200:203]
    v_exp_f32 v211, v211
    v_mfma_f32_16x16x32_bf16 v[200:203], a[92:95], a[44:47], v[200:203]
    ds_read_b128 a[100:103], v231 offset:50176
    v_cvt_pk_bf16_f32 v164, v208, v209
    v_mfma_f32_16x16x32_bf16 v[0:3], a[136:139], v[160:163], v[0:3]
    v_cvt_pk_bf16_f32 v165, v210, v211
    v_mfma_f32_16x16x32_bf16 v[32:35], a[136:139], v[168:171], v[32:35]
    v_exp_f32 v212, v212
    v_mfma_f32_16x16x32_bf16 v[64:67], a[136:139], v[176:179], v[64:67]
    v_exp_f32 v213, v213
    v_mfma_f32_16x16x32_bf16 v[96:99], a[136:139], v[184:187], v[96:99]
    v_exp_f32 v214, v214
    v_mfma_f32_16x16x32_bf16 v[128:131], a[136:139], v[192:195], v[128:131]
    v_exp_f32 v215, v215
    v_mfma_f32_16x16x32_bf16 v[132:135], a[140:143], v[192:195], v[132:135]
    v_cvt_pk_bf16_f32 v172, v212, v213
    v_cvt_pk_bf16_f32 v173, v214, v215
    v_mfma_f32_16x16x32_bf16 v[100:103], a[140:143], v[184:187], v[100:103]
    v_exp_f32 v200, v200
    v_mfma_f32_16x16x32_bf16 v[68:71], a[140:143], v[176:179], v[68:71]
    v_exp_f32 v201, v201
    v_mfma_f32_16x16x32_bf16 v[36:39], a[140:143], v[168:171], v[36:39]
    v_exp_f32 v202, v202
    v_mfma_f32_16x16x32_bf16 v[4:7], a[140:143], v[160:163], v[4:7]
    v_exp_f32 v203, v203
    v_smfmac_f32_16x16x64_bf16 a[124:127], a[132:135], v[184:191], v238
    v_cvt_pk_bf16_f32 v180, v200, v201
    v_mfma_f32_16x16x32_bf16 v[204:207], a[92:95], a[60:63], -4.0
    v_cvt_pk_bf16_f32 v181, v202, v203
    v_mfma_f32_16x16x32_bf16 v[204:207], a[88:91], a[56:59], v[204:207]
    ds_write_b64 v236, a[150:151] offset:58376
    v_mfma_f32_16x16x32_bf16 v[204:207], a[84:87], a[52:55], v[204:207]
    v_mfma_f32_16x16x32_bf16 v[204:207], a[80:83], a[48:51], v[204:207]
    v_mfma_f32_16x16x32_bf16 v[208:211], a[80:83], a[64:67], -4.0
    ds_read_b128 a[80:83], v229 offset:61440
    v_mfma_f32_16x16x32_bf16 v[208:211], a[84:87], a[68:71], v[208:211]
    ds_read_b128 a[84:87], v229 offset:61696
    v_mfma_f32_16x16x32_bf16 v[208:211], a[88:91], a[72:75], v[208:211]
    ds_read_b128 a[88:91], v229 offset:61952
    v_mfma_f32_16x16x32_bf16 v[208:211], a[92:95], a[76:79], v[208:211]
    s_waitcnt lgkmcnt(4)
    v_exp_f32 v204, v204
    v_mfma_f32_16x16x32_bf16 v[8:11], a[104:107], v[160:163], v[8:11]
    ds_read_b128 a[92:95], v229 offset:62208
    v_mfma_f32_16x16x32_bf16 v[40:43], a[104:107], v[168:171], v[40:43]
    v_exp_f32 v205, v205
    v_mfma_f32_16x16x32_bf16 v[72:75], a[104:107], v[176:179], v[72:75]
    v_exp_f32 v206, v206
    v_mfma_f32_16x16x32_bf16 v[104:107], a[104:107], v[184:187], v[104:107]
    v_exp_f32 v207, v207
    v_mfma_f32_16x16x32_bf16 v[136:139], a[104:107], v[192:195], v[136:139]
    ds_read_b128 a[104:107], v239 offset:49152
    v_cvt_pk_bf16_f32 v188, v204, v205
    v_mfma_f32_16x16x32_bf16 v[140:143], a[108:111], v[192:195], v[140:143]
    v_cvt_pk_bf16_f32 v189, v206, v207
    v_mfma_f32_16x16x32_bf16 v[108:111], a[108:111], v[184:187], v[108:111]
    v_exp_f32 v208, v208
    v_mfma_f32_16x16x32_bf16 v[76:79], a[108:111], v[176:179], v[76:79]
    v_exp_f32 v209, v209
    v_mfma_f32_16x16x32_bf16 v[44:47], a[108:111], v[168:171], v[44:47]
    v_exp_f32 v210, v210
    v_mfma_f32_16x16x32_bf16 v[12:15], a[108:111], v[160:163], v[12:15]
    s_waitcnt lgkmcnt(2)
    v_exp_f32 v211, v211
    v_mfma_f32_16x16x32_bf16 v[212:215], a[80:83], a[0:3], -4.0
    ds_read_b128 a[108:111], v239 offset:50176
    v_cvt_pk_bf16_f32 v196, v208, v209
    v_mfma_f32_16x16x32_bf16 v[212:215], a[84:87], a[4:7], v[212:215]
    v_cvt_pk_bf16_f32 v197, v210, v211
    v_mfma_f32_16x16x32_bf16 v[212:215], a[88:91], a[8:11], v[212:215]
    s_waitcnt lgkmcnt(2)
    s_waitcnt vmcnt(7)
    v_accvgpr_mov_b32 a0, a240
    v_mfma_f32_16x16x32_bf16 v[212:215], a[92:95], a[12:15], v[212:215]
    v_accvgpr_mov_b32 a1, a241
    v_accvgpr_mov_b32 a2, a242
    v_mfma_f32_16x16x32_bf16 v[200:203], a[92:95], a[28:31], -4.0
    v_accvgpr_mov_b32 a3, a243
    v_mfma_f32_16x16x32_bf16 v[200:203], a[88:91], a[24:27], v[200:203]
    s_waitcnt vmcnt(6)
    v_accvgpr_mov_b32 a4, a244
    v_accvgpr_mov_b32 a5, a245
    v_mfma_f32_16x16x32_bf16 v[200:203], a[84:87], a[20:23], v[200:203]
    v_exp_f32 v212, v212
    v_mfma_f32_16x16x32_bf16 v[200:203], a[80:83], a[16:19], v[200:203]
    v_exp_f32 v213, v213
    v_mfma_f32_16x16x32_bf16 v[204:207], a[80:83], a[32:35], -4.0
    v_exp_f32 v214, v214
    v_mfma_f32_16x16x32_bf16 v[204:207], a[84:87], a[36:39], v[204:207]
    v_exp_f32 v215, v215
    v_mfma_f32_16x16x32_bf16 v[204:207], a[88:91], a[40:43], v[204:207]
    v_cvt_pk_bf16_f32 v166, v212, v213
    v_cvt_pk_bf16_f32 v167, v214, v215
    v_mfma_f32_16x16x32_bf16 v[204:207], a[92:95], a[44:47], v[204:207]
    v_exp_f32 v200, v200
    v_mfma_f32_16x16x32_bf16 v[16:19], a[96:99], v[160:163], v[16:19]
    v_exp_f32 v201, v201
    v_mfma_f32_16x16x32_bf16 v[48:51], a[96:99], v[168:171], v[48:51]
    v_exp_f32 v202, v202
    v_mfma_f32_16x16x32_bf16 v[80:83], a[96:99], v[176:179], v[80:83]
    v_exp_f32 v203, v203
    v_mfma_f32_16x16x32_bf16 v[112:115], a[96:99], v[184:187], v[112:115]
    v_exp_f32 v204, v204
    v_mfma_f32_16x16x32_bf16 v[144:147], a[96:99], v[192:195], v[144:147]
    v_exp_f32 v205, v205
    v_mfma_f32_16x16x32_bf16 v[148:151], a[100:103], v[192:195], v[148:151]
    v_exp_f32 v206, v206
    v_mfma_f32_16x16x32_bf16 v[116:119], a[100:103], v[184:187], v[116:119]
    v_exp_f32 v207, v207
    v_mfma_f32_16x16x32_bf16 v[84:87], a[100:103], v[176:179], v[84:87]
    v_cvt_pk_bf16_f32 v182, v204, v205
    v_cvt_pk_bf16_f32 v183, v206, v207
    v_mfma_f32_16x16x32_bf16 v[52:55], a[100:103], v[168:171], v[52:55]
    v_cvt_pk_bf16_f32 v174, v200, v201
    v_cvt_pk_bf16_f32 v175, v202, v203
    v_mfma_f32_16x16x32_bf16 v[20:23], a[100:103], v[160:163], v[20:23]
    v_accvgpr_mov_b32 a6, a246
    v_accvgpr_mov_b32 a7, a247
    v_smfmac_f32_16x16x64_bf16 a[112:115], a[132:135], v[160:167], v238
    s_waitcnt vmcnt(5)
    v_accvgpr_mov_b32 a8, a248
    v_mfma_f32_16x16x32_bf16 v[208:211], a[92:95], a[60:63], -4.0
    v_accvgpr_mov_b32 a9, a249
    v_accvgpr_mov_b32 a10, a250
    v_mfma_f32_16x16x32_bf16 v[208:211], a[88:91], a[56:59], v[208:211]
    v_accvgpr_mov_b32 a11, a251
    v_mfma_f32_16x16x32_bf16 v[208:211], a[84:87], a[52:55], v[208:211]
    v_accvgpr_read_b32 v224, a112
    v_accvgpr_read_b32 v226, a113
    v_mfma_f32_16x16x32_bf16 v[208:211], a[80:83], a[48:51], v[208:211]
    v_add_f32 v226, v226, v224
    v_accvgpr_write_b32 a112, 0
    v_mfma_f32_16x16x32_bf16 v[212:215], a[80:83], a[64:67], -4.0
    v_rcp_f32 v224, v226
    v_mfma_f32_16x16x32_bf16 v[212:215], a[84:87], a[68:71], v[212:215]
    ds_read_b128 a[80:83], v228 offset:0
    v_mov_b32_dpp v246, v224 row_ror:8 row_mask:0xf bank_mask:0xf
    v_mfma_f32_16x16x32_bf16 v[212:215], a[88:91], a[72:75], v[212:215]
    ds_read_b128 a[84:87], v228 offset:256
    v_accvgpr_write_b32 a113, 0
    v_mfma_f32_16x16x32_bf16 v[212:215], a[92:95], a[76:79], v[212:215]
    s_waitcnt lgkmcnt(2)
    s_waitcnt vmcnt(4)
    v_accvgpr_mov_b32 a12, a252
    v_mfma_f32_16x16x32_bf16 v[24:27], a[104:107], v[160:163], v[24:27]
    ds_read_b128 a[88:91], v228 offset:512
    v_accvgpr_mov_b32 a13, a253
    v_mfma_f32_16x16x32_bf16 v[56:59], a[104:107], v[168:171], v[56:59]
    ds_read_b128 a[92:95], v228 offset:768
    v_accvgpr_mov_b32 a14, a254
    v_mfma_f32_16x16x32_bf16 v[88:91], a[104:107], v[176:179], v[88:91]
    v_accvgpr_mov_b32 a15, a255
    v_max3_f32 v227, v226, v224, v227
    v_mfma_f32_16x16x32_bf16 v[120:123], a[104:107], v[184:187], v[120:123]
    v_exp_f32 v208, v208
    v_mfma_f32_16x16x32_bf16 v[152:155], a[104:107], v[192:195], v[152:155]
    v_exp_f32 v209, v209
    v_mfma_f32_16x16x32_bf16 v[156:159], a[108:111], v[192:195], v[156:159]
    v_exp_f32 v210, v210
    v_mfma_f32_16x16x32_bf16 v[124:127], a[108:111], v[184:187], v[124:127]
    v_exp_f32 v211, v211
    v_mfma_f32_16x16x32_bf16 v[92:95], a[108:111], v[176:179], v[92:95]
    v_cvt_pk_bf16_f32 v190, v208, v209
    v_cvt_pk_bf16_f32 v191, v210, v211
    v_mfma_f32_16x16x32_bf16 v[60:63], a[108:111], v[168:171], v[60:63]
    v_exp_f32 v212, v212
    v_mfma_f32_16x16x32_bf16 v[28:31], a[108:111], v[160:163], v[28:31]
    v_exp_f32 v213, v213
    v_smfmac_f32_16x16x64_bf16 a[120:123], a[132:135], v[176:183], v238
    s_waitcnt lgkmcnt(1)
    s_add_u32 s4, s4, 16384
    s_addc_u32 s5, s5, 0
    v_mfma_f32_16x16x32_bf16 v[200:203], a[80:83], a[0:3], -4.0
    global_load_dwordx4 a[240:243], v237, s[4:5] offset:0
    v_mfma_f32_16x16x32_bf16 v[200:203], a[84:87], a[4:7], v[200:203]
    global_load_dwordx4 a[244:247], v237, s[4:5] offset:64
    v_mfma_f32_16x16x32_bf16 v[200:203], a[88:91], a[8:11], v[200:203]
    s_waitcnt lgkmcnt(0)
    v_exp_f32 v214, v214
    v_mfma_f32_16x16x32_bf16 v[200:203], a[92:95], a[12:15], v[200:203]
    global_load_dwordx4 a[248:251], v237, s[4:5] offset:128
    v_mfma_f32_16x16x32_bf16 v[204:207], a[92:95], a[28:31], -4.0
    global_load_dwordx4 a[252:255], v237, s[4:5] offset:192
    v_mfma_f32_16x16x32_bf16 v[204:207], a[88:91], a[24:27], v[204:207]
    v_exp_f32 v215, v215
    v_mfma_f32_16x16x32_bf16 v[204:207], a[84:87], a[20:23], v[204:207]
    v_cvt_pk_bf16_f32 v198, v212, v213
    v_cvt_pk_bf16_f32 v199, v214, v215
    v_mfma_f32_16x16x32_bf16 v[204:207], a[80:83], a[16:19], v[204:207]
    s_barrier
    v_mfma_f32_16x16x32_bf16 v[208:211], a[80:83], a[32:35], -4.0
    ds_read_b128 a[104:107], v230 offset:57344
    v_mfma_f32_16x16x32_bf16 v[208:211], a[84:87], a[36:39], v[208:211]
    v_exp_f32 v200, v200
    v_mfma_f32_16x16x32_bf16 v[208:211], a[88:91], a[40:43], v[208:211]
    v_exp_f32 v201, v201
    v_mfma_f32_16x16x32_bf16 v[208:211], a[92:95], a[44:47], v[208:211]
    v_exp_f32 v202, v202
    v_mfma_f32_16x16x32_bf16 v[0:3], a[144:147], v[164:167], v[0:3]
    v_exp_f32 v203, v203
    v_mfma_f32_16x16x32_bf16 v[32:35], a[144:147], v[172:175], v[32:35]
    ds_read_b128 a[108:111], v230 offset:58368
    v_cvt_pk_bf16_f32 v160, v200, v201
    v_mfma_f32_16x16x32_bf16 v[64:67], a[144:147], v[180:183], v[64:67]
    ds_read_b128 a[96:99], v231 offset:57344
    v_cvt_pk_bf16_f32 v161, v202, v203
    v_mfma_f32_16x16x32_bf16 v[96:99], a[144:147], v[188:191], v[96:99]
    v_exp_f32 v204, v204
    v_mfma_f32_16x16x32_bf16 v[128:131], a[144:147], v[196:199], v[128:131]
    v_exp_f32 v205, v205
    v_mfma_f32_16x16x32_bf16 v[132:135], a[148:151], v[196:199], v[132:135]
    v_exp_f32 v206, v206
    v_mfma_f32_16x16x32_bf16 v[100:103], a[148:151], v[188:191], v[100:103]
    v_exp_f32 v207, v207
    v_mfma_f32_16x16x32_bf16 v[68:71], a[148:151], v[180:183], v[68:71]
    ds_read_b128 a[100:103], v231 offset:58368
    v_cvt_pk_bf16_f32 v168, v204, v205
    v_mfma_f32_16x16x32_bf16 v[36:39], a[148:151], v[172:175], v[36:39]
    v_cvt_pk_bf16_f32 v169, v206, v207
    v_mul_f32 v0, v0, v224
    v_mfma_f32_16x16x32_bf16 v[4:7], a[148:151], v[164:167], v[4:7]
    v_exp_f32 v208, v208
    v_smfmac_f32_16x16x64_bf16 a[128:131], a[132:135], v[192:199], v238
    v_mul_f32 v1, v1, v224
    v_mfma_f32_16x16x32_bf16 v[212:215], a[92:95], a[60:63], -4.0
    v_exp_f32 v209, v209
    v_mfma_f32_16x16x32_bf16 v[212:215], a[88:91], a[56:59], v[212:215]
    v_exp_f32 v210, v210
    v_mfma_f32_16x16x32_bf16 v[212:215], a[84:87], a[52:55], v[212:215]
    v_exp_f32 v211, v211
    v_mfma_f32_16x16x32_bf16 v[212:215], a[80:83], a[48:51], v[212:215]
    v_cvt_pk_bf16_f32 v176, v208, v209
    v_cvt_pk_bf16_f32 v177, v210, v211
    v_mfma_f32_16x16x32_bf16 v[200:203], a[80:83], a[64:67], -4.0
    ds_read_b128 a[80:83], v228 offset:4096
    v_mul_f32 v2, v2, v224
    v_mfma_f32_16x16x32_bf16 v[200:203], a[84:87], a[68:71], v[200:203]
    ds_read_b128 a[84:87], v228 offset:4352
    v_mul_f32 v3, v3, v224
    v_mfma_f32_16x16x32_bf16 v[200:203], a[88:91], a[72:75], v[200:203]
    ds_read_b128 a[88:91], v228 offset:4608
    v_cvt_pk_bf16_f32 v216, v0, v1
    v_mfma_f32_16x16x32_bf16 v[200:203], a[92:95], a[76:79], v[200:203]
    s_waitcnt lgkmcnt(3)
    v_exp_f32 v212, v212
    v_mfma_f32_16x16x32_bf16 v[8:11], a[104:107], v[164:167], v[8:11]
    ds_read_b128 a[92:95], v228 offset:4864
    v_cvt_pk_bf16_f32 v217, v2, v3
    v_mfma_f32_16x16x32_bf16 v[40:43], a[104:107], v[172:175], v[40:43]
    v_exp_f32 v213, v213
    v_mfma_f32_16x16x32_bf16 v[72:75], a[104:107], v[180:183], v[72:75]
    v_exp_f32 v214, v214
    v_mfma_f32_16x16x32_bf16 v[104:107], a[104:107], v[188:191], v[104:107]
    v_exp_f32 v215, v215
    v_mfma_f32_16x16x32_bf16 v[136:139], a[104:107], v[196:199], v[136:139]
    ds_read_b128 a[104:107], v239 offset:57344
    v_cvt_pk_bf16_f32 v184, v212, v213
    v_mfma_f32_16x16x32_bf16 v[140:143], a[108:111], v[196:199], v[140:143]
    v_cvt_pk_bf16_f32 v185, v214, v215
    v_mul_f32 v4, v4, v224
    v_mfma_f32_16x16x32_bf16 v[108:111], a[108:111], v[188:191], v[108:111]
    v_exp_f32 v200, v200
    v_mfma_f32_16x16x32_bf16 v[76:79], a[108:111], v[180:183], v[76:79]
    v_exp_f32 v201, v201
    v_mfma_f32_16x16x32_bf16 v[44:47], a[108:111], v[172:175], v[44:47]
    v_exp_f32 v202, v202
    v_mfma_f32_16x16x32_bf16 v[12:15], a[108:111], v[164:167], v[12:15]
    s_waitcnt lgkmcnt(2)
    v_exp_f32 v203, v203
    v_mfma_f32_16x16x32_bf16 v[204:207], a[80:83], a[0:3], -4.0
    ds_read_b128 a[108:111], v239 offset:58368
    v_cvt_pk_bf16_f32 v192, v200, v201
    v_mfma_f32_16x16x32_bf16 v[204:207], a[84:87], a[4:7], v[204:207]
    v_cvt_pk_bf16_f32 v193, v202, v203
    v_mul_f32 v5, v5, v224
    v_mfma_f32_16x16x32_bf16 v[204:207], a[88:91], a[8:11], v[204:207]
    s_waitcnt lgkmcnt(2)
    v_mul_f32 v6, v6, v224
    v_mul_f32 v7, v7, v224
    v_mfma_f32_16x16x32_bf16 v[204:207], a[92:95], a[12:15], v[204:207]
    v_cvt_pk_bf16_f32 v218, v4, v5
    v_cvt_pk_bf16_f32 v219, v6, v7
    v_mfma_f32_16x16x32_bf16 v[208:211], a[92:95], a[28:31], -4.0
    v_mul_f32_dpp v8, v8, v246 row_ror:8 row_mask:0xf bank_mask:0xf
    v_mul_f32_dpp v9, v9, v246 row_ror:8 row_mask:0xf bank_mask:0xf
    v_mfma_f32_16x16x32_bf16 v[208:211], a[88:91], a[24:27], v[208:211]
    v_mul_f32_dpp v10, v10, v246 row_ror:8 row_mask:0xf bank_mask:0xf
    v_mul_f32_dpp v11, v11, v246 row_ror:8 row_mask:0xf bank_mask:0xf
    v_mfma_f32_16x16x32_bf16 v[208:211], a[84:87], a[20:23], v[208:211]
    v_exp_f32 v204, v204
    v_mfma_f32_16x16x32_bf16 v[208:211], a[80:83], a[16:19], v[208:211]
    v_exp_f32 v205, v205
    v_mfma_f32_16x16x32_bf16 v[212:215], a[80:83], a[32:35], -4.0
    v_exp_f32 v206, v206
    v_mfma_f32_16x16x32_bf16 v[212:215], a[84:87], a[36:39], v[212:215]
    v_exp_f32 v207, v207
    v_mfma_f32_16x16x32_bf16 v[212:215], a[88:91], a[40:43], v[212:215]
    v_cvt_pk_bf16_f32 v162, v204, v205
    v_cvt_pk_bf16_f32 v163, v206, v207
    v_mfma_f32_16x16x32_bf16 v[212:215], a[92:95], a[44:47], v[212:215]
    v_exp_f32 v208, v208
    v_mfma_f32_16x16x32_bf16 v[16:19], a[96:99], v[164:167], v[16:19]
    v_exp_f32 v209, v209
    v_mfma_f32_16x16x32_bf16 v[48:51], a[96:99], v[172:175], v[48:51]
    v_exp_f32 v210, v210
    v_mfma_f32_16x16x32_bf16 v[80:83], a[96:99], v[180:183], v[80:83]
    v_exp_f32 v211, v211
    v_mfma_f32_16x16x32_bf16 v[112:115], a[96:99], v[188:191], v[112:115]
    v_cvt_pk_bf16_f32 v170, v208, v209
    v_cvt_pk_bf16_f32 v171, v210, v211
    v_mfma_f32_16x16x32_bf16 v[144:147], a[96:99], v[196:199], v[144:147]
    v_exp_f32 v212, v212
    v_mfma_f32_16x16x32_bf16 v[148:151], a[100:103], v[196:199], v[148:151]
    v_exp_f32 v213, v213
    v_mfma_f32_16x16x32_bf16 v[116:119], a[100:103], v[188:191], v[116:119]
    v_exp_f32 v214, v214
    v_mfma_f32_16x16x32_bf16 v[84:87], a[100:103], v[180:183], v[84:87]
    v_exp_f32 v215, v215
    v_mfma_f32_16x16x32_bf16 v[52:55], a[100:103], v[172:175], v[52:55]
    ds_read_b128 a[96:99], v236 offset:32768
    v_cvt_pk_bf16_f32 v178, v212, v213
    v_mfma_f32_16x16x32_bf16 v[20:23], a[100:103], v[164:167], v[20:23]
    ds_read_b128 a[100:103], v236 offset:33792
    v_cvt_pk_bf16_f32 v179, v214, v215
    v_mfma_f32_16x16x32_bf16 v[200:203], a[92:95], a[60:63], -4.0
    v_cvt_pk_bf16_f32 v220, v8, v9
    v_cvt_pk_bf16_f32 v221, v10, v11
    v_mfma_f32_16x16x32_bf16 v[200:203], a[88:91], a[56:59], v[200:203]
    v_mul_f32_dpp v12, v12, v246 row_ror:8 row_mask:0xf bank_mask:0xf
    v_mul_f32_dpp v13, v13, v246 row_ror:8 row_mask:0xf bank_mask:0xf
    v_mfma_f32_16x16x32_bf16 v[200:203], a[84:87], a[52:55], v[200:203]
    v_mul_f32_dpp v14, v14, v246 row_ror:8 row_mask:0xf bank_mask:0xf
    v_mul_f32_dpp v15, v15, v246 row_ror:8 row_mask:0xf bank_mask:0xf
    v_mfma_f32_16x16x32_bf16 v[200:203], a[80:83], a[48:51], v[200:203]
    v_cvt_pk_bf16_f32 v222, v12, v13
    v_cvt_pk_bf16_f32 v223, v14, v15
    v_mfma_f32_16x16x32_bf16 v[204:207], a[80:83], a[64:67], -4.0
    ds_read_b128 a[80:83], v228 offset:8192
    v_cndmask_b32 v240, v216, v220, vcc
    v_mfma_f32_16x16x32_bf16 v[204:207], a[84:87], a[68:71], v[204:207]
    ds_read_b128 a[84:87], v228 offset:8448
    v_cndmask_b32 v241, v217, v221, vcc
    v_mfma_f32_16x16x32_bf16 v[204:207], a[88:91], a[72:75], v[204:207]
    ds_read_b128 a[88:91], v228 offset:8704
    v_cndmask_b32 v220, v220, v216, vcc
    v_mfma_f32_16x16x32_bf16 v[204:207], a[92:95], a[76:79], v[204:207]
    s_waitcnt lgkmcnt(5)
    v_exp_f32 v200, v200
    v_mfma_f32_16x16x32_bf16 v[24:27], a[104:107], v[164:167], v[24:27]
    ds_read_b128 a[92:95], v228 offset:8960
    v_cndmask_b32 v221, v221, v217, vcc
    v_mfma_f32_16x16x32_bf16 v[56:59], a[104:107], v[172:175], v[56:59]
    v_exp_f32 v201, v201
    v_mfma_f32_16x16x32_bf16 v[88:91], a[104:107], v[180:183], v[88:91]
    v_exp_f32 v202, v202
    v_mfma_f32_16x16x32_bf16 v[120:123], a[104:107], v[188:191], v[120:123]
    v_exp_f32 v203, v203
    v_mfma_f32_16x16x32_bf16 v[152:155], a[104:107], v[196:199], v[152:155]
    ds_read_b128 a[104:107], v230 offset:32768
    v_cvt_pk_bf16_f32 v186, v200, v201
    v_mfma_f32_16x16x32_bf16 v[156:159], a[108:111], v[196:199], v[156:159]
    v_cvt_pk_bf16_f32 v187, v202, v203
    v_mul_f32 v16, v16, v224
    v_mfma_f32_16x16x32_bf16 v[124:127], a[108:111], v[188:191], v[124:127]
    v_exp_f32 v204, v204
    v_mfma_f32_16x16x32_bf16 v[92:95], a[108:111], v[180:183], v[92:95]
    v_exp_f32 v205, v205
    v_mfma_f32_16x16x32_bf16 v[60:63], a[108:111], v[172:175], v[60:63]
    v_exp_f32 v206, v206
    v_mfma_f32_16x16x32_bf16 v[28:31], a[108:111], v[164:167], v[28:31]
    v_exp_f32 v207, v207
    s_branch L_loop
L_loop_done:
    v_smfmac_f32_16x16x64_bf16 a[116:119], a[132:135], v[168:175], v238
    s_waitcnt lgkmcnt(0)
    v_mul_f32_dpp v138, v138, v246 row_ror:8 row_mask:0xf bank_mask:0xf
    v_mfma_f32_16x16x32_bf16 v[208:211], a[80:83], a[0:3], -4.0
    s_barrier
    v_mfma_f32_16x16x32_bf16 v[208:211], a[84:87], a[4:7], v[208:211]
    ds_write_b64 v236, v[248:249] offset:57344
    v_mfma_f32_16x16x32_bf16 v[208:211], a[88:91], a[8:11], v[208:211]
    ds_read_b128 a[104:107], v230 offset:49152
    v_mul_f32_dpp v139, v139, v246 row_ror:8 row_mask:0xf bank_mask:0xf
    v_mfma_f32_16x16x32_bf16 v[208:211], a[92:95], a[12:15], v[208:211]
    ds_write_b64 v236, v[250:251] offset:57352
    v_mfma_f32_16x16x32_bf16 v[212:215], a[92:95], a[28:31], -4.0
    ds_read_b128 a[108:111], v230 offset:50176
    v_cvt_pk_bf16_f32 v220, v136, v137
    v_mfma_f32_16x16x32_bf16 v[212:215], a[88:91], a[24:27], v[212:215]
    ds_read_b128 a[96:99], v231 offset:49152
    v_cvt_pk_bf16_f32 v221, v138, v139
    v_mfma_f32_16x16x32_bf16 v[212:215], a[84:87], a[20:23], v[212:215]
    v_exp_f32 v208, v208
    v_mfma_f32_16x16x32_bf16 v[212:215], a[80:83], a[16:19], v[212:215]
    v_exp_f32 v209, v209
    v_mfma_f32_16x16x32_bf16 v[200:203], a[80:83], a[32:35], -4.0
    v_exp_f32 v210, v210
    v_mfma_f32_16x16x32_bf16 v[200:203], a[84:87], a[36:39], v[200:203]
    v_exp_f32 v211, v211
    v_mfma_f32_16x16x32_bf16 v[200:203], a[88:91], a[40:43], v[200:203]
    ds_read_b128 a[100:103], v231 offset:50176
    v_cvt_pk_bf16_f32 v164, v208, v209
    v_mfma_f32_16x16x32_bf16 v[200:203], a[92:95], a[44:47], v[200:203]
    v_cvt_pk_bf16_f32 v165, v210, v211
    v_mul_f32_dpp v140, v140, v246 row_ror:8 row_mask:0xf bank_mask:0xf
    v_mfma_f32_16x16x32_bf16 v[0:3], a[232:235], v[160:163], v[0:3]
    v_mul_f32_dpp v141, v141, v246 row_ror:8 row_mask:0xf bank_mask:0xf
    v_mul_f32_dpp v142, v142, v246 row_ror:8 row_mask:0xf bank_mask:0xf
    v_mfma_f32_16x16x32_bf16 v[32:35], a[232:235], v[168:171], v[32:35]
    v_mul_f32_dpp v143, v143, v246 row_ror:8 row_mask:0xf bank_mask:0xf
    v_cvt_pk_bf16_f32 v222, v140, v141
    v_mfma_f32_16x16x32_bf16 v[64:67], a[232:235], v[176:179], v[64:67]
    v_cvt_pk_bf16_f32 v223, v142, v143
    v_cndmask_b32 v240, v216, v220, vcc
    v_mfma_f32_16x16x32_bf16 v[96:99], a[232:235], v[184:187], v[96:99]
    ds_write_b64 v236, v[252:253] offset:58368
    v_mfma_f32_16x16x32_bf16 v[128:131], a[232:235], v[192:195], 0
    v_exp_f32 v212, v212
    v_mfma_f32_16x16x32_bf16 v[132:135], a[236:239], v[192:195], 0
    v_exp_f32 v213, v213
    v_mfma_f32_16x16x32_bf16 v[100:103], a[236:239], v[184:187], v[100:103]
    v_exp_f32 v214, v214
    v_mfma_f32_16x16x32_bf16 v[68:71], a[236:239], v[176:179], v[68:71]
    v_exp_f32 v215, v215
    v_mfma_f32_16x16x32_bf16 v[36:39], a[236:239], v[168:171], v[36:39]
    v_cvt_pk_bf16_f32 v172, v212, v213
    v_cvt_pk_bf16_f32 v173, v214, v215
    v_mfma_f32_16x16x32_bf16 v[4:7], a[236:239], v[160:163], v[4:7]
    v_exp_f32 v200, v200
    v_smfmac_f32_16x16x64_bf16 a[124:127], a[132:135], v[184:191], v238
    ds_write_b64 v236, v[254:255] offset:58376
    v_mfma_f32_16x16x32_bf16 v[204:207], a[92:95], a[60:63], -4.0
    v_exp_f32 v201, v201
    v_mfma_f32_16x16x32_bf16 v[204:207], a[88:91], a[56:59], v[204:207]
    v_exp_f32 v202, v202
    v_mfma_f32_16x16x32_bf16 v[204:207], a[84:87], a[52:55], v[204:207]
    v_exp_f32 v203, v203
    v_mfma_f32_16x16x32_bf16 v[204:207], a[80:83], a[48:51], v[204:207]
    v_cvt_pk_bf16_f32 v180, v200, v201
    v_cvt_pk_bf16_f32 v181, v202, v203
    v_mfma_f32_16x16x32_bf16 v[208:211], a[80:83], a[64:67], -4.0
    ds_read_b128 a[80:83], v229 offset:45056
    v_cndmask_b32 v241, v217, v221, vcc
    v_mfma_f32_16x16x32_bf16 v[208:211], a[84:87], a[68:71], v[208:211]
    ds_read_b128 a[84:87], v229 offset:45312
    v_cndmask_b32 v220, v220, v216, vcc
    v_mfma_f32_16x16x32_bf16 v[208:211], a[88:91], a[72:75], v[208:211]
    ds_read_b128 a[88:91], v229 offset:45568
    v_cndmask_b32 v221, v221, v217, vcc
    v_mfma_f32_16x16x32_bf16 v[208:211], a[92:95], a[76:79], v[208:211]
    s_waitcnt lgkmcnt(4)
    v_exp_f32 v204, v204
    v_mfma_f32_16x16x32_bf16 v[8:11], a[104:107], v[160:163], v[8:11]
    ds_read_b128 a[92:95], v229 offset:45824
    v_mul_f32 v144, v144, v224
    v_mfma_f32_16x16x32_bf16 v[40:43], a[104:107], v[168:171], v[40:43]
    v_exp_f32 v205, v205
    v_mfma_f32_16x16x32_bf16 v[72:75], a[104:107], v[176:179], v[72:75]
    v_exp_f32 v206, v206
    v_mfma_f32_16x16x32_bf16 v[104:107], a[104:107], v[184:187], v[104:107]
    v_exp_f32 v207, v207
    v_mfma_f32_16x16x32_bf16 v[136:139], a[104:107], v[192:195], 0
    ds_read_b128 a[104:107], v239 offset:49152
    v_cvt_pk_bf16_f32 v188, v204, v205
    v_mfma_f32_16x16x32_bf16 v[140:143], a[108:111], v[192:195], 0
    v_cvt_pk_bf16_f32 v189, v206, v207
    v_mul_f32 v145, v145, v224
    v_mfma_f32_16x16x32_bf16 v[108:111], a[108:111], v[184:187], v[108:111]
    v_mul_f32 v146, v146, v224
    v_mul_f32 v147, v147, v224
    v_mfma_f32_16x16x32_bf16 v[76:79], a[108:111], v[176:179], v[76:79]
    v_cndmask_b32 v242, v218, v222, vcc
    v_cndmask_b32 v243, v219, v223, vcc
    v_mfma_f32_16x16x32_bf16 v[44:47], a[108:111], v[168:171], v[44:47]
    v_cvt_pk_bf16_f32 v216, v144, v145
    v_cvt_pk_bf16_f32 v217, v146, v147
    v_mfma_f32_16x16x32_bf16 v[12:15], a[108:111], v[160:163], v[12:15]
    s_waitcnt lgkmcnt(2)
    v_cndmask_b32 v222, v222, v218, vcc
    v_cndmask_b32 v223, v223, v219, vcc
    v_mfma_f32_16x16x32_bf16 v[212:215], a[80:83], a[0:3], -4.0
    ds_read_b128 a[108:111], v239 offset:50176
    v_mul_f32 v148, v148, v224
    v_mfma_f32_16x16x32_bf16 v[212:215], a[84:87], a[4:7], v[212:215]
    v_mul_f32 v149, v149, v224
    v_mul_f32 v150, v150, v224
    v_mfma_f32_16x16x32_bf16 v[212:215], a[88:91], a[8:11], v[212:215]
    s_waitcnt lgkmcnt(2)
    v_mul_f32 v151, v151, v224
    v_cvt_pk_bf16_f32 v218, v148, v149
    v_mfma_f32_16x16x32_bf16 v[212:215], a[92:95], a[12:15], v[212:215]
    v_cvt_pk_bf16_f32 v219, v150, v151
    v_mul_f32_dpp v152, v152, v246 row_ror:8 row_mask:0xf bank_mask:0xf
    v_mfma_f32_16x16x32_bf16 v[200:203], a[92:95], a[28:31], -4.0
    v_exp_f32 v208, v208
    v_mfma_f32_16x16x32_bf16 v[200:203], a[88:91], a[24:27], v[200:203]
    v_exp_f32 v209, v209
    v_mfma_f32_16x16x32_bf16 v[200:203], a[84:87], a[20:23], v[200:203]
    v_exp_f32 v210, v210
    v_mfma_f32_16x16x32_bf16 v[200:203], a[80:83], a[16:19], v[200:203]
    v_exp_f32 v212, v212
    v_mfma_f32_16x16x32_bf16 v[204:207], a[80:83], a[32:35], -4.0
    v_exp_f32 v213, v213
    v_mfma_f32_16x16x32_bf16 v[204:207], a[84:87], a[36:39], v[204:207]
    v_exp_f32 v214, v214
    v_mfma_f32_16x16x32_bf16 v[204:207], a[88:91], a[40:43], v[204:207]
    v_exp_f32 v215, v215
    v_mfma_f32_16x16x32_bf16 v[204:207], a[92:95], a[44:47], v[204:207]
    v_cvt_pk_bf16_f32 v166, v212, v213
    v_cvt_pk_bf16_f32 v167, v214, v215
    v_mfma_f32_16x16x32_bf16 v[16:19], a[96:99], v[160:163], v[16:19]
    v_exp_f32 v211, v211
    v_mfma_f32_16x16x32_bf16 v[48:51], a[96:99], v[168:171], v[48:51]
    v_cvt_pk_bf16_f32 v196, v208, v209
    v_cvt_pk_bf16_f32 v197, v210, v211
    v_mfma_f32_16x16x32_bf16 v[80:83], a[96:99], v[176:179], v[80:83]
    v_mul_f32_dpp v153, v153, v246 row_ror:8 row_mask:0xf bank_mask:0xf
    v_mul_f32_dpp v154, v154, v246 row_ror:8 row_mask:0xf bank_mask:0xf
    v_mfma_f32_16x16x32_bf16 v[112:115], a[96:99], v[184:187], v[112:115]
    v_mul_f32_dpp v155, v155, v246 row_ror:8 row_mask:0xf bank_mask:0xf
    v_cvt_pk_bf16_f32 v232, v152, v153
    v_mfma_f32_16x16x32_bf16 v[144:147], a[96:99], v[192:195], 0
    v_cvt_pk_bf16_f32 v233, v154, v155
    v_mul_f32_dpp v156, v156, v246 row_ror:8 row_mask:0xf bank_mask:0xf
    v_mfma_f32_16x16x32_bf16 v[148:151], a[100:103], v[192:195], 0
    v_mul_f32_dpp v157, v157, v246 row_ror:8 row_mask:0xf bank_mask:0xf
    v_mul_f32_dpp v158, v158, v246 row_ror:8 row_mask:0xf bank_mask:0xf
    v_mfma_f32_16x16x32_bf16 v[116:119], a[100:103], v[184:187], v[116:119]
    v_mul_f32_dpp v159, v159, v246 row_ror:8 row_mask:0xf bank_mask:0xf
    v_cvt_pk_bf16_f32 v234, v156, v157
    v_mfma_f32_16x16x32_bf16 v[84:87], a[100:103], v[176:179], v[84:87]
    v_cvt_pk_bf16_f32 v235, v158, v159
    v_accvgpr_write_b32 a128, 0
    v_mfma_f32_16x16x32_bf16 v[52:55], a[100:103], v[168:171], v[52:55]
    v_exp_f32 v204, v204
    v_mfma_f32_16x16x32_bf16 v[20:23], a[100:103], v[160:163], v[20:23]
    v_exp_f32 v205, v205
    v_smfmac_f32_16x16x64_bf16 a[112:115], a[132:135], v[160:167], v238
    v_cvt_pk_bf16_f32 v182, v204, v205
    v_mfma_f32_16x16x32_bf16 v[208:211], a[92:95], a[60:63], -4.0
    v_exp_f32 v206, v206
    v_mfma_f32_16x16x32_bf16 v[208:211], a[88:91], a[56:59], v[208:211]
    v_exp_f32 v207, v207
    v_mfma_f32_16x16x32_bf16 v[208:211], a[84:87], a[52:55], v[208:211]
    v_cvt_pk_bf16_f32 v183, v206, v207
    v_accvgpr_write_b32 a129, 0
    v_mfma_f32_16x16x32_bf16 v[208:211], a[80:83], a[48:51], v[208:211]
    v_exp_f32 v200, v200
    v_mfma_f32_16x16x32_bf16 v[212:215], a[80:83], a[64:67], -4.0
    ds_read_b128 a[80:83], v229 offset:49152
    v_max3_f32 v227, v226, v224, v227
    v_mfma_f32_16x16x32_bf16 v[212:215], a[84:87], a[68:71], v[212:215]
    ds_read_b128 a[84:87], v229 offset:49408
    v_mfma_f32_16x16x32_bf16 v[212:215], a[88:91], a[72:75], v[212:215]
    ds_read_b128 a[88:91], v229 offset:49664
    v_mfma_f32_16x16x32_bf16 v[212:215], a[92:95], a[76:79], v[212:215]
    s_waitcnt lgkmcnt(3)
    v_exp_f32 v201, v201
    v_mfma_f32_16x16x32_bf16 v[24:27], a[104:107], v[160:163], v[24:27]
    ds_read_b128 a[92:95], v229 offset:49920
    v_cvt_pk_bf16_f32 v174, v200, v201
    v_mfma_f32_16x16x32_bf16 v[56:59], a[104:107], v[168:171], v[56:59]
    v_exp_f32 v202, v202
    v_mfma_f32_16x16x32_bf16 v[88:91], a[104:107], v[176:179], v[88:91]
    v_exp_f32 v203, v203
    v_mfma_f32_16x16x32_bf16 v[120:123], a[104:107], v[184:187], v[120:123]
    v_cvt_pk_bf16_f32 v175, v202, v203
    v_mfma_f32_16x16x32_bf16 v[152:155], a[104:107], v[192:195], 0
    v_exp_f32 v208, v208
    v_mfma_f32_16x16x32_bf16 v[156:159], a[108:111], v[192:195], 0
    v_exp_f32 v209, v209
    v_mfma_f32_16x16x32_bf16 v[124:127], a[108:111], v[184:187], v[124:127]
    v_exp_f32 v210, v210
    v_mfma_f32_16x16x32_bf16 v[92:95], a[108:111], v[176:179], v[92:95]
    v_exp_f32 v211, v211
    v_mfma_f32_16x16x32_bf16 v[60:63], a[108:111], v[168:171], v[60:63]
    v_cvt_pk_bf16_f32 v190, v208, v209
    v_cvt_pk_bf16_f32 v191, v210, v211
    v_mfma_f32_16x16x32_bf16 v[28:31], a[108:111], v[160:163], v[28:31]
    v_exp_f32 v212, v212
    v_smfmac_f32_16x16x64_bf16 a[120:123], a[132:135], v[176:183], v238
    s_waitcnt lgkmcnt(0)
    v_mfma_f32_16x16x32_bf16 v[200:203], a[80:83], a[0:3], -4.0
    v_exp_f32 v213, v213
    v_mfma_f32_16x16x32_bf16 v[200:203], a[84:87], a[4:7], v[200:203]
    v_exp_f32 v214, v214
    v_mfma_f32_16x16x32_bf16 v[200:203], a[88:91], a[8:11], v[200:203]
    v_exp_f32 v215, v215
    v_mfma_f32_16x16x32_bf16 v[200:203], a[92:95], a[12:15], v[200:203]
    v_cvt_pk_bf16_f32 v198, v212, v213
    v_cvt_pk_bf16_f32 v199, v214, v215
    v_mfma_f32_16x16x32_bf16 v[204:207], a[92:95], a[28:31], -4.0
    s_barrier
    v_mfma_f32_16x16x32_bf16 v[204:207], a[88:91], a[24:27], v[204:207]
    buffer_store_dwordx4 v[240:243], v244, s[16:19], s26 offen nt
    v_mfma_f32_16x16x32_bf16 v[204:207], a[84:87], a[20:23], v[204:207]
    ds_write_b64 v236, a[136:137] offset:49152
    v_mfma_f32_16x16x32_bf16 v[204:207], a[80:83], a[16:19], v[204:207]
    ds_read_b128 a[104:107], v230 offset:57344
    v_cndmask_b32 v240, v216, v232, vcc
    v_mfma_f32_16x16x32_bf16 v[208:211], a[80:83], a[32:35], -4.0
    ds_write_b64 v236, a[138:139] offset:49160
    v_mfma_f32_16x16x32_bf16 v[208:211], a[84:87], a[36:39], v[208:211]
    buffer_store_dwordx4 v[220:223], v245, s[16:19], s26 offen nt
    v_mfma_f32_16x16x32_bf16 v[208:211], a[88:91], a[40:43], v[208:211]
    v_exp_f32 v200, v200
    v_mfma_f32_16x16x32_bf16 v[208:211], a[92:95], a[44:47], v[208:211]
    s_add_u32 s26, s26, 16384
    v_exp_f32 v201, v201
    v_mfma_f32_16x16x32_bf16 v[0:3], v[248:251], v[164:167], v[0:3]
    v_exp_f32 v202, v202
    v_mfma_f32_16x16x32_bf16 v[32:35], v[248:251], v[172:175], v[32:35]
    v_exp_f32 v203, v203
    v_mfma_f32_16x16x32_bf16 v[64:67], v[248:251], v[180:183], v[64:67]
    ds_read_b128 a[108:111], v230 offset:58368
    v_cvt_pk_bf16_f32 v160, v200, v201
    v_mfma_f32_16x16x32_bf16 v[96:99], v[248:251], v[188:191], v[96:99]
    ds_read_b128 a[96:99], v231 offset:57344
    v_cvt_pk_bf16_f32 v161, v202, v203
    v_mfma_f32_16x16x32_bf16 v[128:131], v[248:251], v[196:199], v[128:131]
    ds_write_b64 v236, a[140:141] offset:50176
    v_mfma_f32_16x16x32_bf16 v[132:135], v[252:255], v[196:199], v[132:135]
    v_exp_f32 v204, v204
    v_mfma_f32_16x16x32_bf16 v[100:103], v[252:255], v[188:191], v[100:103]
    v_exp_f32 v205, v205
    v_mfma_f32_16x16x32_bf16 v[68:71], v[252:255], v[180:183], v[68:71]
    v_exp_f32 v206, v206
    v_mfma_f32_16x16x32_bf16 v[36:39], v[252:255], v[172:175], v[36:39]
    v_exp_f32 v207, v207
    v_mfma_f32_16x16x32_bf16 v[4:7], v[252:255], v[164:167], v[4:7]
    ds_read_b128 a[100:103], v231 offset:58368
    v_cvt_pk_bf16_f32 v168, v204, v205
    v_smfmac_f32_16x16x64_bf16 a[128:131], a[132:135], v[192:199], v238
    v_cvt_pk_bf16_f32 v169, v206, v207
    v_mfma_f32_16x16x32_bf16 v[212:215], a[92:95], a[60:63], -4.0
    v_exp_f32 v208, v208
    v_mfma_f32_16x16x32_bf16 v[212:215], a[88:91], a[56:59], v[212:215]
    v_exp_f32 v209, v209
    v_mfma_f32_16x16x32_bf16 v[212:215], a[84:87], a[52:55], v[212:215]
    v_exp_f32 v210, v210
    v_mfma_f32_16x16x32_bf16 v[212:215], a[80:83], a[48:51], v[212:215]
    v_exp_f32 v211, v211
    v_mfma_f32_16x16x32_bf16 v[200:203], a[80:83], a[64:67], -4.0
    ds_read_b128 a[80:83], v229 offset:53248
    v_cvt_pk_bf16_f32 v176, v208, v209
    v_mfma_f32_16x16x32_bf16 v[200:203], a[84:87], a[68:71], v[200:203]
    ds_read_b128 a[84:87], v229 offset:53504
    v_cvt_pk_bf16_f32 v177, v210, v211
    v_mfma_f32_16x16x32_bf16 v[200:203], a[88:91], a[72:75], v[200:203]
    ds_read_b128 a[88:91], v229 offset:53760
    v_cndmask_b32 v241, v217, v233, vcc
    v_mfma_f32_16x16x32_bf16 v[200:203], a[92:95], a[76:79], v[200:203]
    s_waitcnt lgkmcnt(4)
    v_exp_f32 v212, v212
    v_mfma_f32_16x16x32_bf16 v[8:11], a[104:107], v[164:167], v[8:11]
    ds_read_b128 a[92:95], v229 offset:54016
    v_cndmask_b32 v242, v218, v234, vcc
    v_mfma_f32_16x16x32_bf16 v[40:43], a[104:107], v[172:175], v[40:43]
    ds_write_b64 v236, a[142:143] offset:50184
    v_mfma_f32_16x16x32_bf16 v[72:75], a[104:107], v[180:183], v[72:75]
    v_exp_f32 v213, v213
    v_mfma_f32_16x16x32_bf16 v[104:107], a[104:107], v[188:191], v[104:107]
    v_exp_f32 v214, v214
    v_mfma_f32_16x16x32_bf16 v[136:139], a[104:107], v[196:199], v[136:139]
    v_exp_f32 v215, v215
    v_mfma_f32_16x16x32_bf16 v[140:143], a[108:111], v[196:199], v[140:143]
    ds_read_b128 a[104:107], v239 offset:57344
    v_cvt_pk_bf16_f32 v184, v212, v213
    v_mfma_f32_16x16x32_bf16 v[108:111], a[108:111], v[188:191], v[108:111]
    v_cvt_pk_bf16_f32 v185, v214, v215
    v_cndmask_b32 v243, v219, v235, vcc
    v_mfma_f32_16x16x32_bf16 v[76:79], a[108:111], v[180:183], v[76:79]
    buffer_store_dwordx4 v[240:243], v244, s[16:19], s42 offen nt
    v_mfma_f32_16x16x32_bf16 v[44:47], a[108:111], v[172:175], v[44:47]
    ds_write_b64 v236, a[152:153] offset:0
    v_mfma_f32_16x16x32_bf16 v[12:15], a[108:111], v[164:167], v[12:15]
    s_waitcnt lgkmcnt(2)
    v_exp_f32 v200, v200
    v_mfma_f32_16x16x32_bf16 v[204:207], a[80:83], a[0:3], -4.0
    v_exp_f32 v201, v201
    v_mfma_f32_16x16x32_bf16 v[204:207], a[84:87], a[4:7], v[204:207]
    v_exp_f32 v202, v202
    v_mfma_f32_16x16x32_bf16 v[204:207], a[88:91], a[8:11], v[204:207]
    v_exp_f32 v203, v203
    v_mfma_f32_16x16x32_bf16 v[204:207], a[92:95], a[12:15], v[204:207]
    ds_read_b128 a[108:111], v239 offset:58368
    v_cvt_pk_bf16_f32 v192, v200, v201
    v_mfma_f32_16x16x32_bf16 v[208:211], a[92:95], a[28:31], -4.0
    v_cvt_pk_bf16_f32 v193, v202, v203
    v_cndmask_b32 v232, v232, v216, vcc
    v_mfma_f32_16x16x32_bf16 v[208:211], a[88:91], a[24:27], v[208:211]
    ds_write_b64 v236, a[154:155] offset:8
    v_mfma_f32_16x16x32_bf16 v[208:211], a[84:87], a[20:23], v[208:211]
    v_exp_f32 v204, v204
    v_mfma_f32_16x16x32_bf16 v[208:211], a[80:83], a[16:19], v[208:211]
    v_exp_f32 v205, v205
    v_mfma_f32_16x16x32_bf16 v[212:215], a[80:83], a[32:35], -4.0
    v_exp_f32 v206, v206
    v_mfma_f32_16x16x32_bf16 v[212:215], a[84:87], a[36:39], v[212:215]
    v_exp_f32 v207, v207
    v_mfma_f32_16x16x32_bf16 v[212:215], a[88:91], a[40:43], v[212:215]
    v_cvt_pk_bf16_f32 v162, v204, v205
    v_cvt_pk_bf16_f32 v163, v206, v207
    v_mfma_f32_16x16x32_bf16 v[212:215], a[92:95], a[44:47], v[212:215]
    ds_write_b64 v236, a[156:157] offset:1024
    v_mfma_f32_16x16x32_bf16 v[16:19], a[96:99], v[164:167], v[16:19]
    v_exp_f32 v208, v208
    v_mfma_f32_16x16x32_bf16 v[48:51], a[96:99], v[172:175], v[48:51]
    v_exp_f32 v209, v209
    v_mfma_f32_16x16x32_bf16 v[80:83], a[96:99], v[180:183], v[80:83]
    v_exp_f32 v210, v210
    v_mfma_f32_16x16x32_bf16 v[112:115], a[96:99], v[188:191], v[112:115]
    v_exp_f32 v211, v211
    v_mfma_f32_16x16x32_bf16 v[144:147], a[96:99], v[196:199], v[144:147]
    v_cvt_pk_bf16_f32 v170, v208, v209
    v_cvt_pk_bf16_f32 v171, v210, v211
    v_mfma_f32_16x16x32_bf16 v[148:151], a[100:103], v[196:199], v[148:151]
    v_exp_f32 v212, v212
    v_mfma_f32_16x16x32_bf16 v[116:119], a[100:103], v[188:191], v[116:119]
    v_exp_f32 v213, v213
    v_mfma_f32_16x16x32_bf16 v[84:87], a[100:103], v[180:183], v[84:87]
    v_exp_f32 v214, v214
    v_mfma_f32_16x16x32_bf16 v[52:55], a[100:103], v[172:175], v[52:55]
    v_exp_f32 v215, v215
    v_mfma_f32_16x16x32_bf16 v[20:23], a[100:103], v[164:167], v[20:23]
    ds_write_b64 v236, a[158:159] offset:1032
    v_mfma_f32_16x16x32_bf16 v[200:203], a[92:95], a[60:63], -4.0
    v_cvt_pk_bf16_f32 v178, v212, v213
    v_cvt_pk_bf16_f32 v179, v214, v215
    v_mfma_f32_16x16x32_bf16 v[200:203], a[88:91], a[56:59], v[200:203]
    v_cndmask_b32 v233, v233, v217, vcc
    v_cndmask_b32 v234, v234, v218, vcc
    v_mfma_f32_16x16x32_bf16 v[200:203], a[84:87], a[52:55], v[200:203]
    v_cndmask_b32 v235, v235, v219, vcc
    v_mfma_f32_16x16x32_bf16 v[200:203], a[80:83], a[48:51], v[200:203]
    buffer_store_dwordx4 v[232:235], v245, s[16:19], s42 offen nt
    v_mfma_f32_16x16x32_bf16 v[204:207], a[80:83], a[64:67], -4.0
    ds_read_b128 a[80:83], v229 offset:57344
    s_add_u32 s42, s42, 16384
    v_mfma_f32_16x16x32_bf16 v[204:207], a[84:87], a[68:71], v[204:207]
    ds_read_b128 a[84:87], v229 offset:57600
    v_mfma_f32_16x16x32_bf16 v[204:207], a[88:91], a[72:75], v[204:207]
    ds_read_b128 a[88:91], v229 offset:57856
    v_mfma_f32_16x16x32_bf16 v[204:207], a[92:95], a[76:79], v[204:207]
    s_waitcnt lgkmcnt(3)
    v_exp_f32 v200, v200
    v_mfma_f32_16x16x32_bf16 v[24:27], a[104:107], v[164:167], v[24:27]
    ds_read_b128 a[92:95], v229 offset:58112
    v_mfma_f32_16x16x32_bf16 v[56:59], a[104:107], v[172:175], v[56:59]
    v_exp_f32 v201, v201
    v_mfma_f32_16x16x32_bf16 v[88:91], a[104:107], v[180:183], v[88:91]
    v_exp_f32 v202, v202
    v_mfma_f32_16x16x32_bf16 v[120:123], a[104:107], v[188:191], v[120:123]
    v_exp_f32 v203, v203
    v_mfma_f32_16x16x32_bf16 v[152:155], a[104:107], v[196:199], v[152:155]
    v_cvt_pk_bf16_f32 v186, v200, v201
    v_cvt_pk_bf16_f32 v187, v202, v203
    v_mfma_f32_16x16x32_bf16 v[156:159], a[108:111], v[196:199], v[156:159]
    v_exp_f32 v204, v204
    v_mfma_f32_16x16x32_bf16 v[124:127], a[108:111], v[188:191], v[124:127]
    v_exp_f32 v205, v205
    v_mfma_f32_16x16x32_bf16 v[92:95], a[108:111], v[180:183], v[92:95]
    v_exp_f32 v206, v206
    v_mfma_f32_16x16x32_bf16 v[60:63], a[108:111], v[172:175], v[60:63]
    v_exp_f32 v207, v207
    v_mfma_f32_16x16x32_bf16 v[28:31], a[108:111], v[164:167], v[28:31]
    v_cvt_pk_bf16_f32 v194, v204, v205
    v_cvt_pk_bf16_f32 v195, v206, v207
    v_smfmac_f32_16x16x64_bf16 a[116:119], a[132:135], v[168:175], v238
    s_waitcnt lgkmcnt(0)
    v_mfma_f32_16x16x32_bf16 v[208:211], a[80:83], a[0:3], -4.0
    s_barrier
    v_mfma_f32_16x16x32_bf16 v[208:211], a[84:87], a[4:7], v[208:211]
    ds_write_b64 v236, a[144:145] offset:57344
    v_mfma_f32_16x16x32_bf16 v[208:211], a[88:91], a[8:11], v[208:211]
    ds_read_b128 a[104:107], v230 offset:49152
    v_mfma_f32_16x16x32_bf16 v[208:211], a[92:95], a[12:15], v[208:211]
    ds_write_b64 v236, a[146:147] offset:57352
    v_mfma_f32_16x16x32_bf16 v[212:215], a[92:95], a[28:31], -4.0
    ds_read_b128 a[108:111], v230 offset:50176
    v_mfma_f32_16x16x32_bf16 v[212:215], a[88:91], a[24:27], v[212:215]
    ds_write_b64 v236, a[148:149] offset:58368
    v_mfma_f32_16x16x32_bf16 v[212:215], a[84:87], a[20:23], v[212:215]
    ds_read_b128 a[96:99], v231 offset:49152
    v_mfma_f32_16x16x32_bf16 v[212:215], a[80:83], a[16:19], v[212:215]
    v_exp_f32 v208, v208
    v_mfma_f32_16x16x32_bf16 v[200:203], a[80:83], a[32:35], -4.0
    v_exp_f32 v209, v209
    v_mfma_f32_16x16x32_bf16 v[200:203], a[84:87], a[36:39], v[200:203]
    v_exp_f32 v210, v210
    v_mfma_f32_16x16x32_bf16 v[200:203], a[88:91], a[40:43], v[200:203]
    v_exp_f32 v211, v211
    v_mfma_f32_16x16x32_bf16 v[200:203], a[92:95], a[44:47], v[200:203]
    ds_read_b128 a[100:103], v231 offset:50176
    v_cvt_pk_bf16_f32 v164, v208, v209
    v_mfma_f32_16x16x32_bf16 v[0:3], a[136:139], v[160:163], v[0:3]
    v_cvt_pk_bf16_f32 v165, v210, v211
    v_mfma_f32_16x16x32_bf16 v[32:35], a[136:139], v[168:171], v[32:35]
    v_exp_f32 v212, v212
    v_mfma_f32_16x16x32_bf16 v[64:67], a[136:139], v[176:179], v[64:67]
    v_exp_f32 v213, v213
    v_mfma_f32_16x16x32_bf16 v[96:99], a[136:139], v[184:187], v[96:99]
    v_exp_f32 v214, v214
    v_mfma_f32_16x16x32_bf16 v[128:131], a[136:139], v[192:195], v[128:131]
    v_exp_f32 v215, v215
    v_mfma_f32_16x16x32_bf16 v[132:135], a[140:143], v[192:195], v[132:135]
    v_cvt_pk_bf16_f32 v172, v212, v213
    v_cvt_pk_bf16_f32 v173, v214, v215
    v_mfma_f32_16x16x32_bf16 v[100:103], a[140:143], v[184:187], v[100:103]
    ds_write_b64 v236, a[150:151] offset:58376
    v_mfma_f32_16x16x32_bf16 v[68:71], a[140:143], v[176:179], v[68:71]
    v_exp_f32 v200, v200
    v_mfma_f32_16x16x32_bf16 v[36:39], a[140:143], v[168:171], v[36:39]
    v_exp_f32 v201, v201
    v_mfma_f32_16x16x32_bf16 v[4:7], a[140:143], v[160:163], v[4:7]
    v_exp_f32 v202, v202
    v_smfmac_f32_16x16x64_bf16 a[124:127], a[132:135], v[184:191], v238
    v_cvt_pk_bf16_f32 v180, v200, v201
    v_mfma_f32_16x16x32_bf16 v[204:207], a[92:95], a[60:63], -4.0
    v_exp_f32 v203, v203
    v_mfma_f32_16x16x32_bf16 v[204:207], a[88:91], a[56:59], v[204:207]
    v_cvt_pk_bf16_f32 v181, v202, v203
    v_mfma_f32_16x16x32_bf16 v[204:207], a[84:87], a[52:55], v[204:207]
    ds_write_b64 v236, a[160:161] offset:8192
    v_mfma_f32_16x16x32_bf16 v[204:207], a[80:83], a[48:51], v[204:207]
    v_mfma_f32_16x16x32_bf16 v[208:211], a[80:83], a[64:67], -4.0
    ds_read_b128 a[80:83], v229 offset:61440
    v_mfma_f32_16x16x32_bf16 v[208:211], a[84:87], a[68:71], v[208:211]
    ds_read_b128 a[84:87], v229 offset:61696
    v_mfma_f32_16x16x32_bf16 v[208:211], a[88:91], a[72:75], v[208:211]
    ds_read_b128 a[88:91], v229 offset:61952
    v_mfma_f32_16x16x32_bf16 v[208:211], a[92:95], a[76:79], v[208:211]
    s_waitcnt lgkmcnt(4)
    v_exp_f32 v204, v204
    v_mfma_f32_16x16x32_bf16 v[8:11], a[104:107], v[160:163], v[8:11]
    ds_read_b128 a[92:95], v229 offset:62208
    v_mfma_f32_16x16x32_bf16 v[40:43], a[104:107], v[168:171], v[40:43]
    v_exp_f32 v205, v205
    v_mfma_f32_16x16x32_bf16 v[72:75], a[104:107], v[176:179], v[72:75]
    v_exp_f32 v206, v206
    v_mfma_f32_16x16x32_bf16 v[104:107], a[104:107], v[184:187], v[104:107]
    v_exp_f32 v207, v207
    v_mfma_f32_16x16x32_bf16 v[136:139], a[104:107], v[192:195], v[136:139]
    ds_read_b128 a[104:107], v239 offset:49152
    v_cvt_pk_bf16_f32 v188, v204, v205
    v_mfma_f32_16x16x32_bf16 v[140:143], a[108:111], v[192:195], v[140:143]
    v_cvt_pk_bf16_f32 v189, v206, v207
    v_mfma_f32_16x16x32_bf16 v[108:111], a[108:111], v[184:187], v[108:111]
    ds_write_b64 v236, a[162:163] offset:8200
    v_mfma_f32_16x16x32_bf16 v[76:79], a[108:111], v[176:179], v[76:79]
    v_exp_f32 v208, v208
    v_mfma_f32_16x16x32_bf16 v[44:47], a[108:111], v[168:171], v[44:47]
    v_exp_f32 v209, v209
    v_mfma_f32_16x16x32_bf16 v[12:15], a[108:111], v[160:163], v[12:15]
    s_waitcnt lgkmcnt(2)
    v_exp_f32 v210, v210
    v_mfma_f32_16x16x32_bf16 v[212:215], a[80:83], a[0:3], -4.0
    v_exp_f32 v211, v211
    v_mfma_f32_16x16x32_bf16 v[212:215], a[84:87], a[4:7], v[212:215]
    ds_read_b128 a[108:111], v239 offset:50176
    v_cvt_pk_bf16_f32 v196, v208, v209
    v_mfma_f32_16x16x32_bf16 v[212:215], a[88:91], a[8:11], v[212:215]
    v_cvt_pk_bf16_f32 v197, v210, v211
    v_mfma_f32_16x16x32_bf16 v[212:215], a[92:95], a[12:15], v[212:215]
    ds_write_b64 v236, a[164:165] offset:9216
    v_mfma_f32_16x16x32_bf16 v[200:203], a[92:95], a[28:31], -4.0
    v_mfma_f32_16x16x32_bf16 v[200:203], a[88:91], a[24:27], v[200:203]
    ds_write_b64 v236, a[166:167] offset:9224
    v_mfma_f32_16x16x32_bf16 v[200:203], a[84:87], a[20:23], v[200:203]
    v_mfma_f32_16x16x32_bf16 v[200:203], a[80:83], a[16:19], v[200:203]
    v_mfma_f32_16x16x32_bf16 v[204:207], a[80:83], a[32:35], -4.0
    v_mfma_f32_16x16x32_bf16 v[204:207], a[84:87], a[36:39], v[204:207]
    v_exp_f32 v212, v212
    v_mfma_f32_16x16x32_bf16 v[204:207], a[88:91], a[40:43], v[204:207]
    v_exp_f32 v213, v213
    v_mfma_f32_16x16x32_bf16 v[204:207], a[92:95], a[44:47], v[204:207]
    v_exp_f32 v214, v214
    v_mfma_f32_16x16x32_bf16 v[16:19], a[96:99], v[160:163], v[16:19]
    v_exp_f32 v215, v215
    v_mfma_f32_16x16x32_bf16 v[48:51], a[96:99], v[168:171], v[48:51]
    v_cvt_pk_bf16_f32 v166, v212, v213
    v_cvt_pk_bf16_f32 v167, v214, v215
    v_mfma_f32_16x16x32_bf16 v[80:83], a[96:99], v[176:179], v[80:83]
    v_exp_f32 v200, v200
    v_mfma_f32_16x16x32_bf16 v[112:115], a[96:99], v[184:187], v[112:115]
    v_exp_f32 v204, v204
    v_mfma_f32_16x16x32_bf16 v[144:147], a[96:99], v[192:195], v[144:147]
    v_exp_f32 v205, v205
    v_mfma_f32_16x16x32_bf16 v[148:151], a[100:103], v[192:195], v[148:151]
    v_exp_f32 v206, v206
    v_mfma_f32_16x16x32_bf16 v[116:119], a[100:103], v[184:187], v[116:119]
    v_exp_f32 v207, v207
    v_mfma_f32_16x16x32_bf16 v[84:87], a[100:103], v[176:179], v[84:87]
    v_cvt_pk_bf16_f32 v182, v204, v205
    v_cvt_pk_bf16_f32 v183, v206, v207
    v_mfma_f32_16x16x32_bf16 v[52:55], a[100:103], v[168:171], v[52:55]
    v_exp_f32 v201, v201
    v_mfma_f32_16x16x32_bf16 v[20:23], a[100:103], v[160:163], v[20:23]
    v_exp_f32 v202, v202
    v_smfmac_f32_16x16x64_bf16 a[112:115], a[132:135], v[160:167], v238
    v_cvt_pk_bf16_f32 v174, v200, v201
    v_mfma_f32_16x16x32_bf16 v[208:211], a[92:95], a[60:63], -4.0
    v_exp_f32 v203, v203
    v_mfma_f32_16x16x32_bf16 v[208:211], a[88:91], a[56:59], v[208:211]
    v_cvt_pk_bf16_f32 v175, v202, v203
    v_mfma_f32_16x16x32_bf16 v[208:211], a[84:87], a[52:55], v[208:211]
    s_waitcnt lgkmcnt(0)
    v_mfma_f32_16x16x32_bf16 v[208:211], a[80:83], a[48:51], v[208:211]
    v_accvgpr_read_b32 v224, a112
    v_accvgpr_read_b32 v226, a113
    v_mfma_f32_16x16x32_bf16 v[212:215], a[80:83], a[64:67], -4.0
    ds_read_b128 a[80:83], v228 offset:0
    v_add_f32 v226, v226, v224
    v_mfma_f32_16x16x32_bf16 v[212:215], a[84:87], a[68:71], v[212:215]
    v_rcp_f32 v224, v226
    v_mfma_f32_16x16x32_bf16 v[212:215], a[88:91], a[72:75], v[212:215]
    ds_read_b128 a[84:87], v228 offset:256
    v_mov_b32_dpp v246, v224 row_ror:8 row_mask:0xf bank_mask:0xf
    v_mfma_f32_16x16x32_bf16 v[212:215], a[92:95], a[76:79], v[212:215]
    ds_read_b128 a[88:91], v228 offset:512
    v_max3_f32 v227, v226, v224, v227
    v_mfma_f32_16x16x32_bf16 v[24:27], a[104:107], v[160:163], v[24:27]
    ds_read_b128 a[92:95], v228 offset:768
    v_mfma_f32_16x16x32_bf16 v[56:59], a[104:107], v[168:171], v[56:59]
    v_exp_f32 v208, v208
    v_mfma_f32_16x16x32_bf16 v[88:91], a[104:107], v[176:179], v[88:91]
    v_exp_f32 v209, v209
    v_mfma_f32_16x16x32_bf16 v[120:123], a[104:107], v[184:187], v[120:123]
    v_exp_f32 v212, v212
    v_mfma_f32_16x16x32_bf16 v[152:155], a[104:107], v[192:195], v[152:155]
    v_exp_f32 v213, v213
    v_mfma_f32_16x16x32_bf16 v[156:159], a[108:111], v[192:195], v[156:159]
    v_exp_f32 v214, v214
    v_mfma_f32_16x16x32_bf16 v[124:127], a[108:111], v[184:187], v[124:127]
    v_exp_f32 v215, v215
    v_mfma_f32_16x16x32_bf16 v[92:95], a[108:111], v[176:179], v[92:95]
    v_cvt_pk_bf16_f32 v198, v212, v213
    v_cvt_pk_bf16_f32 v199, v214, v215
    v_mfma_f32_16x16x32_bf16 v[60:63], a[108:111], v[168:171], v[60:63]
    v_exp_f32 v210, v210
    v_mfma_f32_16x16x32_bf16 v[28:31], a[108:111], v[160:163], v[28:31]
    v_exp_f32 v211, v211
    v_smfmac_f32_16x16x64_bf16 a[120:123], a[132:135], v[176:183], v238
    s_waitcnt lgkmcnt(0)
    v_cvt_pk_bf16_f32 v190, v208, v209
    v_mfma_f32_16x16x32_bf16 v[200:203], a[80:83], a[16:19], -4.0
    v_cvt_pk_bf16_f32 v191, v210, v211
    v_mfma_f32_16x16x32_bf16 v[200:203], a[84:87], a[20:23], v[200:203]
    s_barrier
    v_mfma_f32_16x16x32_bf16 v[200:203], a[88:91], a[24:27], v[200:203]
    ds_write_b128 v236, a[168:171] offset:16384
    v_mfma_f32_16x16x32_bf16 v[200:203], a[92:95], a[28:31], v[200:203]
    v_mfma_f32_16x16x32_bf16 v[0:3], a[144:147], v[164:167], v[0:3]
    v_mfma_f32_16x16x32_bf16 v[32:35], a[144:147], v[172:175], v[32:35]
    ds_read_b128 a[104:107], v230 offset:57344
    v_smfmac_f32_16x16x64_bf16 a[128:131], a[132:135], v[192:199], v238
    ds_write_b128 v236, a[172:175] offset:17408
    v_mfma_f32_16x16x32_bf16 v[204:207], a[80:83], a[32:35], -4.0
    v_mfma_f32_16x16x32_bf16 v[204:207], a[84:87], a[36:39], v[204:207]
    v_mfma_f32_16x16x32_bf16 v[204:207], a[88:91], a[40:43], v[204:207]
    ds_read_b128 a[108:111], v230 offset:58368
    v_mul_f32 v0, v0, v224
    v_mfma_f32_16x16x32_bf16 v[204:207], a[92:95], a[44:47], v[204:207]
    ds_read_b128 a[96:99], v231 offset:57344
    v_mul_f32 v1, v1, v224
    v_mfma_f32_16x16x32_bf16 v[64:67], a[144:147], v[180:183], v[64:67]
    ds_write_b128 v236, a[176:179] offset:24576
    v_mfma_f32_16x16x32_bf16 v[96:99], a[144:147], v[188:191], v[96:99]
    v_exp_f32 v200, v200
    v_mfma_f32_16x16x32_bf16 v[128:131], a[144:147], v[196:199], v[128:131]
    v_exp_f32 v201, v201
    v_mfma_f32_16x16x32_bf16 v[208:211], a[80:83], a[48:51], -4.0
    v_exp_f32 v202, v202
    v_mfma_f32_16x16x32_bf16 v[208:211], a[84:87], a[52:55], v[208:211]
    v_exp_f32 v203, v203
    v_mfma_f32_16x16x32_bf16 v[208:211], a[88:91], a[56:59], v[208:211]
    ds_read_b128 a[100:103], v231 offset:58368
    v_cvt_pk_bf16_f32 v168, v200, v201
    v_mfma_f32_16x16x32_bf16 v[208:211], a[92:95], a[60:63], v[208:211]
    v_cvt_pk_bf16_f32 v169, v202, v203
    v_mul_f32 v2, v2, v224
    v_mfma_f32_16x16x32_bf16 v[132:135], a[148:151], v[196:199], v[132:135]
    v_exp_f32 v204, v204
    v_mfma_f32_16x16x32_bf16 v[100:103], a[148:151], v[188:191], v[100:103]
    v_exp_f32 v205, v205
    v_mfma_f32_16x16x32_bf16 v[68:71], a[148:151], v[180:183], v[68:71]
    v_exp_f32 v206, v206
    v_mfma_f32_16x16x32_bf16 v[212:215], a[80:83], a[64:67], -4.0
    ds_read_b128 a[80:83], v228 offset:4096
    v_cvt_pk_bf16_f32 v176, v204, v205
    v_mfma_f32_16x16x32_bf16 v[212:215], a[84:87], a[68:71], v[212:215]
    ds_read_b128 a[84:87], v228 offset:4352
    v_mul_f32 v3, v3, v224
    v_mfma_f32_16x16x32_bf16 v[212:215], a[88:91], a[72:75], v[212:215]
    ds_read_b128 a[88:91], v228 offset:4608
    v_cvt_pk_bf16_f32 v216, v0, v1
    v_mfma_f32_16x16x32_bf16 v[212:215], a[92:95], a[76:79], v[212:215]
    ds_read_b128 a[92:95], v228 offset:4864
    v_cvt_pk_bf16_f32 v217, v2, v3
    v_mfma_f32_16x16x32_bf16 v[36:39], a[148:151], v[172:175], v[36:39]
    v_exp_f32 v207, v207
    v_mfma_f32_16x16x32_bf16 v[4:7], a[148:151], v[164:167], v[4:7]
    s_waitcnt lgkmcnt(4)
    v_cvt_pk_bf16_f32 v177, v206, v207
    v_mfma_f32_16x16x32_bf16 v[8:11], a[104:107], v[164:167], v[8:11]
    ds_write_b128 v236, a[180:183] offset:25600
    v_mfma_f32_16x16x32_bf16 v[40:43], a[104:107], v[172:175], v[40:43]
    v_exp_f32 v208, v208
    v_mfma_f32_16x16x32_bf16 v[72:75], a[104:107], v[180:183], v[72:75]
    v_exp_f32 v209, v209
    v_mfma_f32_16x16x32_bf16 v[104:107], a[104:107], v[188:191], v[104:107]
    v_exp_f32 v210, v210
    v_mfma_f32_16x16x32_bf16 v[136:139], a[104:107], v[196:199], v[136:139]
    v_exp_f32 v211, v211
    v_mfma_f32_16x16x32_bf16 v[140:143], a[108:111], v[196:199], v[140:143]
    ds_read_b128 a[104:107], v239 offset:57344
    v_cvt_pk_bf16_f32 v184, v208, v209
    v_mfma_f32_16x16x32_bf16 v[108:111], a[108:111], v[188:191], v[108:111]
    v_cvt_pk_bf16_f32 v185, v210, v211
    v_mul_f32 v4, v4, v224
    v_mfma_f32_16x16x32_bf16 v[76:79], a[108:111], v[180:183], v[76:79]
    ds_write_b128 v236, a[184:187] offset:49152
    v_mfma_f32_16x16x32_bf16 v[44:47], a[108:111], v[172:175], v[44:47]
    v_exp_f32 v212, v212
    v_mfma_f32_16x16x32_bf16 v[12:15], a[108:111], v[164:167], v[12:15]
    s_waitcnt lgkmcnt(2)
    v_exp_f32 v213, v213
    v_mfma_f32_16x16x32_bf16 v[200:203], a[80:83], a[16:19], -4.0
    v_exp_f32 v214, v214
    v_mfma_f32_16x16x32_bf16 v[200:203], a[84:87], a[20:23], v[200:203]
    v_exp_f32 v215, v215
    v_mfma_f32_16x16x32_bf16 v[200:203], a[88:91], a[24:27], v[200:203]
    ds_read_b128 a[108:111], v239 offset:58368
    v_cvt_pk_bf16_f32 v192, v212, v213
    v_mfma_f32_16x16x32_bf16 v[200:203], a[92:95], a[28:31], v[200:203]
    v_cvt_pk_bf16_f32 v193, v214, v215
    v_mul_f32 v5, v5, v224
    v_mfma_f32_16x16x32_bf16 v[16:19], a[96:99], v[164:167], v[16:19]
    ds_write_b128 v236, a[188:191] offset:50176
    v_mfma_f32_16x16x32_bf16 v[48:51], a[96:99], v[172:175], v[48:51]
    v_mul_f32 v6, v6, v224
    v_mul_f32 v7, v7, v224
    v_mfma_f32_16x16x32_bf16 v[204:207], a[80:83], a[32:35], -4.0
    v_exp_f32 v200, v200
    v_mfma_f32_16x16x32_bf16 v[204:207], a[84:87], a[36:39], v[204:207]
    v_exp_f32 v201, v201
    v_mfma_f32_16x16x32_bf16 v[204:207], a[88:91], a[40:43], v[204:207]
    v_exp_f32 v202, v202
    v_mfma_f32_16x16x32_bf16 v[204:207], a[92:95], a[44:47], v[204:207]
    v_exp_f32 v203, v203
    v_mfma_f32_16x16x32_bf16 v[80:83], a[96:99], v[180:183], v[80:83]
    v_cvt_pk_bf16_f32 v170, v200, v201
    v_cvt_pk_bf16_f32 v171, v202, v203
    v_mfma_f32_16x16x32_bf16 v[112:115], a[96:99], v[188:191], v[112:115]
    v_mul_f32_dpp v8, v8, v246 row_ror:8 row_mask:0xf bank_mask:0xf
    v_mul_f32_dpp v9, v9, v246 row_ror:8 row_mask:0xf bank_mask:0xf
    v_mfma_f32_16x16x32_bf16 v[144:147], a[96:99], v[196:199], v[144:147]
    ds_read_b128 a[96:99], v236 offset:32768
    v_mul_f32_dpp v10, v10, v246 row_ror:8 row_mask:0xf bank_mask:0xf
    v_mfma_f32_16x16x32_bf16 v[208:211], a[80:83], a[48:51], -4.0
    v_exp_f32 v204, v204
    v_mfma_f32_16x16x32_bf16 v[208:211], a[84:87], a[52:55], v[208:211]
    v_exp_f32 v205, v205
    v_mfma_f32_16x16x32_bf16 v[208:211], a[88:91], a[56:59], v[208:211]
    v_exp_f32 v206, v206
    v_mfma_f32_16x16x32_bf16 v[208:211], a[92:95], a[60:63], v[208:211]
    v_exp_f32 v207, v207
    v_mfma_f32_16x16x32_bf16 v[148:151], a[100:103], v[196:199], v[148:151]
    v_cvt_pk_bf16_f32 v178, v204, v205
    v_cvt_pk_bf16_f32 v179, v206, v207
    v_mfma_f32_16x16x32_bf16 v[116:119], a[100:103], v[188:191], v[116:119]
    v_mul_f32_dpp v11, v11, v246 row_ror:8 row_mask:0xf bank_mask:0xf
    v_mul_f32_dpp v12, v12, v246 row_ror:8 row_mask:0xf bank_mask:0xf
    v_mfma_f32_16x16x32_bf16 v[84:87], a[100:103], v[180:183], v[84:87]
    v_exp_f32 v208, v208
    v_smfmac_f32_16x16x64_bf16 a[116:119], a[132:135], v[168:175], v238
    v_mul_f32_dpp v13, v13, v246 row_ror:8 row_mask:0xf bank_mask:0xf
    v_mfma_f32_16x16x32_bf16 v[212:215], a[80:83], a[64:67], -4.0
    ds_read_b128 a[80:83], v228 offset:8192
    v_mul_f32_dpp v14, v14, v246 row_ror:8 row_mask:0xf bank_mask:0xf
    v_mfma_f32_16x16x32_bf16 v[212:215], a[84:87], a[68:71], v[212:215]
    ds_read_b128 a[84:87], v228 offset:8448
    v_mul_f32_dpp v15, v15, v246 row_ror:8 row_mask:0xf bank_mask:0xf
    v_mfma_f32_16x16x32_bf16 v[212:215], a[88:91], a[72:75], v[212:215]
    ds_read_b128 a[88:91], v228 offset:8704
    v_cvt_pk_bf16_f32 v218, v4, v5
    v_mfma_f32_16x16x32_bf16 v[212:215], a[92:95], a[76:79], v[212:215]
    ds_read_b128 a[92:95], v228 offset:8960
    v_cvt_pk_bf16_f32 v219, v6, v7
    v_mfma_f32_16x16x32_bf16 v[52:55], a[100:103], v[172:175], v[52:55]
    v_exp_f32 v209, v209
    v_mfma_f32_16x16x32_bf16 v[20:23], a[100:103], v[164:167], v[20:23]
    s_waitcnt lgkmcnt(4)
    v_exp_f32 v210, v210
    v_mfma_f32_16x16x32_bf16 v[24:27], a[104:107], v[164:167], v[24:27]
    v_exp_f32 v211, v211
    v_mfma_f32_16x16x32_bf16 v[56:59], a[104:107], v[172:175], v[56:59]
    ds_read_b128 a[100:103], v236 offset:33792
    v_cvt_pk_bf16_f32 v186, v208, v209
    v_mfma_f32_16x16x32_bf16 v[88:91], a[104:107], v[180:183], v[88:91]
    v_cvt_pk_bf16_f32 v187, v210, v211
    v_cvt_pk_bf16_f32 v220, v8, v9
    v_mfma_f32_16x16x32_bf16 v[120:123], a[104:107], v[188:191], v[120:123]
    v_exp_f32 v212, v212
    v_mfma_f32_16x16x32_bf16 v[152:155], a[104:107], v[196:199], v[152:155]
    v_exp_f32 v213, v213
    v_mfma_f32_16x16x32_bf16 v[156:159], a[108:111], v[196:199], v[156:159]
    v_exp_f32 v214, v214
    v_mfma_f32_16x16x32_bf16 v[124:127], a[108:111], v[188:191], v[124:127]
    v_exp_f32 v215, v215
    v_mfma_f32_16x16x32_bf16 v[92:95], a[108:111], v[180:183], v[92:95]
    ds_read_b128 a[104:107], v230 offset:32768
    v_cvt_pk_bf16_f32 v194, v212, v213
    v_mfma_f32_16x16x32_bf16 v[60:63], a[108:111], v[172:175], v[60:63]
    v_cvt_pk_bf16_f32 v195, v214, v215
    v_cvt_pk_bf16_f32 v221, v10, v11
    v_mfma_f32_16x16x32_bf16 v[28:31], a[108:111], v[164:167], v[28:31]
    ds_read_b128 a[108:111], v230 offset:33792
    v_cvt_pk_bf16_f32 v222, v12, v13
    v_smfmac_f32_16x16x64_bf16 a[124:127], a[132:135], v[184:191], v238
    s_waitcnt lgkmcnt(3)
    v_cvt_pk_bf16_f32 v223, v14, v15
    v_mfma_f32_16x16x32_bf16 v[200:203], a[80:83], a[16:19], -4.0
    v_cndmask_b32 v240, v216, v220, vcc
    v_cndmask_b32 v241, v217, v221, vcc
    v_mfma_f32_16x16x32_bf16 v[200:203], a[84:87], a[20:23], v[200:203]
    v_cndmask_b32 v242, v218, v222, vcc
    v_cndmask_b32 v243, v219, v223, vcc
    v_mfma_f32_16x16x32_bf16 v[200:203], a[88:91], a[24:27], v[200:203]
    buffer_store_dwordx4 v[240:243], v244, s[16:19], s26 offen nt
    v_mfma_f32_16x16x32_bf16 v[200:203], a[92:95], a[28:31], v[200:203]
    v_cndmask_b32 v220, v220, v216, vcc
    v_cndmask_b32 v221, v221, v217, vcc
    v_mfma_f32_16x16x32_bf16 v[32:35], a[96:99], v[168:171], v[32:35]
    v_cndmask_b32 v222, v222, v218, vcc
    v_cndmask_b32 v223, v223, v219, vcc
    v_mfma_f32_16x16x32_bf16 v[204:207], a[80:83], a[32:35], -4.0
    v_mul_f32 v16, v16, v224
    v_mul_f32 v17, v17, v224
    v_mfma_f32_16x16x32_bf16 v[204:207], a[84:87], a[36:39], v[204:207]
    buffer_store_dwordx4 v[220:223], v245, s[16:19], s26 offen nt
    v_mfma_f32_16x16x32_bf16 v[204:207], a[88:91], a[40:43], v[204:207]
    v_exp_f32 v200, v200
    v_mfma_f32_16x16x32_bf16 v[204:207], a[92:95], a[44:47], v[204:207]
    s_add_u32 s26, s26, 16384
    v_exp_f32 v201, v201
    v_mfma_f32_16x16x32_bf16 v[64:67], a[96:99], v[176:179], v[64:67]
    v_exp_f32 v202, v202
    v_mfma_f32_16x16x32_bf16 v[208:211], a[80:83], a[48:51], -4.0
    v_exp_f32 v203, v203
    v_mfma_f32_16x16x32_bf16 v[208:211], a[84:87], a[52:55], v[208:211]
    v_cvt_pk_bf16_f32 v172, v200, v201
    v_cvt_pk_bf16_f32 v173, v202, v203
    v_mfma_f32_16x16x32_bf16 v[208:211], a[88:91], a[56:59], v[208:211]
    v_exp_f32 v204, v204
    v_mfma_f32_16x16x32_bf16 v[208:211], a[92:95], a[60:63], v[208:211]
    v_exp_f32 v205, v205
    v_mfma_f32_16x16x32_bf16 v[96:99], a[96:99], v[184:187], v[96:99]
    v_exp_f32 v206, v206
    v_mfma_f32_16x16x32_bf16 v[128:131], a[96:99], v[192:195], v[128:131]
    ds_read_b128 a[96:99], v231 offset:32768
    v_cvt_pk_bf16_f32 v180, v204, v205
    v_mfma_f32_16x16x32_bf16 v[212:215], a[80:83], a[64:67], -4.0
    ds_read_b128 a[80:83], v228 offset:12288
    v_mul_f32 v18, v18, v224
    v_mfma_f32_16x16x32_bf16 v[212:215], a[84:87], a[68:71], v[212:215]
    ds_read_b128 a[84:87], v228 offset:12544
    v_mul_f32 v19, v19, v224
    v_mfma_f32_16x16x32_bf16 v[212:215], a[88:91], a[72:75], v[212:215]
    ds_read_b128 a[88:91], v228 offset:12800
    v_mul_f32 v20, v20, v224
    v_mfma_f32_16x16x32_bf16 v[212:215], a[92:95], a[76:79], v[212:215]
    s_waitcnt lgkmcnt(4)
    v_exp_f32 v207, v207
    v_mfma_f32_16x16x32_bf16 v[132:135], a[100:103], v[192:195], v[132:135]
    ds_read_b128 a[92:95], v228 offset:13056
    v_cvt_pk_bf16_f32 v181, v206, v207
    v_mfma_f32_16x16x32_bf16 v[100:103], a[100:103], v[184:187], v[100:103]
    v_exp_f32 v208, v208
    v_mfma_f32_16x16x32_bf16 v[68:71], a[100:103], v[176:179], v[68:71]
    v_exp_f32 v209, v209
    v_mfma_f32_16x16x32_bf16 v[36:39], a[100:103], v[168:171], v[36:39]
    v_exp_f32 v210, v210
    v_mfma_f32_16x16x32_bf16 v[40:43], a[104:107], v[168:171], v[40:43]
    v_exp_f32 v211, v211
    v_mfma_f32_16x16x32_bf16 v[72:75], a[104:107], v[176:179], v[72:75]
    ds_read_b128 a[100:103], v231 offset:33792
    v_cvt_pk_bf16_f32 v188, v208, v209
    v_mfma_f32_16x16x32_bf16 v[104:107], a[104:107], v[184:187], v[104:107]
    v_cvt_pk_bf16_f32 v189, v210, v211
    v_mul_f32 v21, v21, v224
    v_mfma_f32_16x16x32_bf16 v[136:139], a[104:107], v[192:195], v[136:139]
    v_exp_f32 v212, v212
    v_mfma_f32_16x16x32_bf16 v[140:143], a[108:111], v[192:195], v[140:143]
    v_exp_f32 v213, v213
    v_mfma_f32_16x16x32_bf16 v[108:111], a[108:111], v[184:187], v[108:111]
    v_exp_f32 v214, v214
    v_mfma_f32_16x16x32_bf16 v[76:79], a[108:111], v[176:179], v[76:79]
    v_exp_f32 v215, v215
    v_mfma_f32_16x16x32_bf16 v[44:47], a[108:111], v[168:171], v[44:47]
    s_waitcnt lgkmcnt(1)
    v_cvt_pk_bf16_f32 v196, v212, v213
    v_cvt_pk_bf16_f32 v197, v214, v215
    v_mfma_f32_16x16x32_bf16 v[200:203], a[80:83], a[16:19], -4.0
    ds_read_b128 a[104:107], v239 offset:32768
    v_mul_f32 v22, v22, v224
    v_mfma_f32_16x16x32_bf16 v[200:203], a[84:87], a[20:23], v[200:203]
    ds_read_b128 a[108:111], v239 offset:33792
    v_mul_f32 v23, v23, v224
    v_mfma_f32_16x16x32_bf16 v[200:203], a[88:91], a[24:27], v[200:203]
    v_mul_f32_dpp v24, v24, v246 row_ror:8 row_mask:0xf bank_mask:0xf
    v_mul_f32_dpp v25, v25, v246 row_ror:8 row_mask:0xf bank_mask:0xf
    v_mfma_f32_16x16x32_bf16 v[200:203], a[92:95], a[28:31], v[200:203]
    v_mul_f32_dpp v26, v26, v246 row_ror:8 row_mask:0xf bank_mask:0xf
    v_mul_f32_dpp v27, v27, v246 row_ror:8 row_mask:0xf bank_mask:0xf
    v_mfma_f32_16x16x32_bf16 v[48:51], a[96:99], v[168:171], v[48:51]
    v_mul_f32_dpp v28, v28, v246 row_ror:8 row_mask:0xf bank_mask:0xf
    v_mul_f32_dpp v29, v29, v246 row_ror:8 row_mask:0xf bank_mask:0xf
    v_mfma_f32_16x16x32_bf16 v[204:207], a[80:83], a[32:35], -4.0
    v_mul_f32_dpp v30, v30, v246 row_ror:8 row_mask:0xf bank_mask:0xf
    v_mul_f32_dpp v31, v31, v246 row_ror:8 row_mask:0xf bank_mask:0xf
    v_mfma_f32_16x16x32_bf16 v[204:207], a[84:87], a[36:39], v[204:207]
    v_cvt_pk_bf16_f32 v216, v16, v17
    v_cvt_pk_bf16_f32 v217, v18, v19
    v_mfma_f32_16x16x32_bf16 v[204:207], a[88:91], a[40:43], v[204:207]
    v_cvt_pk_bf16_f32 v218, v20, v21
    v_cvt_pk_bf16_f32 v219, v22, v23
    v_mfma_f32_16x16x32_bf16 v[204:207], a[92:95], a[44:47], v[204:207]
    v_cvt_pk_bf16_f32 v220, v24, v25
    v_cvt_pk_bf16_f32 v221, v26, v27
    v_mfma_f32_16x16x32_bf16 v[80:83], a[96:99], v[176:179], v[80:83]
    v_cvt_pk_bf16_f32 v222, v28, v29
    v_cvt_pk_bf16_f32 v223, v30, v31
    v_mfma_f32_16x16x32_bf16 v[208:211], a[80:83], a[48:51], -4.0
    v_cndmask_b32 v240, v216, v220, vcc
    v_cndmask_b32 v241, v217, v221, vcc
    v_mfma_f32_16x16x32_bf16 v[208:211], a[84:87], a[52:55], v[208:211]
    v_exp_f32 v204, v204
    v_mfma_f32_16x16x32_bf16 v[208:211], a[88:91], a[56:59], v[208:211]
    v_exp_f32 v205, v205
    v_mfma_f32_16x16x32_bf16 v[208:211], a[92:95], a[60:63], v[208:211]
    v_exp_f32 v206, v206
    v_mfma_f32_16x16x32_bf16 v[112:115], a[96:99], v[184:187], v[112:115]
    v_exp_f32 v207, v207
    v_mfma_f32_16x16x32_bf16 v[144:147], a[96:99], v[192:195], v[144:147]
    ds_read_b128 a[96:99], v236 offset:40960
    v_cndmask_b32 v242, v218, v222, vcc
    v_mfma_f32_16x16x32_bf16 v[212:215], a[80:83], a[64:67], -4.0
    ds_read_b128 a[80:83], v228 offset:16384
    v_cndmask_b32 v243, v219, v223, vcc
    v_mfma_f32_16x16x32_bf16 v[212:215], a[84:87], a[68:71], v[212:215]
    buffer_store_dwordx4 v[240:243], v244, s[16:19], s42 offen nt
    v_mfma_f32_16x16x32_bf16 v[212:215], a[88:91], a[72:75], v[212:215]
    ds_read_b128 a[84:87], v228 offset:16640
    v_cvt_pk_bf16_f32 v182, v204, v205
    v_mfma_f32_16x16x32_bf16 v[212:215], a[92:95], a[76:79], v[212:215]
    s_waitcnt lgkmcnt(3)
    v_cvt_pk_bf16_f32 v183, v206, v207
    v_cndmask_b32 v220, v220, v216, vcc
    v_mfma_f32_16x16x32_bf16 v[148:151], a[100:103], v[192:195], v[148:151]
    ds_read_b128 a[88:91], v228 offset:16896
    v_cndmask_b32 v221, v221, v217, vcc
    v_mfma_f32_16x16x32_bf16 v[116:119], a[100:103], v[184:187], v[116:119]
    ds_read_b128 a[92:95], v228 offset:17152
    v_cndmask_b32 v222, v222, v218, vcc
    v_mfma_f32_16x16x32_bf16 v[84:87], a[100:103], v[176:179], v[84:87]
    v_cndmask_b32 v223, v223, v219, vcc
    v_mfma_f32_16x16x32_bf16 v[52:55], a[100:103], v[168:171], v[52:55]
    buffer_store_dwordx4 v[220:223], v245, s[16:19], s42 offen nt
    v_mfma_f32_16x16x32_bf16 v[56:59], a[104:107], v[168:171], v[56:59]
    v_exp_f32 v200, v200
    v_mfma_f32_16x16x32_bf16 v[88:91], a[104:107], v[176:179], v[88:91]
    s_add_u32 s42, s42, 16384
    v_exp_f32 v201, v201
    v_mfma_f32_16x16x32_bf16 v[120:123], a[104:107], v[184:187], v[120:123]
    v_exp_f32 v202, v202
    v_mfma_f32_16x16x32_bf16 v[152:155], a[104:107], v[192:195], v[152:155]
    v_exp_f32 v203, v203
    v_mfma_f32_16x16x32_bf16 v[156:159], a[108:111], v[192:195], v[156:159]
    ds_read_b128 a[100:103], v236 offset:41984
    v_cvt_pk_bf16_f32 v174, v200, v201
    v_mfma_f32_16x16x32_bf16 v[124:127], a[108:111], v[184:187], v[124:127]
    ds_read_b128 a[104:107], v230 offset:40960
    v_cvt_pk_bf16_f32 v175, v202, v203
    v_mfma_f32_16x16x32_bf16 v[92:95], a[108:111], v[176:179], v[92:95]
    v_exp_f32 v212, v212
    v_mfma_f32_16x16x32_bf16 v[60:63], a[108:111], v[168:171], v[60:63]
    v_exp_f32 v213, v213
    v_smfmac_f32_16x16x64_bf16 a[120:123], a[132:135], v[176:183], v238
    s_waitcnt lgkmcnt(2)
    v_cvt_pk_bf16_f32 v198, v212, v213
    v_mfma_f32_16x16x32_bf16 v[200:203], a[80:83], a[16:19], -4.0
    v_exp_f32 v214, v214
    v_mfma_f32_16x16x32_bf16 v[200:203], a[84:87], a[20:23], v[200:203]
    v_exp_f32 v215, v215
    v_mfma_f32_16x16x32_bf16 v[200:203], a[88:91], a[24:27], v[200:203]
    ds_read_b128 a[108:111], v230 offset:41984
    v_cvt_pk_bf16_f32 v199, v214, v215
    v_mfma_f32_16x16x32_bf16 v[200:203], a[92:95], a[28:31], v[200:203]
    v_exp_f32 v208, v208
    v_mfma_f32_16x16x32_bf16 v[32:35], a[96:99], v[172:175], v[32:35]
    v_exp_f32 v209, v209
    v_smfmac_f32_16x16x64_bf16 a[128:131], a[132:135], v[192:199], v238
    v_cvt_pk_bf16_f32 v190, v208, v209
    v_mfma_f32_16x16x32_bf16 v[204:207], a[80:83], a[32:35], -4.0
    v_exp_f32 v210, v210
    v_mfma_f32_16x16x32_bf16 v[204:207], a[84:87], a[36:39], v[204:207]
    v_exp_f32 v211, v211
    v_mfma_f32_16x16x32_bf16 v[204:207], a[88:91], a[40:43], v[204:207]
    v_cvt_pk_bf16_f32 v191, v210, v211
    v_mfma_f32_16x16x32_bf16 v[204:207], a[92:95], a[44:47], v[204:207]
    v_exp_f32 v200, v200
    v_mfma_f32_16x16x32_bf16 v[64:67], a[96:99], v[180:183], v[64:67]
    v_exp_f32 v201, v201
    v_mfma_f32_16x16x32_bf16 v[208:211], a[80:83], a[48:51], -4.0
    v_exp_f32 v202, v202
    v_mfma_f32_16x16x32_bf16 v[208:211], a[84:87], a[52:55], v[208:211]
    v_exp_f32 v203, v203
    v_mfma_f32_16x16x32_bf16 v[208:211], a[88:91], a[56:59], v[208:211]
    v_cvt_pk_bf16_f32 v168, v200, v201
    v_cvt_pk_bf16_f32 v169, v202, v203
    v_mfma_f32_16x16x32_bf16 v[208:211], a[92:95], a[60:63], v[208:211]
    v_exp_f32 v204, v204
    v_mfma_f32_16x16x32_bf16 v[96:99], a[96:99], v[188:191], v[96:99]
    v_exp_f32 v205, v205
    v_mfma_f32_16x16x32_bf16 v[128:131], a[96:99], v[196:199], v[128:131]
    ds_read_b128 a[96:99], v231 offset:40960
    v_cvt_pk_bf16_f32 v176, v204, v205
    v_mfma_f32_16x16x32_bf16 v[212:215], a[80:83], a[64:67], -4.0
    ds_read_b128 a[80:83], v228 offset:20480
    v_mfma_f32_16x16x32_bf16 v[212:215], a[84:87], a[68:71], v[212:215]
    ds_read_b128 a[84:87], v228 offset:20736
    v_mfma_f32_16x16x32_bf16 v[212:215], a[88:91], a[72:75], v[212:215]
    ds_read_b128 a[88:91], v228 offset:20992
    v_mfma_f32_16x16x32_bf16 v[212:215], a[92:95], a[76:79], v[212:215]
    s_waitcnt lgkmcnt(4)
    v_exp_f32 v206, v206
    v_mfma_f32_16x16x32_bf16 v[132:135], a[100:103], v[196:199], v[132:135]
    ds_read_b128 a[92:95], v228 offset:21248
    v_mfma_f32_16x16x32_bf16 v[100:103], a[100:103], v[188:191], v[100:103]
    v_exp_f32 v207, v207
    v_mfma_f32_16x16x32_bf16 v[68:71], a[100:103], v[180:183], v[68:71]
    v_cvt_pk_bf16_f32 v177, v206, v207
    v_mfma_f32_16x16x32_bf16 v[36:39], a[100:103], v[172:175], v[36:39]
    v_exp_f32 v208, v208
    v_mfma_f32_16x16x32_bf16 v[40:43], a[104:107], v[172:175], v[40:43]
    v_exp_f32 v209, v209
    v_mfma_f32_16x16x32_bf16 v[72:75], a[104:107], v[180:183], v[72:75]
    v_exp_f32 v210, v210
    v_mfma_f32_16x16x32_bf16 v[104:107], a[104:107], v[188:191], v[104:107]
    v_exp_f32 v211, v211
    v_mfma_f32_16x16x32_bf16 v[136:139], a[104:107], v[196:199], v[136:139]
    ds_read_b128 a[100:103], v231 offset:41984
    v_cvt_pk_bf16_f32 v184, v208, v209
    v_mfma_f32_16x16x32_bf16 v[140:143], a[108:111], v[196:199], v[140:143]
    ds_read_b128 a[104:107], v239 offset:40960
    v_cvt_pk_bf16_f32 v185, v210, v211
    v_mfma_f32_16x16x32_bf16 v[108:111], a[108:111], v[188:191], v[108:111]
    v_exp_f32 v212, v212
    v_mfma_f32_16x16x32_bf16 v[76:79], a[108:111], v[180:183], v[76:79]
    v_exp_f32 v213, v213
    v_mfma_f32_16x16x32_bf16 v[44:47], a[108:111], v[172:175], v[44:47]
    s_waitcnt lgkmcnt(2)
    v_exp_f32 v214, v214
    v_mfma_f32_16x16x32_bf16 v[200:203], a[80:83], a[16:19], -4.0
    v_exp_f32 v215, v215
    v_mfma_f32_16x16x32_bf16 v[200:203], a[84:87], a[20:23], v[200:203]
    ds_read_b128 a[108:111], v239 offset:41984
    v_cvt_pk_bf16_f32 v192, v212, v213
    v_mfma_f32_16x16x32_bf16 v[200:203], a[88:91], a[24:27], v[200:203]
    v_cvt_pk_bf16_f32 v193, v214, v215
    v_mfma_f32_16x16x32_bf16 v[200:203], a[92:95], a[28:31], v[200:203]
    v_mfma_f32_16x16x32_bf16 v[48:51], a[96:99], v[172:175], v[48:51]
    v_mfma_f32_16x16x32_bf16 v[204:207], a[80:83], a[32:35], -4.0
    v_mfma_f32_16x16x32_bf16 v[204:207], a[84:87], a[36:39], v[204:207]
    v_mfma_f32_16x16x32_bf16 v[204:207], a[88:91], a[40:43], v[204:207]
    v_mfma_f32_16x16x32_bf16 v[204:207], a[92:95], a[44:47], v[204:207]
    v_mfma_f32_16x16x32_bf16 v[80:83], a[96:99], v[180:183], v[80:83]
    s_waitcnt lgkmcnt(0)
    v_mfma_f32_16x16x32_bf16 v[208:211], a[80:83], a[48:51], -4.0
    v_exp_f32 v200, v200
    v_mfma_f32_16x16x32_bf16 v[208:211], a[84:87], a[52:55], v[208:211]
    v_exp_f32 v201, v201
    v_mfma_f32_16x16x32_bf16 v[208:211], a[88:91], a[56:59], v[208:211]
    v_exp_f32 v202, v202
    v_mfma_f32_16x16x32_bf16 v[208:211], a[92:95], a[60:63], v[208:211]
    v_exp_f32 v203, v203
    v_mfma_f32_16x16x32_bf16 v[112:115], a[96:99], v[188:191], v[112:115]
    v_cvt_pk_bf16_f32 v170, v200, v201
    v_cvt_pk_bf16_f32 v171, v202, v203
    v_mfma_f32_16x16x32_bf16 v[144:147], a[96:99], v[196:199], v[144:147]
    v_exp_f32 v204, v204
    v_mfma_f32_16x16x32_bf16 v[212:215], a[80:83], a[64:67], -4.0
    ds_read_b128 a[80:83], v228 offset:24576
    v_mfma_f32_16x16x32_bf16 v[212:215], a[84:87], a[68:71], v[212:215]
    ds_read_b128 a[84:87], v228 offset:24832
    v_mfma_f32_16x16x32_bf16 v[212:215], a[88:91], a[72:75], v[212:215]
    ds_read_b128 a[88:91], v228 offset:25088
    v_mfma_f32_16x16x32_bf16 v[212:215], a[92:95], a[76:79], v[212:215]
    ds_read_b128 a[92:95], v228 offset:25344
    v_mfma_f32_16x16x32_bf16 v[148:151], a[100:103], v[196:199], v[148:151]
    v_exp_f32 v208, v208
    v_mfma_f32_16x16x32_bf16 v[116:119], a[100:103], v[188:191], v[116:119]
    v_exp_f32 v209, v209
    v_mfma_f32_16x16x32_bf16 v[84:87], a[100:103], v[180:183], v[84:87]
    v_exp_f32 v210, v210
    v_mfma_f32_16x16x32_bf16 v[52:55], a[100:103], v[172:175], v[52:55]
    v_exp_f32 v211, v211
    v_mfma_f32_16x16x32_bf16 v[56:59], a[104:107], v[172:175], v[56:59]
    ds_read_b128 a[96:99], v231 offset:0
    v_cvt_pk_bf16_f32 v186, v208, v209
    v_mfma_f32_16x16x32_bf16 v[88:91], a[104:107], v[180:183], v[88:91]
    ds_read_b128 a[100:103], v231 offset:1024
    v_cvt_pk_bf16_f32 v187, v210, v211
    v_mfma_f32_16x16x32_bf16 v[120:123], a[104:107], v[188:191], v[120:123]
    v_exp_f32 v205, v205
    v_mfma_f32_16x16x32_bf16 v[152:155], a[104:107], v[196:199], v[152:155]
    v_exp_f32 v206, v206
    v_mfma_f32_16x16x32_bf16 v[156:159], a[108:111], v[196:199], v[156:159]
    v_exp_f32 v207, v207
    v_mfma_f32_16x16x32_bf16 v[124:127], a[108:111], v[188:191], v[124:127]
    ds_read_b128 a[104:107], v230 offset:0
    v_cvt_pk_bf16_f32 v178, v204, v205
    v_mfma_f32_16x16x32_bf16 v[92:95], a[108:111], v[180:183], v[92:95]
    v_cvt_pk_bf16_f32 v179, v206, v207
    v_mfma_f32_16x16x32_bf16 v[60:63], a[108:111], v[172:175], v[60:63]
    v_exp_f32 v212, v212
    v_smfmac_f32_16x16x64_bf16 a[116:119], a[132:135], v[168:175], v238
    ds_read_b128 a[108:111], v230 offset:1024
    v_smfmac_f32_16x16x64_bf16 a[124:127], a[132:135], v[184:191], v238
    s_waitcnt lgkmcnt(4)
    v_mfma_f32_16x16x32_bf16 v[200:203], a[80:83], a[32:35], -4.0
    v_exp_f32 v213, v213
    v_mfma_f32_16x16x32_bf16 v[200:203], a[84:87], a[36:39], v[200:203]
    v_exp_f32 v214, v214
    v_mfma_f32_16x16x32_bf16 v[200:203], a[88:91], a[40:43], v[200:203]
    v_accvgpr_read_b32 v225, a116
    v_accvgpr_read_b32 v226, a117
    v_mfma_f32_16x16x32_bf16 v[200:203], a[92:95], a[44:47], v[200:203]
    v_add_f32 v226, v226, v225
    v_cvt_pk_bf16_f32 v194, v212, v213
    v_mfma_f32_16x16x32_bf16 v[32:35], a[152:155], v[168:171], v[32:35]
    v_rcp_f32 v225, v226
    v_mfma_f32_16x16x32_bf16 v[64:67], a[152:155], v[176:179], v[64:67]
    v_exp_f32 v215, v215
    v_mfma_f32_16x16x32_bf16 v[204:207], a[80:83], a[48:51], -4.0
    v_cvt_pk_bf16_f32 v195, v214, v215
    v_mov_b32_dpp v246, v225 row_ror:8 row_mask:0xf bank_mask:0xf
    v_mfma_f32_16x16x32_bf16 v[204:207], a[84:87], a[52:55], v[204:207]
    v_exp_f32 v200, v200
    v_mfma_f32_16x16x32_bf16 v[204:207], a[88:91], a[56:59], v[204:207]
    v_exp_f32 v201, v201
    v_mfma_f32_16x16x32_bf16 v[204:207], a[92:95], a[60:63], v[204:207]
    v_exp_f32 v202, v202
    v_mfma_f32_16x16x32_bf16 v[96:99], a[152:155], v[184:187], v[96:99]
    v_exp_f32 v203, v203
    v_mfma_f32_16x16x32_bf16 v[128:131], a[152:155], v[192:195], v[128:131]
    v_cvt_pk_bf16_f32 v180, v200, v201
    v_cvt_pk_bf16_f32 v181, v202, v203
    v_mfma_f32_16x16x32_bf16 v[208:211], a[80:83], a[64:67], -4.0
    ds_read_b128 a[80:83], v228 offset:28672
    v_mul_f32 v32, v32, v225
    v_mfma_f32_16x16x32_bf16 v[208:211], a[84:87], a[68:71], v[208:211]
    ds_read_b128 a[84:87], v228 offset:28928
    v_mul_f32 v33, v33, v225
    v_mfma_f32_16x16x32_bf16 v[208:211], a[88:91], a[72:75], v[208:211]
    ds_read_b128 a[88:91], v228 offset:29184
    v_mul_f32 v34, v34, v225
    v_mfma_f32_16x16x32_bf16 v[208:211], a[92:95], a[76:79], v[208:211]
    ds_read_b128 a[92:95], v228 offset:29440
    v_mul_f32 v35, v35, v225
    v_mfma_f32_16x16x32_bf16 v[132:135], a[156:159], v[192:195], v[132:135]
    v_exp_f32 v204, v204
    v_mfma_f32_16x16x32_bf16 v[100:103], a[156:159], v[184:187], v[100:103]
    v_exp_f32 v205, v205
    v_mfma_f32_16x16x32_bf16 v[68:71], a[156:159], v[176:179], v[68:71]
    v_exp_f32 v206, v206
    v_mfma_f32_16x16x32_bf16 v[36:39], a[156:159], v[168:171], v[36:39]
    s_waitcnt lgkmcnt(4)
    v_exp_f32 v207, v207
    v_mfma_f32_16x16x32_bf16 v[40:43], a[104:107], v[168:171], v[40:43]
    v_cvt_pk_bf16_f32 v188, v204, v205
    v_cvt_pk_bf16_f32 v189, v206, v207
    v_mfma_f32_16x16x32_bf16 v[72:75], a[104:107], v[176:179], v[72:75]
    v_exp_f32 v208, v208
    v_mfma_f32_16x16x32_bf16 v[104:107], a[104:107], v[184:187], v[104:107]
    v_exp_f32 v209, v209
    v_mfma_f32_16x16x32_bf16 v[136:139], a[104:107], v[192:195], v[136:139]
    ds_read_b128 a[104:107], v239 offset:0
    v_cvt_pk_bf16_f32 v196, v208, v209
    v_mfma_f32_16x16x32_bf16 v[140:143], a[108:111], v[192:195], v[140:143]
    v_exp_f32 v210, v210
    v_mfma_f32_16x16x32_bf16 v[108:111], a[108:111], v[184:187], v[108:111]
    v_exp_f32 v211, v211
    v_mfma_f32_16x16x32_bf16 v[76:79], a[108:111], v[176:179], v[76:79]
    v_cvt_pk_bf16_f32 v197, v210, v211
    v_mul_f32 v36, v36, v225
    v_mfma_f32_16x16x32_bf16 v[44:47], a[108:111], v[168:171], v[44:47]
    s_waitcnt lgkmcnt(1)
    v_mul_f32 v37, v37, v225
    v_mul_f32 v38, v38, v225
    v_mfma_f32_16x16x32_bf16 v[212:215], a[80:83], a[32:35], -4.0
    ds_read_b128 a[108:111], v239 offset:1024
    v_mul_f32 v39, v39, v225
    v_mfma_f32_16x16x32_bf16 v[212:215], a[84:87], a[36:39], v[212:215]
    v_mul_f32_dpp v40, v40, v246 row_ror:8 row_mask:0xf bank_mask:0xf
    v_mul_f32_dpp v41, v41, v246 row_ror:8 row_mask:0xf bank_mask:0xf
    v_mfma_f32_16x16x32_bf16 v[212:215], a[88:91], a[40:43], v[212:215]
    v_mul_f32_dpp v42, v42, v246 row_ror:8 row_mask:0xf bank_mask:0xf
    v_mul_f32_dpp v43, v43, v246 row_ror:8 row_mask:0xf bank_mask:0xf
    v_mfma_f32_16x16x32_bf16 v[212:215], a[92:95], a[44:47], v[212:215]
    v_mul_f32_dpp v44, v44, v246 row_ror:8 row_mask:0xf bank_mask:0xf
    v_mul_f32_dpp v45, v45, v246 row_ror:8 row_mask:0xf bank_mask:0xf
    v_mfma_f32_16x16x32_bf16 v[48:51], a[96:99], v[168:171], v[48:51]
    v_mul_f32_dpp v46, v46, v246 row_ror:8 row_mask:0xf bank_mask:0xf
    v_mul_f32_dpp v47, v47, v246 row_ror:8 row_mask:0xf bank_mask:0xf
    v_mfma_f32_16x16x32_bf16 v[80:83], a[96:99], v[176:179], v[80:83]
    v_cvt_pk_bf16_f32 v216, v32, v33
    v_cvt_pk_bf16_f32 v217, v34, v35
    v_mfma_f32_16x16x32_bf16 v[200:203], a[80:83], a[48:51], -4.0
    v_exp_f32 v212, v212
    v_mfma_f32_16x16x32_bf16 v[200:203], a[84:87], a[52:55], v[200:203]
    v_exp_f32 v213, v213
    v_mfma_f32_16x16x32_bf16 v[200:203], a[88:91], a[56:59], v[200:203]
    v_exp_f32 v214, v214
    v_mfma_f32_16x16x32_bf16 v[200:203], a[92:95], a[60:63], v[200:203]
    v_exp_f32 v215, v215
    v_mfma_f32_16x16x32_bf16 v[112:115], a[96:99], v[184:187], v[112:115]
    v_cvt_pk_bf16_f32 v182, v212, v213
    v_cvt_pk_bf16_f32 v183, v214, v215
    v_mfma_f32_16x16x32_bf16 v[144:147], a[96:99], v[192:195], v[144:147]
    ds_read_b128 a[96:99], v231 offset:8192
    v_cvt_pk_bf16_f32 v218, v36, v37
    v_mfma_f32_16x16x32_bf16 v[204:207], a[80:83], a[64:67], -4.0
    ds_read_b128 a[80:83], v228 offset:32768
    v_cvt_pk_bf16_f32 v219, v38, v39
    v_mfma_f32_16x16x32_bf16 v[204:207], a[84:87], a[68:71], v[204:207]
    ds_read_b128 a[84:87], v228 offset:33024
    v_cvt_pk_bf16_f32 v220, v40, v41
    v_mfma_f32_16x16x32_bf16 v[204:207], a[88:91], a[72:75], v[204:207]
    ds_read_b128 a[88:91], v228 offset:33280
    v_cvt_pk_bf16_f32 v221, v42, v43
    v_mfma_f32_16x16x32_bf16 v[204:207], a[92:95], a[76:79], v[204:207]
    ds_read_b128 a[92:95], v228 offset:33536
    v_cvt_pk_bf16_f32 v222, v44, v45
    v_mfma_f32_16x16x32_bf16 v[148:151], a[100:103], v[192:195], v[148:151]
    v_exp_f32 v200, v200
    v_mfma_f32_16x16x32_bf16 v[116:119], a[100:103], v[184:187], v[116:119]
    v_exp_f32 v201, v201
    v_mfma_f32_16x16x32_bf16 v[84:87], a[100:103], v[176:179], v[84:87]
    v_exp_f32 v202, v202
    v_mfma_f32_16x16x32_bf16 v[52:55], a[100:103], v[168:171], v[52:55]
    s_waitcnt lgkmcnt(5)
    v_exp_f32 v204, v204
    v_mfma_f32_16x16x32_bf16 v[56:59], a[104:107], v[168:171], v[56:59]
    v_exp_f32 v205, v205
    v_mfma_f32_16x16x32_bf16 v[88:91], a[104:107], v[176:179], v[88:91]
    v_exp_f32 v206, v206
    v_mfma_f32_16x16x32_bf16 v[120:123], a[104:107], v[184:187], v[120:123]
    v_exp_f32 v207, v207
    v_mfma_f32_16x16x32_bf16 v[152:155], a[104:107], v[192:195], v[152:155]
    ds_read_b128 a[104:107], v230 offset:8192
    v_cvt_pk_bf16_f32 v198, v204, v205
    v_mfma_f32_16x16x32_bf16 v[156:159], a[108:111], v[192:195], v[156:159]
    ds_read_b128 a[100:103], v231 offset:9216
    v_cvt_pk_bf16_f32 v199, v206, v207
    v_mfma_f32_16x16x32_bf16 v[124:127], a[108:111], v[184:187], v[124:127]
    v_exp_f32 v203, v203
    v_mfma_f32_16x16x32_bf16 v[92:95], a[108:111], v[176:179], v[92:95]
    v_cvt_pk_bf16_f32 v190, v200, v201
    v_cvt_pk_bf16_f32 v191, v202, v203
    v_mfma_f32_16x16x32_bf16 v[60:63], a[108:111], v[168:171], v[60:63]
    ds_read_b128 a[108:111], v230 offset:9216
    v_cvt_pk_bf16_f32 v223, v46, v47
    v_smfmac_f32_16x16x64_bf16 a[120:123], a[132:135], v[176:183], v238
    v_cndmask_b32 v240, v216, v220, vcc
    v_smfmac_f32_16x16x64_bf16 a[128:131], a[132:135], v[192:199], v238
    s_waitcnt lgkmcnt(3)
    v_cndmask_b32 v241, v217, v221, vcc
    v_mfma_f32_16x16x32_bf16 v[208:211], a[80:83], a[32:35], -4.0
    v_cndmask_b32 v242, v218, v222, vcc
    v_cndmask_b32 v243, v219, v223, vcc
    v_mfma_f32_16x16x32_bf16 v[208:211], a[84:87], a[36:39], v[208:211]
    buffer_store_dwordx4 v[240:243], v244, s[16:19], s26 offen nt
    v_mfma_f32_16x16x32_bf16 v[208:211], a[88:91], a[40:43], v[208:211]
    v_cndmask_b32 v220, v220, v216, vcc
    v_cndmask_b32 v221, v221, v217, vcc
    v_mfma_f32_16x16x32_bf16 v[208:211], a[92:95], a[44:47], v[208:211]
    v_cndmask_b32 v222, v222, v218, vcc
    v_cndmask_b32 v223, v223, v219, vcc
    v_mfma_f32_16x16x32_bf16 v[212:215], a[92:95], a[60:63], -4.0
    v_mul_f32 v48, v48, v225
    v_mul_f32 v49, v49, v225
    v_mfma_f32_16x16x32_bf16 v[212:215], a[88:91], a[56:59], v[212:215]
    buffer_store_dwordx4 v[220:223], v245, s[16:19], s26 offen nt
    v_mfma_f32_16x16x32_bf16 v[212:215], a[84:87], a[52:55], v[212:215]
    v_exp_f32 v208, v208
    v_mfma_f32_16x16x32_bf16 v[212:215], a[80:83], a[48:51], v[212:215]
    s_add_u32 s26, s26, 16384
    v_exp_f32 v209, v209
    v_mfma_f32_16x16x32_bf16 v[200:203], a[80:83], a[64:67], -4.0
    ds_read_b128 a[80:83], v228 offset:36864
    v_cvt_pk_bf16_f32 v176, v208, v209
    v_mfma_f32_16x16x32_bf16 v[200:203], a[84:87], a[68:71], v[200:203]
    ds_read_b128 a[84:87], v228 offset:37120
    v_mul_f32 v50, v50, v225
    v_mfma_f32_16x16x32_bf16 v[200:203], a[88:91], a[72:75], v[200:203]
    ds_read_b128 a[88:91], v228 offset:37376
    v_mul_f32 v51, v51, v225
    v_mfma_f32_16x16x32_bf16 v[200:203], a[92:95], a[76:79], v[200:203]
    ds_read_b128 a[92:95], v228 offset:37632
    v_mul_f32 v52, v52, v225
    v_mfma_f32_16x16x32_bf16 v[64:67], a[160:163], v[180:183], v[64:67]
    v_exp_f32 v210, v210
    v_mfma_f32_16x16x32_bf16 v[96:99], a[160:163], v[188:191], v[96:99]
    v_exp_f32 v211, v211
    v_mfma_f32_16x16x32_bf16 v[128:131], a[160:163], v[196:199], v[128:131]
    v_cvt_pk_bf16_f32 v177, v210, v211
    v_mul_f32 v53, v53, v225
    v_mfma_f32_16x16x32_bf16 v[132:135], a[164:167], v[196:199], v[132:135]
    v_exp_f32 v212, v212
    v_mfma_f32_16x16x32_bf16 v[100:103], a[164:167], v[188:191], v[100:103]
    v_exp_f32 v213, v213
    v_mfma_f32_16x16x32_bf16 v[68:71], a[164:167], v[180:183], v[68:71]
    s_waitcnt lgkmcnt(4)
    v_exp_f32 v214, v214
    v_mfma_f32_16x16x32_bf16 v[72:75], a[104:107], v[180:183], v[72:75]
    v_exp_f32 v215, v215
    v_mfma_f32_16x16x32_bf16 v[104:107], a[104:107], v[188:191], v[104:107]
    v_cvt_pk_bf16_f32 v184, v212, v213
    v_cvt_pk_bf16_f32 v185, v214, v215
    v_mfma_f32_16x16x32_bf16 v[136:139], a[104:107], v[196:199], v[136:139]
    ds_read_b128 a[104:107], v239 offset:8192
    v_mul_f32 v54, v54, v225
    v_mfma_f32_16x16x32_bf16 v[140:143], a[108:111], v[196:199], v[140:143]
    v_mul_f32 v55, v55, v225
    v_mul_f32_dpp v56, v56, v246 row_ror:8 row_mask:0xf bank_mask:0xf
    v_mfma_f32_16x16x32_bf16 v[108:111], a[108:111], v[188:191], v[108:111]
    v_mul_f32_dpp v57, v57, v246 row_ror:8 row_mask:0xf bank_mask:0xf
    v_mul_f32_dpp v58, v58, v246 row_ror:8 row_mask:0xf bank_mask:0xf
    v_mfma_f32_16x16x32_bf16 v[76:79], a[108:111], v[180:183], v[76:79]
    s_waitcnt lgkmcnt(1)
    v_mul_f32_dpp v59, v59, v246 row_ror:8 row_mask:0xf bank_mask:0xf
    v_mul_f32_dpp v60, v60, v246 row_ror:8 row_mask:0xf bank_mask:0xf
    v_mfma_f32_16x16x32_bf16 v[204:207], a[80:83], a[32:35], -4.0
    ds_read_b128 a[108:111], v239 offset:9216
    v_mul_f32_dpp v61, v61, v246 row_ror:8 row_mask:0xf bank_mask:0xf
    v_mfma_f32_16x16x32_bf16 v[204:207], a[84:87], a[36:39], v[204:207]
    v_mul_f32_dpp v62, v62, v246 row_ror:8 row_mask:0xf bank_mask:0xf
    v_mul_f32_dpp v63, v63, v246 row_ror:8 row_mask:0xf bank_mask:0xf
    v_mfma_f32_16x16x32_bf16 v[204:207], a[88:91], a[40:43], v[204:207]
    v_cvt_pk_bf16_f32 v216, v48, v49
    v_cvt_pk_bf16_f32 v217, v50, v51
    v_mfma_f32_16x16x32_bf16 v[204:207], a[92:95], a[44:47], v[204:207]
    v_cvt_pk_bf16_f32 v218, v52, v53
    v_cvt_pk_bf16_f32 v219, v54, v55
    v_mfma_f32_16x16x32_bf16 v[208:211], a[92:95], a[60:63], -4.0
    v_cvt_pk_bf16_f32 v220, v56, v57
    v_cvt_pk_bf16_f32 v221, v58, v59
    v_mfma_f32_16x16x32_bf16 v[208:211], a[88:91], a[56:59], v[208:211]
    v_cvt_pk_bf16_f32 v222, v60, v61
    v_cvt_pk_bf16_f32 v223, v62, v63
    v_mfma_f32_16x16x32_bf16 v[208:211], a[84:87], a[52:55], v[208:211]
    v_cndmask_b32 v240, v216, v220, vcc
    v_cndmask_b32 v241, v217, v221, vcc
    v_mfma_f32_16x16x32_bf16 v[208:211], a[80:83], a[48:51], v[208:211]
    v_cndmask_b32 v242, v218, v222, vcc
    v_cndmask_b32 v243, v219, v223, vcc
    v_mfma_f32_16x16x32_bf16 v[212:215], a[80:83], a[64:67], -4.0
    buffer_store_dwordx4 v[240:243], v244, s[16:19], s42 offen nt
    v_mfma_f32_16x16x32_bf16 v[212:215], a[84:87], a[68:71], v[212:215]
    ds_read_b128 a[80:83], v228 offset:40960
    v_cndmask_b32 v220, v220, v216, vcc
    v_mfma_f32_16x16x32_bf16 v[212:215], a[88:91], a[72:75], v[212:215]
    ds_read_b128 a[84:87], v228 offset:41216
    v_cndmask_b32 v221, v221, v217, vcc
    v_mfma_f32_16x16x32_bf16 v[212:215], a[92:95], a[76:79], v[212:215]
    ds_read_b128 a[88:91], v228 offset:41472
    v_cndmask_b32 v222, v222, v218, vcc
    v_mfma_f32_16x16x32_bf16 v[80:83], a[96:99], v[180:183], v[80:83]
    ds_read_b128 a[92:95], v228 offset:41728
    v_cndmask_b32 v223, v223, v219, vcc
    v_mfma_f32_16x16x32_bf16 v[112:115], a[96:99], v[188:191], v[112:115]
    buffer_store_dwordx4 v[220:223], v245, s[16:19], s42 offen nt
    v_mfma_f32_16x16x32_bf16 v[144:147], a[96:99], v[196:199], v[144:147]
    v_exp_f32 v208, v208
    v_mfma_f32_16x16x32_bf16 v[148:151], a[100:103], v[196:199], v[148:151]
    s_add_u32 s42, s42, 16384
    v_exp_f32 v209, v209
    v_mfma_f32_16x16x32_bf16 v[116:119], a[100:103], v[188:191], v[116:119]
    v_exp_f32 v210, v210
    v_mfma_f32_16x16x32_bf16 v[84:87], a[100:103], v[180:183], v[84:87]
    s_waitcnt lgkmcnt(4)
    v_exp_f32 v211, v211
    v_mfma_f32_16x16x32_bf16 v[88:91], a[104:107], v[180:183], v[88:91]
    v_cvt_pk_bf16_f32 v186, v208, v209
    v_cvt_pk_bf16_f32 v187, v210, v211
    v_mfma_f32_16x16x32_bf16 v[120:123], a[104:107], v[188:191], v[120:123]
    v_exp_f32 v200, v200
    v_mfma_f32_16x16x32_bf16 v[152:155], a[104:107], v[196:199], v[152:155]
    v_exp_f32 v201, v201
    v_mfma_f32_16x16x32_bf16 v[156:159], a[108:111], v[196:199], v[156:159]
    v_exp_f32 v202, v202
    v_mfma_f32_16x16x32_bf16 v[124:127], a[108:111], v[188:191], v[124:127]
    v_exp_f32 v203, v203
    v_mfma_f32_16x16x32_bf16 v[92:95], a[108:111], v[180:183], v[92:95]
    v_cvt_pk_bf16_f32 v192, v200, v201
    v_cvt_pk_bf16_f32 v193, v202, v203
    v_smfmac_f32_16x16x64_bf16 a[124:127], a[132:135], v[184:191], v238
    s_waitcnt lgkmcnt(0)
    v_max3_f32 v227, v226, v225, v227
    v_mfma_f32_16x16x32_bf16 v[200:203], a[80:83], a[32:35], -4.0
    v_exp_f32 v204, v204
    v_mfma_f32_16x16x32_bf16 v[200:203], a[84:87], a[36:39], v[200:203]
    v_exp_f32 v205, v205
    v_mfma_f32_16x16x32_bf16 v[200:203], a[88:91], a[40:43], v[200:203]
    v_exp_f32 v206, v206
    v_exp_f32 v207, v207
    v_mfma_f32_16x16x32_bf16 v[200:203], a[92:95], a[44:47], v[200:203]
    v_cvt_pk_bf16_f32 v178, v204, v205
    v_cvt_pk_bf16_f32 v179, v206, v207
    v_mfma_f32_16x16x32_bf16 v[204:207], a[92:95], a[60:63], -4.0
    s_barrier
    v_mfma_f32_16x16x32_bf16 v[204:207], a[88:91], a[56:59], v[204:207]
    ds_read_b128 a[104:107], v230 offset:16384
    v_mfma_f32_16x16x32_bf16 v[204:207], a[84:87], a[52:55], v[204:207]
    v_exp_f32 v212, v212
    v_mfma_f32_16x16x32_bf16 v[204:207], a[80:83], a[48:51], v[204:207]
    v_exp_f32 v213, v213
    v_mfma_f32_16x16x32_bf16 v[208:211], a[80:83], a[64:67], -4.0
    v_exp_f32 v214, v214
    v_mfma_f32_16x16x32_bf16 v[208:211], a[84:87], a[68:71], v[208:211]
    v_exp_f32 v215, v215
    v_mfma_f32_16x16x32_bf16 v[208:211], a[88:91], a[72:75], v[208:211]
    ds_read_b128 a[108:111], v230 offset:17408
    v_cvt_pk_bf16_f32 v194, v212, v213
    v_mfma_f32_16x16x32_bf16 v[208:211], a[92:95], a[76:79], v[208:211]
    ds_read_b128 a[80:83], v228 offset:45056
    v_cvt_pk_bf16_f32 v195, v214, v215
    v_mfma_f32_16x16x32_bf16 v[64:67], a[168:171], v[176:179], v[64:67]
    ds_read_b128 a[84:87], v228 offset:45312
    v_mfma_f32_16x16x32_bf16 v[96:99], a[168:171], v[184:187], v[96:99]
    ds_read_b128 a[88:91], v228 offset:45568
    v_mfma_f32_16x16x32_bf16 v[128:131], a[168:171], v[192:195], v[128:131]
    ds_read_b128 a[92:95], v228 offset:45824
    v_mfma_f32_16x16x32_bf16 v[132:135], a[172:175], v[192:195], v[132:135]
    ds_write_b128 v236, a[192:195] offset:57344
    v_mfma_f32_16x16x32_bf16 v[100:103], a[172:175], v[184:187], v[100:103]
    v_exp_f32 v200, v200
    v_mfma_f32_16x16x32_bf16 v[68:71], a[172:175], v[176:179], v[68:71]
    s_waitcnt lgkmcnt(6)
    v_exp_f32 v201, v201
    v_mfma_f32_16x16x32_bf16 v[72:75], a[104:107], v[176:179], v[72:75]
    ds_write_b128 v236, a[196:199] offset:58368
    v_mfma_f32_16x16x32_bf16 v[104:107], a[104:107], v[184:187], v[104:107]
    v_exp_f32 v202, v202
    v_mfma_f32_16x16x32_bf16 v[136:139], a[104:107], v[192:195], v[136:139]
    s_waitcnt lgkmcnt(4)
    v_exp_f32 v203, v203
    v_mfma_f32_16x16x32_bf16 v[140:143], a[108:111], v[192:195], v[140:143]
    ds_read_b128 a[96:99], v231 offset:16384
    v_cvt_pk_bf16_f32 v180, v200, v201
    v_mfma_f32_16x16x32_bf16 v[108:111], a[108:111], v[184:187], v[108:111]
    ds_read_b128 a[100:103], v231 offset:17408
    v_cvt_pk_bf16_f32 v181, v202, v203
    v_mfma_f32_16x16x32_bf16 v[76:79], a[108:111], v[176:179], v[76:79]
    v_exp_f32 v204, v204
    v_mfma_f32_16x16x32_bf16 v[212:215], a[80:83], a[32:35], -4.0
    v_exp_f32 v205, v205
    v_mfma_f32_16x16x32_bf16 v[212:215], a[84:87], a[36:39], v[212:215]
    s_waitcnt lgkmcnt(3)
    v_exp_f32 v206, v206
    v_mfma_f32_16x16x32_bf16 v[212:215], a[88:91], a[40:43], v[212:215]
    v_exp_f32 v207, v207
    v_mfma_f32_16x16x32_bf16 v[212:215], a[92:95], a[44:47], v[212:215]
    ds_read_b128 a[104:107], v239 offset:16384
    v_cvt_pk_bf16_f32 v188, v204, v205
    v_mfma_f32_16x16x32_bf16 v[200:203], a[92:95], a[60:63], -4.0
    ds_read_b128 a[108:111], v239 offset:17408
    v_cvt_pk_bf16_f32 v189, v206, v207
    v_mfma_f32_16x16x32_bf16 v[200:203], a[88:91], a[56:59], v[200:203]
    ds_write_b128 v236, a[200:203] offset:32768
    v_mfma_f32_16x16x32_bf16 v[200:203], a[84:87], a[52:55], v[200:203]
    v_exp_f32 v212, v212
    v_mfma_f32_16x16x32_bf16 v[200:203], a[80:83], a[48:51], v[200:203]
    v_exp_f32 v213, v213
    v_mfma_f32_16x16x32_bf16 v[204:207], a[80:83], a[64:67], -4.0
    ds_read_b128 a[80:83], v228 offset:49152
    v_cvt_pk_bf16_f32 v182, v212, v213
    v_mfma_f32_16x16x32_bf16 v[204:207], a[84:87], a[68:71], v[204:207]
    ds_read_b128 a[84:87], v228 offset:49408
    v_mfma_f32_16x16x32_bf16 v[204:207], a[88:91], a[72:75], v[204:207]
    ds_read_b128 a[88:91], v228 offset:49664
    v_mfma_f32_16x16x32_bf16 v[204:207], a[92:95], a[76:79], v[204:207]
    s_waitcnt lgkmcnt(6)
    v_exp_f32 v214, v214
    v_mfma_f32_16x16x32_bf16 v[80:83], a[96:99], v[176:179], v[80:83]
    ds_read_b128 a[92:95], v228 offset:49920
    v_mfma_f32_16x16x32_bf16 v[112:115], a[96:99], v[184:187], v[112:115]
    ds_write_b128 v236, a[204:207] offset:33792
    v_mfma_f32_16x16x32_bf16 v[144:147], a[96:99], v[192:195], v[144:147]
    v_exp_f32 v215, v215
    v_mfma_f32_16x16x32_bf16 v[148:151], a[100:103], v[192:195], v[148:151]
    v_exp_f32 v208, v208
    v_mfma_f32_16x16x32_bf16 v[116:119], a[100:103], v[184:187], v[116:119]
    v_exp_f32 v209, v209
    v_mfma_f32_16x16x32_bf16 v[84:87], a[100:103], v[176:179], v[84:87]
    s_waitcnt lgkmcnt(4)
    v_exp_f32 v210, v210
    v_mfma_f32_16x16x32_bf16 v[88:91], a[104:107], v[176:179], v[88:91]
    v_exp_f32 v211, v211
    v_mfma_f32_16x16x32_bf16 v[120:123], a[104:107], v[184:187], v[120:123]
    ds_read_b128 a[96:99], v231 offset:24576
    v_cvt_pk_bf16_f32 v183, v214, v215
    v_mfma_f32_16x16x32_bf16 v[152:155], a[104:107], v[192:195], v[152:155]
    v_exp_f32 v204, v204
    v_mfma_f32_16x16x32_bf16 v[156:159], a[108:111], v[192:195], v[156:159]
    v_exp_f32 v205, v205
    v_mfma_f32_16x16x32_bf16 v[124:127], a[108:111], v[184:187], v[124:127]
    v_exp_f32 v206, v206
    v_exp_f32 v207, v207
    v_mfma_f32_16x16x32_bf16 v[92:95], a[108:111], v[176:179], v[92:95]
    ds_read_b128 a[104:107], v230 offset:24576
    v_cvt_pk_bf16_f32 v196, v208, v209
    v_cvt_pk_bf16_f32 v197, v210, v211
    v_cvt_pk_bf16_f32 v198, v204, v205
    v_cvt_pk_bf16_f32 v199, v206, v207
    v_smfmac_f32_16x16x64_bf16 a[120:123], a[132:135], v[176:183], v238
    ds_write_b128 v236, a[208:211] offset:40960
    v_smfmac_f32_16x16x64_bf16 a[128:131], a[132:135], v[192:199], v238
    v_mfma_f32_16x16x32_bf16 v[208:211], a[80:83], a[48:51], -4.0
    s_waitcnt lgkmcnt(3)
    v_exp_f32 v200, v200
    v_mfma_f32_16x16x32_bf16 v[208:211], a[84:87], a[52:55], v[208:211]
    v_exp_f32 v201, v201
    v_mfma_f32_16x16x32_bf16 v[208:211], a[88:91], a[56:59], v[208:211]
    ds_read_b128 a[108:111], v230 offset:25600
    v_accvgpr_read_b32 v224, a120
    v_accvgpr_read_b32 v226, a121
    v_mfma_f32_16x16x32_bf16 v[208:211], a[92:95], a[60:63], v[208:211]
    ds_read_b128 a[100:103], v231 offset:25600
    v_add_f32 v226, v226, v224
    v_mfma_f32_16x16x32_bf16 v[212:215], a[92:95], a[76:79], -4.0
    v_rcp_f32 v224, v226
    v_mfma_f32_16x16x32_bf16 v[212:215], a[88:91], a[72:75], v[212:215]
    v_exp_f32 v202, v202
    v_mfma_f32_16x16x32_bf16 v[212:215], a[84:87], a[68:71], v[212:215]
    v_exp_f32 v203, v203
    v_mfma_f32_16x16x32_bf16 v[212:215], a[80:83], a[64:67], v[212:215]
    ds_read_b128 a[80:83], v228 offset:53248
    v_cvt_pk_bf16_f32 v190, v200, v201
    v_cvt_pk_bf16_f32 v191, v202, v203
    v_mfma_f32_16x16x32_bf16 v[64:67], a[176:179], v[180:183], v[64:67]
    ds_read_b128 a[84:87], v228 offset:53504
    v_mov_b32_dpp v246, v224 row_ror:8 row_mask:0xf bank_mask:0xf
    v_mfma_f32_16x16x32_bf16 v[96:99], a[176:179], v[188:191], v[96:99]
    ds_read_b128 a[88:91], v228 offset:53760
    v_max3_f32 v227, v226, v224, v227
    v_mfma_f32_16x16x32_bf16 v[128:131], a[176:179], v[196:199], v[128:131]
    ds_read_b128 a[92:95], v228 offset:54016
    v_mfma_f32_16x16x32_bf16 v[132:135], a[180:183], v[196:199], v[132:135]
    ds_write_b128 v236, a[212:215] offset:41984
    v_mfma_f32_16x16x32_bf16 v[100:103], a[180:183], v[188:191], v[100:103]
    v_exp_f32 v208, v208
    v_mfma_f32_16x16x32_bf16 v[68:71], a[180:183], v[180:183], v[68:71]
    s_waitcnt lgkmcnt(5)
    v_exp_f32 v209, v209
    v_mfma_f32_16x16x32_bf16 v[72:75], a[104:107], v[180:183], v[72:75]
    v_exp_f32 v210, v210
    v_mfma_f32_16x16x32_bf16 v[104:107], a[104:107], v[188:191], v[104:107]
    v_exp_f32 v211, v211
    v_mfma_f32_16x16x32_bf16 v[136:139], a[104:107], v[196:199], v[136:139]
    ds_read_b128 a[104:107], v239 offset:24576
    v_cvt_pk_bf16_f32 v184, v208, v209
    v_mfma_f32_16x16x32_bf16 v[140:143], a[108:111], v[196:199], v[140:143]
    v_cvt_pk_bf16_f32 v185, v210, v211
    v_mul_f32 v64, v64, v224
    v_mfma_f32_16x16x32_bf16 v[108:111], a[108:111], v[188:191], v[108:111]
    v_exp_f32 v212, v212
    v_mfma_f32_16x16x32_bf16 v[76:79], a[108:111], v[180:183], v[76:79]
    s_waitcnt lgkmcnt(2)
    v_exp_f32 v213, v213
    v_mfma_f32_16x16x32_bf16 v[200:203], a[80:83], a[48:51], -4.0
    ds_read_b128 a[108:111], v239 offset:25600
    v_cvt_pk_bf16_f32 v192, v212, v213
    v_mfma_f32_16x16x32_bf16 v[200:203], a[84:87], a[52:55], v[200:203]
    v_exp_f32 v214, v214
    v_mfma_f32_16x16x32_bf16 v[200:203], a[88:91], a[56:59], v[200:203]
    v_exp_f32 v215, v215
    v_mfma_f32_16x16x32_bf16 v[200:203], a[92:95], a[60:63], v[200:203]
    v_cvt_pk_bf16_f32 v193, v214, v215
    v_mul_f32 v65, v65, v224
    v_mfma_f32_16x16x32_bf16 v[204:207], a[92:95], a[76:79], -4.0
    ds_read_b128 a[92:95], v228 offset:58112
    v_mul_f32 v66, v66, v224
    v_mfma_f32_16x16x32_bf16 v[204:207], a[88:91], a[72:75], v[204:207]
    ds_read_b128 a[88:91], v228 offset:57856
    v_mul_f32 v67, v67, v224
    v_mfma_f32_16x16x32_bf16 v[204:207], a[84:87], a[68:71], v[204:207]
    ds_read_b128 a[84:87], v228 offset:57600
    v_mul_f32 v68, v68, v224
    v_mfma_f32_16x16x32_bf16 v[204:207], a[80:83], a[64:67], v[204:207]
    ds_read_b128 a[80:83], v228 offset:57344
    v_mul_f32 v69, v69, v224
    v_mfma_f32_16x16x32_bf16 v[80:83], a[96:99], v[180:183], v[80:83]
    v_exp_f32 v200, v200
    v_mfma_f32_16x16x32_bf16 v[112:115], a[96:99], v[188:191], v[112:115]
    v_exp_f32 v201, v201
    v_mfma_f32_16x16x32_bf16 v[144:147], a[96:99], v[196:199], v[144:147]
    v_exp_f32 v202, v202
    v_mfma_f32_16x16x32_bf16 v[148:151], a[100:103], v[196:199], v[148:151]
    v_exp_f32 v203, v203
    v_mfma_f32_16x16x32_bf16 v[116:119], a[100:103], v[188:191], v[116:119]
    ds_read_b128 a[96:99], v231 offset:49152
    v_cvt_pk_bf16_f32 v186, v200, v201
    v_mfma_f32_16x16x32_bf16 v[84:87], a[100:103], v[180:183], v[84:87]
    s_waitcnt lgkmcnt(5)
    v_cvt_pk_bf16_f32 v187, v202, v203
    v_mul_f32 v70, v70, v224
    v_mfma_f32_16x16x32_bf16 v[88:91], a[104:107], v[180:183], v[88:91]
    v_exp_f32 v204, v204
    v_mfma_f32_16x16x32_bf16 v[120:123], a[104:107], v[188:191], v[120:123]
    v_exp_f32 v205, v205
    v_mfma_f32_16x16x32_bf16 v[152:155], a[104:107], v[196:199], v[152:155]
    ds_read_b128 a[104:107], v230 offset:49152
    v_cvt_pk_bf16_f32 v194, v204, v205
    v_mfma_f32_16x16x32_bf16 v[156:159], a[108:111], v[196:199], v[156:159]
    v_exp_f32 v206, v206
    v_mfma_f32_16x16x32_bf16 v[124:127], a[108:111], v[188:191], v[124:127]
    v_exp_f32 v207, v207
    v_mfma_f32_16x16x32_bf16 v[92:95], a[108:111], v[180:183], v[92:95]
    ds_read_b128 a[108:111], v230 offset:50176
    v_cvt_pk_bf16_f32 v195, v206, v207
    v_smfmac_f32_16x16x64_bf16 a[124:127], a[132:135], v[184:191], v238
    s_waitcnt lgkmcnt(3)
    v_mul_f32 v71, v71, v224
    v_mfma_f32_16x16x32_bf16 v[208:211], a[80:83], a[48:51], -4.0
    ds_read_b128 a[100:103], v231 offset:50176
    v_mul_f32_dpp v72, v72, v246 row_ror:8 row_mask:0xf bank_mask:0xf
    v_mfma_f32_16x16x32_bf16 v[208:211], a[84:87], a[52:55], v[208:211]
    v_mul_f32_dpp v73, v73, v246 row_ror:8 row_mask:0xf bank_mask:0xf
    v_mul_f32_dpp v74, v74, v246 row_ror:8 row_mask:0xf bank_mask:0xf
    v_mfma_f32_16x16x32_bf16 v[208:211], a[88:91], a[56:59], v[208:211]
    v_mul_f32_dpp v75, v75, v246 row_ror:8 row_mask:0xf bank_mask:0xf
    v_mul_f32_dpp v76, v76, v246 row_ror:8 row_mask:0xf bank_mask:0xf
    v_mfma_f32_16x16x32_bf16 v[208:211], a[92:95], a[60:63], v[208:211]
    v_mul_f32_dpp v77, v77, v246 row_ror:8 row_mask:0xf bank_mask:0xf
    v_mul_f32_dpp v78, v78, v246 row_ror:8 row_mask:0xf bank_mask:0xf
    v_mfma_f32_16x16x32_bf16 v[212:215], a[92:95], a[76:79], -4.0
    ds_read_b128 a[92:95], v228 offset:62208
    v_mul_f32_dpp v79, v79, v246 row_ror:8 row_mask:0xf bank_mask:0xf
    v_mfma_f32_16x16x32_bf16 v[212:215], a[88:91], a[72:75], v[212:215]
    ds_read_b128 a[88:91], v228 offset:61952
    v_cvt_pk_bf16_f32 v216, v64, v65
    v_mfma_f32_16x16x32_bf16 v[212:215], a[84:87], a[68:71], v[212:215]
    ds_read_b128 a[84:87], v228 offset:61696
    v_cvt_pk_bf16_f32 v217, v66, v67
    v_mfma_f32_16x16x32_bf16 v[212:215], a[80:83], a[64:67], v[212:215]
    ds_read_b128 a[80:83], v228 offset:61440
    v_cvt_pk_bf16_f32 v218, v68, v69
    v_mfma_f32_16x16x32_bf16 v[96:99], a[184:187], v[184:187], v[96:99]
    v_cvt_pk_bf16_f32 v219, v70, v71
    v_cvt_pk_bf16_f32 v220, v72, v73
    v_mfma_f32_16x16x32_bf16 v[128:131], a[184:187], v[192:195], v[128:131]
    v_cvt_pk_bf16_f32 v221, v74, v75
    v_cvt_pk_bf16_f32 v222, v76, v77
    v_mfma_f32_16x16x32_bf16 v[132:135], a[188:191], v[192:195], v[132:135]
    v_cvt_pk_bf16_f32 v223, v78, v79
    v_cndmask_b32 v240, v216, v220, vcc
    v_mfma_f32_16x16x32_bf16 v[100:103], a[188:191], v[184:187], v[100:103]
    s_waitcnt lgkmcnt(4)
    v_cndmask_b32 v241, v217, v221, vcc
    v_cndmask_b32 v242, v218, v222, vcc
    v_mfma_f32_16x16x32_bf16 v[104:107], a[104:107], v[184:187], v[104:107]
    v_cndmask_b32 v243, v219, v223, vcc
    v_cndmask_b32 v220, v220, v216, vcc
    v_mfma_f32_16x16x32_bf16 v[136:139], a[104:107], v[192:195], v[136:139]
    ds_read_b128 a[104:107], v239 offset:49152
    v_cndmask_b32 v221, v221, v217, vcc
    v_mfma_f32_16x16x32_bf16 v[140:143], a[108:111], v[192:195], v[140:143]
    buffer_store_dwordx4 v[240:243], v244, s[16:19], s26 offen nt
    v_mfma_f32_16x16x32_bf16 v[108:111], a[108:111], v[184:187], v[108:111]
    s_waitcnt lgkmcnt(1)
    v_cndmask_b32 v222, v222, v218, vcc
    v_cndmask_b32 v223, v223, v219, vcc
    v_mfma_f32_16x16x32_bf16 v[200:203], a[80:83], a[48:51], -4.0
    ds_read_b128 a[108:111], v239 offset:50176
    v_mul_f32 v80, v80, v224
    v_mfma_f32_16x16x32_bf16 v[200:203], a[84:87], a[52:55], v[200:203]
    v_mul_f32 v81, v81, v224
    v_mul_f32 v82, v82, v224
    v_mfma_f32_16x16x32_bf16 v[200:203], a[88:91], a[56:59], v[200:203]
    buffer_store_dwordx4 v[220:223], v245, s[16:19], s26 offen nt
    v_mfma_f32_16x16x32_bf16 v[200:203], a[92:95], a[60:63], v[200:203]
    v_mul_f32 v83, v83, v224
    v_mul_f32 v84, v84, v224
    v_mfma_f32_16x16x32_bf16 v[204:207], a[92:95], a[76:79], -4.0
    ds_read_b128 a[92:95], v229 offset:768
    v_mul_f32 v85, v85, v224
    v_mfma_f32_16x16x32_bf16 v[204:207], a[88:91], a[72:75], v[204:207]
    ds_read_b128 a[88:91], v229 offset:512
    v_mul_f32 v86, v86, v224
    v_mfma_f32_16x16x32_bf16 v[204:207], a[84:87], a[68:71], v[204:207]
    ds_read_b128 a[84:87], v229 offset:256
    v_mul_f32 v87, v87, v224
    v_mfma_f32_16x16x32_bf16 v[204:207], a[80:83], a[64:67], v[204:207]
    ds_read_b128 a[80:83], v229 offset:0
    v_mul_f32_dpp v88, v88, v246 row_ror:8 row_mask:0xf bank_mask:0xf
    v_mfma_f32_16x16x32_bf16 v[112:115], a[96:99], v[184:187], v[112:115]
    s_add_u32 s26, s26, 16384
    v_mul_f32_dpp v89, v89, v246 row_ror:8 row_mask:0xf bank_mask:0xf
    v_mul_f32_dpp v90, v90, v246 row_ror:8 row_mask:0xf bank_mask:0xf
    v_mfma_f32_16x16x32_bf16 v[144:147], a[96:99], v[192:195], v[144:147]
    v_mul_f32_dpp v91, v91, v246 row_ror:8 row_mask:0xf bank_mask:0xf
    v_mul_f32_dpp v92, v92, v246 row_ror:8 row_mask:0xf bank_mask:0xf
    v_mfma_f32_16x16x32_bf16 v[148:151], a[100:103], v[192:195], v[148:151]
    v_mul_f32_dpp v93, v93, v246 row_ror:8 row_mask:0xf bank_mask:0xf
    v_mul_f32_dpp v94, v94, v246 row_ror:8 row_mask:0xf bank_mask:0xf
    v_mfma_f32_16x16x32_bf16 v[116:119], a[100:103], v[184:187], v[116:119]
    s_waitcnt lgkmcnt(4)
    v_mul_f32_dpp v95, v95, v246 row_ror:8 row_mask:0xf bank_mask:0xf
    v_cvt_pk_bf16_f32 v216, v80, v81
    v_mfma_f32_16x16x32_bf16 v[120:123], a[104:107], v[184:187], v[120:123]
    v_exp_f32 v212, v212
    v_mfma_f32_16x16x32_bf16 v[152:155], a[104:107], v[192:195], v[152:155]
    v_exp_f32 v213, v213
    v_exp_f32 v214, v214
    v_exp_f32 v215, v215
    v_exp_f32 v204, v204
    v_exp_f32 v205, v205
    v_exp_f32 v206, v206
    v_exp_f32 v207, v207
    v_cvt_pk_bf16_f32 v217, v82, v83
    v_cvt_pk_bf16_f32 v218, v84, v85
    v_cvt_pk_bf16_f32 v219, v86, v87
    v_cvt_pk_bf16_f32 v220, v88, v89
    v_cvt_pk_bf16_f32 v221, v90, v91
    v_cvt_pk_bf16_f32 v222, v92, v93
    v_cvt_pk_bf16_f32 v223, v94, v95
    v_mfma_f32_16x16x32_bf16 v[156:159], a[108:111], v[192:195], v[156:159]
    v_cndmask_b32 v240, v216, v220, vcc
    v_cndmask_b32 v241, v217, v221, vcc
    v_cndmask_b32 v242, v218, v222, vcc
    v_cndmask_b32 v243, v219, v223, vcc
    v_cvt_pk_bf16_f32 v196, v212, v213
    v_cvt_pk_bf16_f32 v197, v214, v215
    v_cvt_pk_bf16_f32 v198, v204, v205
    v_cvt_pk_bf16_f32 v199, v206, v207
    v_cndmask_b32 v220, v220, v216, vcc
    v_cndmask_b32 v221, v221, v217, vcc
    v_cndmask_b32 v222, v222, v218, vcc
    v_cndmask_b32 v223, v223, v219, vcc
    v_mfma_f32_16x16x32_bf16 v[124:127], a[108:111], v[184:187], v[124:127]
    buffer_store_dwordx4 v[240:243], v244, s[16:19], s42 offen nt
    v_exp_f32 v208, v208
    v_exp_f32 v209, v209
    v_exp_f32 v210, v210
    v_exp_f32 v211, v211
    v_cvt_pk_bf16_f32 v188, v208, v209
    v_cvt_pk_bf16_f32 v189, v210, v211
    buffer_store_dwordx4 v[220:223], v245, s[16:19], s42 offen nt
    v_smfmac_f32_16x16x64_bf16 a[128:131], a[132:135], v[192:199], v238
    s_waitcnt lgkmcnt(0)
    s_add_u32 s42, s42, 16384
    v_mfma_f32_16x16x32_bf16 v[208:211], a[80:83], a[48:51], -4.0
    s_barrier
    v_mfma_f32_16x16x32_bf16 v[208:211], a[84:87], a[52:55], v[208:211]
    ds_read_b128 a[104:107], v230 offset:57344
    v_mfma_f32_16x16x32_bf16 v[208:211], a[88:91], a[56:59], v[208:211]
    ds_read_b128 a[108:111], v230 offset:58368
    v_mfma_f32_16x16x32_bf16 v[208:211], a[92:95], a[60:63], v[208:211]
    v_exp_f32 v200, v200
    v_mfma_f32_16x16x32_bf16 v[212:215], a[92:95], a[76:79], -4.0
    v_exp_f32 v201, v201
    v_mfma_f32_16x16x32_bf16 v[212:215], a[88:91], a[72:75], v[212:215]
    v_exp_f32 v202, v202
    v_exp_f32 v203, v203
    v_mfma_f32_16x16x32_bf16 v[212:215], a[84:87], a[68:71], v[212:215]
    ds_read_b128 a[84:87], v229 offset:4352
    v_cvt_pk_bf16_f32 v190, v200, v201
    v_cvt_pk_bf16_f32 v191, v202, v203
    v_mfma_f32_16x16x32_bf16 v[212:215], a[80:83], a[64:67], v[212:215]
    ds_read_b128 a[80:83], v229 offset:4096
    v_mfma_f32_16x16x32_bf16 v[96:99], a[192:195], v[188:191], v[96:99]
    ds_read_b128 a[88:91], v229 offset:4608
    v_mfma_f32_16x16x32_bf16 v[128:131], a[192:195], v[196:199], v[128:131]
    ds_read_b128 a[92:95], v229 offset:4864
    v_mfma_f32_16x16x32_bf16 v[132:135], a[196:199], v[196:199], v[132:135]
    ds_write_b128 v236, a[216:219] offset:0
    v_mfma_f32_16x16x32_bf16 v[100:103], a[196:199], v[188:191], v[100:103]
    s_waitcnt lgkmcnt(5)
    v_exp_f32 v208, v208
    v_mfma_f32_16x16x32_bf16 v[104:107], a[104:107], v[188:191], v[104:107]
    v_exp_f32 v209, v209
    v_mfma_f32_16x16x32_bf16 v[136:139], a[104:107], v[196:199], v[136:139]
    ds_read_b128 a[96:99], v231 offset:57344
    v_cvt_pk_bf16_f32 v184, v208, v209
    v_mfma_f32_16x16x32_bf16 v[140:143], a[108:111], v[196:199], v[140:143]
    ds_read_b128 a[104:107], v239 offset:57344
    v_mfma_f32_16x16x32_bf16 v[108:111], a[108:111], v[188:191], v[108:111]
    s_waitcnt lgkmcnt(5)
    v_exp_f32 v210, v210
    v_mfma_f32_16x16x32_bf16 v[200:203], a[80:83], a[48:51], -4.0
    ds_read_b128 a[100:103], v231 offset:58368
    v_mfma_f32_16x16x32_bf16 v[200:203], a[84:87], a[52:55], v[200:203]
    s_waitcnt lgkmcnt(5)
    v_exp_f32 v211, v211
    v_mfma_f32_16x16x32_bf16 v[200:203], a[88:91], a[56:59], v[200:203]
    s_waitcnt lgkmcnt(4)
    ds_read_b128 a[108:111], v239 offset:58368
    v_mfma_f32_16x16x32_bf16 v[200:203], a[92:95], a[60:63], v[200:203]
    v_cvt_pk_bf16_f32 v185, v210, v211
    v_mfma_f32_16x16x32_bf16 v[204:207], a[92:95], a[76:79], -4.0
    ds_read_b128 a[92:95], v229 offset:8960
    v_mfma_f32_16x16x32_bf16 v[204:207], a[88:91], a[72:75], v[204:207]
    ds_read_b128 a[88:91], v229 offset:8704
    v_mfma_f32_16x16x32_bf16 v[204:207], a[84:87], a[68:71], v[204:207]
    ds_write_b128 v236, a[220:223] offset:1024
    v_mfma_f32_16x16x32_bf16 v[204:207], a[80:83], a[64:67], v[204:207]
    s_waitcnt lgkmcnt(5)
    v_exp_f32 v200, v200
    v_mfma_f32_16x16x32_bf16 v[112:115], a[96:99], v[188:191], v[112:115]
    ds_read_b128 a[80:83], v229 offset:8192
    v_mfma_f32_16x16x32_bf16 v[144:147], a[96:99], v[196:199], v[144:147]
    s_waitcnt lgkmcnt(5)
    ds_read_b128 a[84:87], v229 offset:8448
    v_mfma_f32_16x16x32_bf16 v[148:151], a[100:103], v[196:199], v[148:151]
    v_exp_f32 v201, v201
    v_mfma_f32_16x16x32_bf16 v[116:119], a[100:103], v[188:191], v[116:119]
    v_exp_f32 v202, v202
    v_mfma_f32_16x16x32_bf16 v[120:123], a[104:107], v[188:191], v[120:123]
    v_exp_f32 v203, v203
    v_mfma_f32_16x16x32_bf16 v[152:155], a[104:107], v[196:199], v[152:155]
    s_waitcnt lgkmcnt(3)
    ds_read_b128 a[104:107], v230 offset:32768
    v_mfma_f32_16x16x32_bf16 v[156:159], a[108:111], v[196:199], v[156:159]
    v_exp_f32 v212, v212
    v_mfma_f32_16x16x32_bf16 v[124:127], a[108:111], v[188:191], v[124:127]
    ds_read_b128 a[108:111], v230 offset:33792
    s_waitcnt lgkmcnt(3)
    v_mfma_f32_16x16x32_bf16 v[208:211], a[80:83], a[64:67], -4.0
    ds_write_b128 v236, a[224:227] offset:8192
    s_waitcnt lgkmcnt(3)
    v_mfma_f32_16x16x32_bf16 v[208:211], a[84:87], a[68:71], v[208:211]
    v_exp_f32 v213, v213
    v_mfma_f32_16x16x32_bf16 v[208:211], a[88:91], a[72:75], v[208:211]
    v_exp_f32 v214, v214
    v_exp_f32 v215, v215
    v_cvt_pk_bf16_f32 v186, v200, v201
    v_cvt_pk_bf16_f32 v187, v202, v203
    v_exp_f32 v204, v204
    v_exp_f32 v205, v205
    v_exp_f32 v206, v206
    v_exp_f32 v207, v207
    v_mfma_f32_16x16x32_bf16 v[208:211], a[92:95], a[76:79], v[208:211]
    ds_read_b128 a[80:83], v229 offset:12288
    v_cvt_pk_bf16_f32 v192, v212, v213
    v_cvt_pk_bf16_f32 v193, v214, v215
    v_cvt_pk_bf16_f32 v194, v204, v205
    v_cvt_pk_bf16_f32 v195, v206, v207
    v_mfma_f32_16x16x32_bf16 v[96:99], a[200:203], v[184:187], v[96:99]
    ds_read_b128 a[84:87], v229 offset:12544
    v_mfma_f32_16x16x32_bf16 v[128:131], a[200:203], v[192:195], v[128:131]
    ds_read_b128 a[88:91], v229 offset:12800
    v_mfma_f32_16x16x32_bf16 v[132:135], a[204:207], v[192:195], v[132:135]
    ds_read_b128 a[92:95], v229 offset:13056
    v_mfma_f32_16x16x32_bf16 v[100:103], a[204:207], v[184:187], v[100:103]
    s_waitcnt lgkmcnt(4)
    v_exp_f32 v208, v208
    v_mfma_f32_16x16x32_bf16 v[104:107], a[104:107], v[184:187], v[104:107]
    ds_read_b128 a[96:99], v231 offset:32768
    v_mfma_f32_16x16x32_bf16 v[136:139], a[104:107], v[192:195], v[136:139]
    ds_read_b128 a[104:107], v239 offset:32768
    v_mfma_f32_16x16x32_bf16 v[140:143], a[108:111], v[192:195], v[140:143]
    ds_write_b128 v236, a[228:231] offset:9216
    v_mfma_f32_16x16x32_bf16 v[108:111], a[108:111], v[184:187], v[108:111]
    ds_read_b128 a[108:111], v239 offset:33792
    ds_read_b128 a[100:103], v231 offset:33792
    v_smfmac_f32_16x16x64_bf16 a[124:127], a[132:135], v[184:191], v238
    s_waitcnt lgkmcnt(6)
    v_mfma_f32_16x16x32_bf16 v[212:215], a[80:83], a[64:67], -4.0
    ds_read_b128 a[80:83], v229 offset:16384
    v_mfma_f32_16x16x32_bf16 v[212:215], a[84:87], a[68:71], v[212:215]
    ds_read_b128 a[84:87], v229 offset:16640
    v_mfma_f32_16x16x32_bf16 v[212:215], a[88:91], a[72:75], v[212:215]
    s_waitcnt lgkmcnt(6)
    v_exp_f32 v209, v209
    v_accvgpr_read_b32 v225, a124
    v_accvgpr_read_b32 v226, a125
    v_mfma_f32_16x16x32_bf16 v[212:215], a[92:95], a[76:79], v[212:215]
    ds_read_b128 a[88:91], v229 offset:16896
    v_add_f32 v226, v226, v225
    v_mfma_f32_16x16x32_bf16 v[112:115], a[96:99], v[184:187], v[112:115]
    ds_read_b128 a[92:95], v229 offset:17152
    v_cvt_pk_bf16_f32 v196, v208, v209
    v_mfma_f32_16x16x32_bf16 v[144:147], a[96:99], v[192:195], v[144:147]
    v_rcp_f32 v225, v226
    s_waitcnt lgkmcnt(4)
    v_mfma_f32_16x16x32_bf16 v[148:151], a[100:103], v[192:195], v[148:151]
    v_exp_f32 v210, v210
    v_mfma_f32_16x16x32_bf16 v[116:119], a[100:103], v[184:187], v[116:119]
    v_exp_f32 v211, v211
    v_mfma_f32_16x16x32_bf16 v[120:123], a[104:107], v[184:187], v[120:123]
    v_exp_f32 v212, v212
    v_mfma_f32_16x16x32_bf16 v[152:155], a[104:107], v[192:195], v[152:155]
    ds_read_b128 a[104:107], v230 offset:40960
    v_exp_f32 v213, v213
    v_exp_f32 v214, v214
    v_exp_f32 v215, v215
    v_mfma_f32_16x16x32_bf16 v[156:159], a[108:111], v[192:195], v[156:159]
    ds_read_b128 a[96:99], v231 offset:40960
    v_cvt_pk_bf16_f32 v197, v210, v211
    v_cvt_pk_bf16_f32 v198, v212, v213
    v_cvt_pk_bf16_f32 v199, v214, v215
    v_mfma_f32_16x16x32_bf16 v[124:127], a[108:111], v[184:187], v[124:127]
    ds_read_b128 a[108:111], v230 offset:41984
    v_mov_b32_dpp v246, v225 row_ror:8 row_mask:0xf bank_mask:0xf
    v_smfmac_f32_16x16x64_bf16 a[128:131], a[132:135], v[192:199], v238
    s_waitcnt lgkmcnt(3)
    v_mul_f32 v96, v96, v225
    v_mfma_f32_16x16x32_bf16 v[200:203], a[80:83], a[64:67], -4.0
    ds_read_b128 a[80:83], v229 offset:20480
    v_mul_f32 v97, v97, v225
    v_mfma_f32_16x16x32_bf16 v[200:203], a[84:87], a[68:71], v[200:203]
    ds_read_b128 a[84:87], v229 offset:20736
    v_mul_f32 v98, v98, v225
    v_mfma_f32_16x16x32_bf16 v[200:203], a[88:91], a[72:75], v[200:203]
    ds_read_b128 a[88:91], v229 offset:20992
    v_mul_f32 v99, v99, v225
    v_mfma_f32_16x16x32_bf16 v[200:203], a[92:95], a[76:79], v[200:203]
    ds_read_b128 a[92:95], v229 offset:21248
    v_mul_f32 v100, v100, v225
    v_mfma_f32_16x16x32_bf16 v[128:131], a[208:211], v[196:199], v[128:131]
    s_barrier
    v_mfma_f32_16x16x32_bf16 v[132:135], a[212:215], v[196:199], v[132:135]
    s_waitcnt lgkmcnt(6)
    ds_read_b128 a[100:103], v231 offset:41984
    v_mfma_f32_16x16x32_bf16 v[136:139], a[104:107], v[196:199], v[136:139]
    s_waitcnt lgkmcnt(5)
    ds_read_b128 a[104:107], v239 offset:40960
    v_mfma_f32_16x16x32_bf16 v[140:143], a[108:111], v[196:199], v[140:143]
    ds_read_b128 a[108:111], v239 offset:41984
    s_waitcnt lgkmcnt(6)
    v_mfma_f32_16x16x32_bf16 v[204:207], a[80:83], a[64:67], -4.0
    ds_read_b128 a[80:83], v229 offset:24576
    s_waitcnt lgkmcnt(6)
    v_mfma_f32_16x16x32_bf16 v[204:207], a[84:87], a[68:71], v[204:207]
    ds_read_b128 a[84:87], v229 offset:24832
    s_waitcnt lgkmcnt(6)
    v_mfma_f32_16x16x32_bf16 v[204:207], a[88:91], a[72:75], v[204:207]
    ds_read_b128 a[88:91], v229 offset:25088
    s_waitcnt lgkmcnt(6)
    v_mfma_f32_16x16x32_bf16 v[204:207], a[92:95], a[76:79], v[204:207]
    ds_read_b128 a[92:95], v229 offset:25344
    v_mul_f32 v101, v101, v225
    v_mul_f32 v102, v102, v225
    v_mul_f32 v103, v103, v225
    v_mul_f32_dpp v104, v104, v246 row_ror:8 row_mask:0xf bank_mask:0xf
    v_mul_f32_dpp v105, v105, v246 row_ror:8 row_mask:0xf bank_mask:0xf
    v_mul_f32_dpp v106, v106, v246 row_ror:8 row_mask:0xf bank_mask:0xf
    v_mul_f32_dpp v107, v107, v246 row_ror:8 row_mask:0xf bank_mask:0xf
    v_mul_f32_dpp v108, v108, v246 row_ror:8 row_mask:0xf bank_mask:0xf
    v_mul_f32_dpp v109, v109, v246 row_ror:8 row_mask:0xf bank_mask:0xf
    v_mul_f32_dpp v110, v110, v246 row_ror:8 row_mask:0xf bank_mask:0xf
    v_mul_f32_dpp v111, v111, v246 row_ror:8 row_mask:0xf bank_mask:0xf
    v_cvt_pk_bf16_f32 v216, v96, v97
    v_cvt_pk_bf16_f32 v217, v98, v99
    v_cvt_pk_bf16_f32 v218, v100, v101
    v_cvt_pk_bf16_f32 v219, v102, v103
    v_cvt_pk_bf16_f32 v220, v104, v105
    v_cvt_pk_bf16_f32 v221, v106, v107
    v_cvt_pk_bf16_f32 v222, v108, v109
    v_cvt_pk_bf16_f32 v223, v110, v111
    v_mfma_f32_16x16x32_bf16 v[144:147], a[96:99], v[196:199], v[144:147]
    s_waitcnt lgkmcnt(4)
    v_cndmask_b32 v240, v216, v220, vcc
    v_cndmask_b32 v241, v217, v221, vcc
    v_cndmask_b32 v242, v218, v222, vcc
    v_cndmask_b32 v243, v219, v223, vcc
    v_cndmask_b32 v220, v220, v216, vcc
    v_cndmask_b32 v221, v221, v217, vcc
    v_cndmask_b32 v222, v222, v218, vcc
    v_cndmask_b32 v223, v223, v219, vcc
    v_mfma_f32_16x16x32_bf16 v[148:151], a[100:103], v[196:199], v[148:151]
    buffer_store_dwordx4 v[220:223], v245, s[16:19], s26 offen nt
    v_mul_f32 v112, v112, v225
    v_mul_f32 v113, v113, v225
    v_mul_f32 v114, v114, v225
    v_mul_f32 v115, v115, v225
    v_mul_f32 v116, v116, v225
    v_mul_f32 v117, v117, v225
    v_mul_f32 v118, v118, v225
    v_mul_f32 v119, v119, v225
    v_mul_f32_dpp v120, v120, v246 row_ror:8 row_mask:0xf bank_mask:0xf
    v_mul_f32_dpp v121, v121, v246 row_ror:8 row_mask:0xf bank_mask:0xf
    v_mul_f32_dpp v122, v122, v246 row_ror:8 row_mask:0xf bank_mask:0xf
    v_mul_f32_dpp v123, v123, v246 row_ror:8 row_mask:0xf bank_mask:0xf
    v_mul_f32_dpp v124, v124, v246 row_ror:8 row_mask:0xf bank_mask:0xf
    v_mul_f32_dpp v125, v125, v246 row_ror:8 row_mask:0xf bank_mask:0xf
    v_mul_f32_dpp v126, v126, v246 row_ror:8 row_mask:0xf bank_mask:0xf
    v_mul_f32_dpp v127, v127, v246 row_ror:8 row_mask:0xf bank_mask:0xf
    v_cvt_pk_bf16_f32 v216, v112, v113
    v_cvt_pk_bf16_f32 v217, v114, v115
    v_cvt_pk_bf16_f32 v218, v116, v117
    v_cvt_pk_bf16_f32 v219, v118, v119
    v_cvt_pk_bf16_f32 v220, v120, v121
    v_cvt_pk_bf16_f32 v221, v122, v123
    v_cvt_pk_bf16_f32 v222, v124, v125
    v_cvt_pk_bf16_f32 v223, v126, v127
    v_mfma_f32_16x16x32_bf16 v[152:155], a[104:107], v[196:199], v[152:155]
    ds_read_b128 a[104:107], v230 offset:0
    v_max3_f32 v227, v226, v225, v227
    v_mfma_f32_16x16x32_bf16 v[156:159], a[108:111], v[196:199], v[156:159]
    ds_read_b128 a[108:111], v230 offset:1024
    buffer_store_dwordx4 v[240:243], v244, s[16:19], s26 offen nt
    v_exp_f32 v200, v200
    v_exp_f32 v201, v201
    v_cndmask_b32 v240, v216, v220, vcc
    v_cndmask_b32 v241, v217, v221, vcc
    v_cndmask_b32 v242, v218, v222, vcc
    v_cndmask_b32 v243, v219, v223, vcc
    v_cndmask_b32 v220, v220, v216, vcc
    v_cndmask_b32 v221, v221, v217, vcc
    v_cndmask_b32 v222, v222, v218, vcc
    v_cndmask_b32 v223, v223, v219, vcc
    buffer_store_dwordx4 v[240:243], v244, s[16:19], s42 offen nt
    v_exp_f32 v202, v202
    v_exp_f32 v203, v203
    v_exp_f32 v204, v204
    v_exp_f32 v205, v205
    v_exp_f32 v206, v206
    buffer_store_dwordx4 v[220:223], v245, s[16:19], s42 offen nt
    s_waitcnt lgkmcnt(0)
    v_mfma_f32_16x16x32_bf16 v[208:211], a[80:83], a[64:67], -4.0
    ds_read_b128 a[80:83], v229 offset:28672
    v_cvt_pk_bf16_f32 v192, v200, v201
    v_mfma_f32_16x16x32_bf16 v[208:211], a[84:87], a[68:71], v[208:211]
    ds_read_b128 a[84:87], v229 offset:28928
    v_exp_f32 v207, v207
    v_mfma_f32_16x16x32_bf16 v[208:211], a[88:91], a[72:75], v[208:211]
    ds_read_b128 a[88:91], v229 offset:29184
    v_cvt_pk_bf16_f32 v193, v202, v203
    v_cvt_pk_bf16_f32 v194, v204, v205
    v_cvt_pk_bf16_f32 v195, v206, v207
    v_mfma_f32_16x16x32_bf16 v[208:211], a[92:95], a[76:79], v[208:211]
    ds_read_b128 a[92:95], v229 offset:29440
    s_add_u32 s26, s26, 16384
    v_mfma_f32_16x16x32_bf16 v[128:131], a[216:219], v[192:195], v[128:131]
    ds_read_b128 a[96:99], v231 offset:0
    s_add_u32 s42, s42, 16384
    v_mfma_f32_16x16x32_bf16 v[132:135], a[220:223], v[192:195], v[132:135]
    ds_read_b128 a[100:103], v231 offset:1024
    v_mfma_f32_16x16x32_bf16 v[136:139], a[104:107], v[192:195], v[136:139]
    ds_read_b128 a[104:107], v239 offset:0
    v_mfma_f32_16x16x32_bf16 v[140:143], a[108:111], v[192:195], v[140:143]
    ds_read_b128 a[108:111], v239 offset:1024
    s_waitcnt lgkmcnt(7)
    v_mfma_f32_16x16x32_bf16 v[212:215], a[80:83], a[64:67], -4.0
    s_waitcnt lgkmcnt(6)
    v_mfma_f32_16x16x32_bf16 v[212:215], a[84:87], a[68:71], v[212:215]
    s_waitcnt lgkmcnt(5)
    v_mfma_f32_16x16x32_bf16 v[212:215], a[88:91], a[72:75], v[212:215]
    v_exp_f32 v208, v208
    s_waitcnt lgkmcnt(4)
    v_mfma_f32_16x16x32_bf16 v[212:215], a[92:95], a[76:79], v[212:215]
    s_waitcnt lgkmcnt(3)
    v_mfma_f32_16x16x32_bf16 v[144:147], a[96:99], v[192:195], v[144:147]
    ds_read_b128 a[96:99], v231 offset:8192
    s_waitcnt lgkmcnt(3)
    v_mfma_f32_16x16x32_bf16 v[148:151], a[100:103], v[192:195], v[148:151]
    ds_read_b128 a[100:103], v231 offset:9216
    v_exp_f32 v209, v209
    v_exp_f32 v210, v210
    v_exp_f32 v211, v211
    v_exp_f32 v212, v212
    v_exp_f32 v213, v213
    v_exp_f32 v214, v214
    v_exp_f32 v215, v215
    s_waitcnt lgkmcnt(2)
    v_mfma_f32_16x16x32_bf16 v[152:155], a[104:107], v[192:195], v[152:155]
    ds_read_b128 a[104:107], v230 offset:8192
    v_cvt_pk_bf16_f32 v196, v208, v209
    v_cvt_pk_bf16_f32 v197, v210, v211
    v_cvt_pk_bf16_f32 v198, v212, v213
    v_cvt_pk_bf16_f32 v199, v214, v215
    v_mfma_f32_16x16x32_bf16 v[156:159], a[108:111], v[192:195], v[156:159]
    ds_read_b128 a[108:111], v230 offset:9216
    v_mfma_f32_16x16x32_bf16 v[128:131], a[224:227], v[196:199], v[128:131]
    v_mfma_f32_16x16x32_bf16 v[132:135], a[228:231], v[196:199], v[132:135]
    v_smfmac_f32_16x16x64_bf16 a[128:131], a[132:135], v[192:199], v238
    s_waitcnt lgkmcnt(1)
    v_mfma_f32_16x16x32_bf16 v[136:139], a[104:107], v[196:199], v[136:139]
    ds_read_b128 a[104:107], v239 offset:8192
    s_waitcnt lgkmcnt(1)
    v_mfma_f32_16x16x32_bf16 v[140:143], a[108:111], v[196:199], v[140:143]
    ds_read_b128 a[108:111], v239 offset:9216
    v_mfma_f32_16x16x32_bf16 v[144:147], a[96:99], v[196:199], v[144:147]
    v_mfma_f32_16x16x32_bf16 v[148:151], a[100:103], v[196:199], v[148:151]
    v_accvgpr_read_b32 v224, a128
    v_accvgpr_read_b32 v226, a129
    v_add_f32 v226, v226, v224
    v_rcp_f32 v224, v226
    s_waitcnt lgkmcnt(1)
    v_mfma_f32_16x16x32_bf16 v[152:155], a[104:107], v[196:199], v[152:155]
    v_mov_b32_dpp v246, v224 row_ror:8 row_mask:0xf bank_mask:0xf
    v_mul_f32 v128, v128, v224
    v_mul_f32 v129, v129, v224
    v_mul_f32 v130, v130, v224
    s_waitcnt lgkmcnt(0)
    v_mfma_f32_16x16x32_bf16 v[156:159], a[108:111], v[196:199], v[156:159]
    v_mul_f32 v131, v131, v224
    v_mul_f32 v132, v132, v224
    v_mul_f32 v133, v133, v224
    v_mul_f32 v134, v134, v224
    v_mul_f32 v135, v135, v224
    v_mul_f32_dpp v136, v136, v246 row_ror:8 row_mask:0xf bank_mask:0xf
    v_mul_f32_dpp v137, v137, v246 row_ror:8 row_mask:0xf bank_mask:0xf
    v_mul_f32_dpp v138, v138, v246 row_ror:8 row_mask:0xf bank_mask:0xf
    v_mul_f32_dpp v139, v139, v246 row_ror:8 row_mask:0xf bank_mask:0xf
    v_mul_f32_dpp v140, v140, v246 row_ror:8 row_mask:0xf bank_mask:0xf
    v_mul_f32_dpp v141, v141, v246 row_ror:8 row_mask:0xf bank_mask:0xf
    v_mul_f32_dpp v142, v142, v246 row_ror:8 row_mask:0xf bank_mask:0xf
    v_mul_f32_dpp v143, v143, v246 row_ror:8 row_mask:0xf bank_mask:0xf
    v_cvt_pk_bf16_f32 v216, v128, v129
    v_cvt_pk_bf16_f32 v217, v130, v131
    v_cvt_pk_bf16_f32 v218, v132, v133
    v_cvt_pk_bf16_f32 v219, v134, v135
    v_cvt_pk_bf16_f32 v220, v136, v137
    v_cvt_pk_bf16_f32 v221, v138, v139
    v_cvt_pk_bf16_f32 v222, v140, v141
    v_cvt_pk_bf16_f32 v223, v142, v143
    v_cndmask_b32 v240, v216, v220, vcc
    v_cndmask_b32 v241, v217, v221, vcc
    v_cndmask_b32 v242, v218, v222, vcc
    v_cndmask_b32 v243, v219, v223, vcc
    buffer_store_dwordx4 v[240:243], v244, s[16:19], s26 offen nt
    v_cndmask_b32 v220, v220, v216, vcc
    v_cndmask_b32 v221, v221, v217, vcc
    v_cndmask_b32 v222, v222, v218, vcc
    v_cndmask_b32 v223, v223, v219, vcc
    v_mul_f32 v144, v144, v224
    v_mul_f32 v145, v145, v224
    v_mul_f32 v146, v146, v224
    v_mul_f32 v147, v147, v224
    v_mul_f32 v148, v148, v224
    v_mul_f32 v149, v149, v224
    buffer_store_dwordx4 v[220:223], v245, s[16:19], s26 offen nt
    v_mul_f32 v150, v150, v224
    v_mul_f32 v151, v151, v224
    v_mul_f32_dpp v152, v152, v246 row_ror:8 row_mask:0xf bank_mask:0xf
    v_mul_f32_dpp v153, v153, v246 row_ror:8 row_mask:0xf bank_mask:0xf
    v_mul_f32_dpp v154, v154, v246 row_ror:8 row_mask:0xf bank_mask:0xf
    v_mul_f32_dpp v155, v155, v246 row_ror:8 row_mask:0xf bank_mask:0xf
    v_mul_f32_dpp v156, v156, v246 row_ror:8 row_mask:0xf bank_mask:0xf
    v_mul_f32_dpp v157, v157, v246 row_ror:8 row_mask:0xf bank_mask:0xf
    v_mul_f32_dpp v158, v158, v246 row_ror:8 row_mask:0xf bank_mask:0xf
    v_mul_f32_dpp v159, v159, v246 row_ror:8 row_mask:0xf bank_mask:0xf
    v_cvt_pk_bf16_f32 v216, v144, v145
    v_cvt_pk_bf16_f32 v217, v146, v147
    v_cvt_pk_bf16_f32 v218, v148, v149
    v_cvt_pk_bf16_f32 v219, v150, v151
    v_cvt_pk_bf16_f32 v220, v152, v153
    v_cvt_pk_bf16_f32 v221, v154, v155
    v_cvt_pk_bf16_f32 v222, v156, v157
    v_cvt_pk_bf16_f32 v223, v158, v159
    v_cndmask_b32 v240, v216, v220, vcc
    v_cndmask_b32 v241, v217, v221, vcc
    v_cndmask_b32 v242, v218, v222, vcc
    v_cndmask_b32 v243, v219, v223, vcc
    buffer_store_dwordx4 v[240:243], v244, s[16:19], s42 offen nt
    v_cndmask_b32 v220, v220, v216, vcc
    v_cndmask_b32 v221, v221, v217, vcc
    v_cndmask_b32 v222, v222, v218, vcc
    v_cndmask_b32 v223, v223, v219, vcc
    v_max3_f32 v227, v226, v224, v227
    buffer_store_dwordx4 v[220:223], v245, s[16:19], s42 offen nt
L_main_end:
    s_mov_b32 s29, 0x4b800000
    v_cmp_lt_f32 vcc, s29, v227
    s_nop 4
    s_cbranch_vccz L_end
    s_waitcnt vmcnt(0) lgkmcnt(0)
    s_barrier
    s_lshl_b32 s45, s20, 13
    s_add_u32 s46, s45, 131072
    s_add_u32 s4, s32, s30
    s_addc_u32 s5, s33, 0
    s_mov_b32 s6, 409600
    s_mov_b32 s7, 0x20000
    s_add_u32 s8, s34, s31
    s_addc_u32 s9, s35, 0
    s_mov_b32 s10, 131072
    s_mov_b32 s11, 0x20000
    s_add_u32 s12, s36, s31
    s_addc_u32 s13, s37, 0
    s_mov_b32 s14, 131072
    s_mov_b32 s15, 0x20000
    v_mbcnt_lo_u32_b32 v217, -1, 0
    v_mbcnt_hi_u32_b32 v217, -1, v217
    v_and_b32 v219, 3, v217
    v_lshlrev_b32 v219, 4, v219
    v_lshrrev_b32 v216, 4, v217
    v_lshl_add_u32 v219, v216, 6, v219
    v_bfe_u32 v216, v217, 2, 2
    v_lshl_add_u32 v219, v216, 8, v219
    v_lshlrev_b32 v221, 6, v216
    v_lshrrev_b32 v216, 4, v217
    v_lshl_add_u32 v221, v216, 10, v221
    v_and_b32 v216, 2, v216
    v_and_b32 v220, 3, v217
    v_xor_b32 v216, v216, v220
    v_lshl_add_u32 v221, v216, 4, v221
    v_add_u32 v221, s46, v221
    v_xor_b32 v220, 32, v219
    v_lshlrev_b32 v218, 4, v217
    v_add_u32 v218, 98304, v218
    s_mov_b32 s48, 98304
L_slow_k:
    buffer_load_dwordx4 v[0:3], v219, s[8:11], s48 offen offset:0
    buffer_load_dwordx4 v[4:7], v219, s[8:11], s48 offen offset:1024
    buffer_load_dwordx4 v[8:11], v220, s[8:11], s48 offen offset:2048
    buffer_load_dwordx4 v[12:15], v220, s[8:11], s48 offen offset:3072
    s_waitcnt vmcnt(0)
    v_lshlrev_b32 v16, 16, v0
    v_and_b32 v17, 0xffff0000, v0
    v_mul_f32 v16, s27, v16
    v_mul_f32 v17, s27, v17
    v_cvt_pk_bf16_f32 v0, v16, v17
    v_lshlrev_b32 v16, 16, v1
    v_and_b32 v17, 0xffff0000, v1
    v_mul_f32 v16, s27, v16
    v_mul_f32 v17, s27, v17
    v_cvt_pk_bf16_f32 v1, v16, v17
    v_lshlrev_b32 v16, 16, v2
    v_and_b32 v17, 0xffff0000, v2
    v_mul_f32 v16, s27, v16
    v_mul_f32 v17, s27, v17
    v_cvt_pk_bf16_f32 v2, v16, v17
    v_lshlrev_b32 v16, 16, v3
    v_and_b32 v17, 0xffff0000, v3
    v_mul_f32 v16, s27, v16
    v_mul_f32 v17, s27, v17
    v_cvt_pk_bf16_f32 v3, v16, v17
    v_lshlrev_b32 v16, 16, v4
    v_and_b32 v17, 0xffff0000, v4
    v_mul_f32 v16, s27, v16
    v_mul_f32 v17, s27, v17
    v_cvt_pk_bf16_f32 v4, v16, v17
    v_lshlrev_b32 v16, 16, v5
    v_and_b32 v17, 0xffff0000, v5
    v_mul_f32 v16, s27, v16
    v_mul_f32 v17, s27, v17
    v_cvt_pk_bf16_f32 v5, v16, v17
    v_lshlrev_b32 v16, 16, v6
    v_and_b32 v17, 0xffff0000, v6
    v_mul_f32 v16, s27, v16
    v_mul_f32 v17, s27, v17
    v_cvt_pk_bf16_f32 v6, v16, v17
    v_lshlrev_b32 v16, 16, v7
    v_and_b32 v17, 0xffff0000, v7
    v_mul_f32 v16, s27, v16
    v_mul_f32 v17, s27, v17
    v_cvt_pk_bf16_f32 v7, v16, v17
    v_lshlrev_b32 v16, 16, v8
    v_and_b32 v17, 0xffff0000, v8
    v_mul_f32 v16, s27, v16
    v_mul_f32 v17, s27, v17
    v_cvt_pk_bf16_f32 v8, v16, v17
    v_lshlrev_b32 v16, 16, v9
    v_and_b32 v17, 0xffff0000, v9
    v_mul_f32 v16, s27, v16
    v_mul_f32 v17, s27, v17
    v_cvt_pk_bf16_f32 v9, v16, v17
    v_lshlrev_b32 v16, 16, v10
    v_and_b32 v17, 0xffff0000, v10
    v_mul_f32 v16, s27, v16
    v_mul_f32 v17, s27, v17
    v_cvt_pk_bf16_f32 v10, v16, v17
    v_lshlrev_b32 v16, 16, v11
    v_and_b32 v17, 0xffff0000, v11
    v_mul_f32 v16, s27, v16
    v_mul_f32 v17, s27, v17
    v_cvt_pk_bf16_f32 v11, v16, v17
    v_lshlrev_b32 v16, 16, v12
    v_and_b32 v17, 0xffff0000, v12
    v_mul_f32 v16, s27, v16
    v_mul_f32 v17, s27, v17
    v_cvt_pk_bf16_f32 v12, v16, v17
    v_lshlrev_b32 v16, 16, v13
    v_and_b32 v17, 0xffff0000, v13
    v_mul_f32 v16, s27, v16
    v_mul_f32 v17, s27, v17
    v_cvt_pk_bf16_f32 v13, v16, v17
    v_lshlrev_b32 v16, 16, v14
    v_and_b32 v17, 0xffff0000, v14
    v_mul_f32 v16, s27, v16
    v_mul_f32 v17, s27, v17
    v_cvt_pk_bf16_f32 v14, v16, v17
    v_lshlrev_b32 v16, 16, v15
    v_and_b32 v17, 0xffff0000, v15
    v_mul_f32 v16, s27, v16
    v_mul_f32 v17, s27, v17
    v_cvt_pk_bf16_f32 v15, v16, v17
    ds_write_b128 v218, v[0:3] offset:0
    ds_write_b128 v218, v[4:7] offset:1024
    ds_write_b128 v218, v[8:11] offset:2048
    ds_write_b128 v218, v[12:15] offset:3072
    s_waitcnt lgkmcnt(0)
    v_add_u32 v218, 0x1000, v218
    s_add_u32 s48, s48, 0x1000
    s_cmp_lt_u32 s48, 0x20000
    s_cbranch_scc1 L_slow_k
    s_mov_b32 s25, 0
L_slow_tile:
    buffer_load_dwordx4 a[0:3], v237, s[4:7], s25 offen offset:0
    buffer_load_dwordx4 a[4:7], v237, s[4:7], s25 offen offset:64
    buffer_load_dwordx4 a[8:11], v237, s[4:7], s25 offen offset:128
    buffer_load_dwordx4 a[12:15], v237, s[4:7], s25 offen offset:192
    v_mov_b32 v216, 0xff800000
    v_mov_b32 v218, v228
    s_mov_b32 s48, 0
    s_waitcnt vmcnt(0)
L_slow_max:
    ds_read_b128 a[16:19], v218 offset:0
    ds_read_b128 a[20:23], v218 offset:256
    ds_read_b128 a[24:27], v218 offset:512
    ds_read_b128 a[28:31], v218 offset:768
    ds_read_b128 a[32:35], v218 offset:4096
    ds_read_b128 a[36:39], v218 offset:4352
    ds_read_b128 a[40:43], v218 offset:4608
    ds_read_b128 a[44:47], v218 offset:4864
    s_waitcnt lgkmcnt(0)
    v_mfma_f32_16x16x32_bf16 v[200:203], a[16:19], a[0:3], 0
    v_mfma_f32_16x16x32_bf16 v[200:203], a[20:23], a[4:7], v[200:203]
    v_mfma_f32_16x16x32_bf16 v[200:203], a[24:27], a[8:11], v[200:203]
    v_mfma_f32_16x16x32_bf16 v[200:203], a[28:31], a[12:15], v[200:203]
    v_mfma_f32_16x16x32_bf16 v[204:207], a[32:35], a[0:3], 0
    v_mfma_f32_16x16x32_bf16 v[204:207], a[36:39], a[4:7], v[204:207]
    v_mfma_f32_16x16x32_bf16 v[204:207], a[40:43], a[8:11], v[204:207]
    v_mfma_f32_16x16x32_bf16 v[204:207], a[44:47], a[12:15], v[204:207]
    s_nop 15
    v_max3_f32 v216, v200, v201, v216
    v_max3_f32 v216, v202, v203, v216
    v_max3_f32 v216, v204, v205, v216
    v_max3_f32 v216, v206, v207, v216
    v_add_u32 v218, 0x2000, v218
    s_add_u32 s48, s48, 1
    s_cmp_lt_u32 s48, 16
    s_cbranch_scc1 L_slow_max
    v_mov_b32 v217, v216
    s_nop 3
    v_permlane16_swap_b32 v216, v217
    s_nop 3
    v_max_f32 v216, v216, v217
    v_mov_b32 v217, v216
    s_nop 3
    v_permlane32_swap_b32 v216, v217
    s_nop 3
    v_max_f32 v216, v216, v217
    v_sub_f32 v208, 0, v216
    v_sub_f32 v209, 0, v216
    v_sub_f32 v210, 0, v216
    v_sub_f32 v211, 0, v216
    v_mov_b32 v0, 0
    v_mov_b32 v1, 0
    v_mov_b32 v2, 0
    v_mov_b32 v3, 0
    v_mov_b32 v4, 0
    v_mov_b32 v5, 0
    v_mov_b32 v6, 0
    v_mov_b32 v7, 0
    v_mov_b32 v8, 0
    v_mov_b32 v9, 0
    v_mov_b32 v10, 0
    v_mov_b32 v11, 0
    v_mov_b32 v12, 0
    v_mov_b32 v13, 0
    v_mov_b32 v14, 0
    v_mov_b32 v15, 0
    v_mov_b32 v16, 0
    v_mov_b32 v17, 0
    v_mov_b32 v18, 0
    v_mov_b32 v19, 0
    v_mov_b32 v20, 0
    v_mov_b32 v21, 0
    v_mov_b32 v22, 0
    v_mov_b32 v23, 0
    v_mov_b32 v24, 0
    v_mov_b32 v25, 0
    v_mov_b32 v26, 0
    v_mov_b32 v27, 0
    v_mov_b32 v28, 0
    v_mov_b32 v29, 0
    v_mov_b32 v30, 0
    v_mov_b32 v31, 0
    v_accvgpr_write_b32 a112, 0
    v_accvgpr_write_b32 a113, 0
    v_accvgpr_write_b32 a114, 0
    v_accvgpr_write_b32 a115, 0
    v_mov_b32 v218, v228
    s_mov_b32 s48, 0
L_slow_kv:
    s_add_u32 m0, s46, 0
    s_add_u32 s24, s48, 0
    buffer_load_dwordx4 v219, s[12:15], s24 offen offset:0 lds
    buffer_load_dwordx4 v219, s[12:15], s24 offen offset:1024 lds
    buffer_load_dwordx4 v220, s[12:15], s24 offen offset:2048 lds
    buffer_load_dwordx4 v220, s[12:15], s24 offen offset:3072 lds
    s_add_u32 m0, s46, 4096
    s_add_u32 s24, s48, 4096
    buffer_load_dwordx4 v219, s[12:15], s24 offen offset:0 lds
    buffer_load_dwordx4 v219, s[12:15], s24 offen offset:1024 lds
    buffer_load_dwordx4 v220, s[12:15], s24 offen offset:2048 lds
    buffer_load_dwordx4 v220, s[12:15], s24 offen offset:3072 lds
    ds_read_b128 a[16:19], v218 offset:0
    ds_read_b128 a[20:23], v218 offset:256
    ds_read_b128 a[24:27], v218 offset:512
    ds_read_b128 a[28:31], v218 offset:768
    ds_read_b128 a[32:35], v218 offset:4096
    ds_read_b128 a[36:39], v218 offset:4352
    ds_read_b128 a[40:43], v218 offset:4608
    ds_read_b128 a[44:47], v218 offset:4864
    s_waitcnt lgkmcnt(0)
    v_mfma_f32_16x16x32_bf16 v[200:203], a[16:19], a[0:3], v[208:211]
    v_mfma_f32_16x16x32_bf16 v[200:203], a[20:23], a[4:7], v[200:203]
    v_mfma_f32_16x16x32_bf16 v[200:203], a[24:27], a[8:11], v[200:203]
    v_mfma_f32_16x16x32_bf16 v[200:203], a[28:31], a[12:15], v[200:203]
    v_mfma_f32_16x16x32_bf16 v[204:207], a[32:35], a[0:3], v[208:211]
    v_mfma_f32_16x16x32_bf16 v[204:207], a[36:39], a[4:7], v[204:207]
    v_mfma_f32_16x16x32_bf16 v[204:207], a[40:43], a[8:11], v[204:207]
    v_mfma_f32_16x16x32_bf16 v[204:207], a[44:47], a[12:15], v[204:207]
    s_nop 15
    v_exp_f32 v200, v200
    v_exp_f32 v201, v201
    v_exp_f32 v202, v202
    v_exp_f32 v203, v203
    v_exp_f32 v204, v204
    v_exp_f32 v205, v205
    v_exp_f32 v206, v206
    v_exp_f32 v207, v207
    s_nop 1
    v_cvt_pk_bf16_f32 v160, v200, v201
    v_cvt_pk_bf16_f32 v161, v202, v203
    v_cvt_pk_bf16_f32 v162, v204, v205
    v_cvt_pk_bf16_f32 v163, v206, v207
    s_waitcnt vmcnt(0)
    ds_read_b64_tr_b16 a[96:97], v221 offset:0
    ds_read_b64_tr_b16 a[98:99], v221 offset:4096
    ds_read_b64_tr_b16 a[100:101], v221 offset:8
    ds_read_b64_tr_b16 a[102:103], v221 offset:4104
    ds_read_b64_tr_b16 a[104:105], v221 offset:256
    ds_read_b64_tr_b16 a[106:107], v221 offset:4352
    ds_read_b64_tr_b16 a[108:109], v221 offset:264
    ds_read_b64_tr_b16 a[110:111], v221 offset:4360
    s_waitcnt lgkmcnt(0)
    v_mfma_f32_16x16x32_bf16 v[0:3], a[96:99], v[160:163], v[0:3]
    v_mfma_f32_16x16x32_bf16 v[4:7], a[100:103], v[160:163], v[4:7]
    v_mfma_f32_16x16x32_bf16 v[8:11], a[104:107], v[160:163], v[8:11]
    v_mfma_f32_16x16x32_bf16 v[12:15], a[108:111], v[160:163], v[12:15]
    s_nop 7
    ds_read_b64_tr_b16 a[96:97], v221 offset:512
    ds_read_b64_tr_b16 a[98:99], v221 offset:4608
    ds_read_b64_tr_b16 a[100:101], v221 offset:520
    ds_read_b64_tr_b16 a[102:103], v221 offset:4616
    ds_read_b64_tr_b16 a[104:105], v221 offset:768
    ds_read_b64_tr_b16 a[106:107], v221 offset:4864
    ds_read_b64_tr_b16 a[108:109], v221 offset:776
    ds_read_b64_tr_b16 a[110:111], v221 offset:4872
    s_waitcnt lgkmcnt(0)
    v_mfma_f32_16x16x32_bf16 v[16:19], a[96:99], v[160:163], v[16:19]
    v_mfma_f32_16x16x32_bf16 v[20:23], a[100:103], v[160:163], v[20:23]
    v_mfma_f32_16x16x32_bf16 v[24:27], a[104:107], v[160:163], v[24:27]
    v_mfma_f32_16x16x32_bf16 v[28:31], a[108:111], v[160:163], v[28:31]
    s_nop 7
    v_mfma_f32_16x16x32_bf16 a[112:115], a[132:135], v[160:163], a[112:115]
    s_nop 7
    v_add_u32 v218, 0x2000, v218
    s_add_u32 s48, s48, 0x2000
    s_cmp_lt_u32 s48, 0x20000
    s_cbranch_scc1 L_slow_kv
    s_nop 15
    v_accvgpr_read_b32 v226, a112
    s_nop 1
    v_rcp_f32 v224, v226
    s_nop 1
    v_mul_f32 v0, v0, v224
    v_mul_f32 v1, v1, v224
    v_mul_f32 v2, v2, v224
    v_mul_f32 v3, v3, v224
    v_mul_f32 v4, v4, v224
    v_mul_f32 v5, v5, v224
    v_mul_f32 v6, v6, v224
    v_mul_f32 v7, v7, v224
    v_mul_f32 v8, v8, v224
    v_mul_f32 v9, v9, v224
    v_mul_f32 v10, v10, v224
    v_mul_f32 v11, v11, v224
    v_mul_f32 v12, v12, v224
    v_mul_f32 v13, v13, v224
    v_mul_f32 v14, v14, v224
    v_mul_f32 v15, v15, v224
    v_mul_f32 v16, v16, v224
    v_mul_f32 v17, v17, v224
    v_mul_f32 v18, v18, v224
    v_mul_f32 v19, v19, v224
    v_mul_f32 v20, v20, v224
    v_mul_f32 v21, v21, v224
    v_mul_f32 v22, v22, v224
    v_mul_f32 v23, v23, v224
    v_mul_f32 v24, v24, v224
    v_mul_f32 v25, v25, v224
    v_mul_f32 v26, v26, v224
    v_mul_f32 v27, v27, v224
    v_mul_f32 v28, v28, v224
    v_mul_f32 v29, v29, v224
    v_mul_f32 v30, v30, v224
    v_mul_f32 v31, v31, v224
    v_cvt_pk_bf16_f32 v32, v0, v1
    v_cvt_pk_bf16_f32 v33, v2, v3
    v_cvt_pk_bf16_f32 v34, v4, v5
    v_cvt_pk_bf16_f32 v35, v6, v7
    v_cvt_pk_bf16_f32 v36, v8, v9
    v_cvt_pk_bf16_f32 v37, v10, v11
    v_cvt_pk_bf16_f32 v38, v12, v13
    v_cvt_pk_bf16_f32 v39, v14, v15
    v_cvt_pk_bf16_f32 v40, v16, v17
    v_cvt_pk_bf16_f32 v41, v18, v19
    v_cvt_pk_bf16_f32 v42, v20, v21
    v_cvt_pk_bf16_f32 v43, v22, v23
    v_cvt_pk_bf16_f32 v44, v24, v25
    v_cvt_pk_bf16_f32 v45, v26, v27
    v_cvt_pk_bf16_f32 v46, v28, v29
    v_cvt_pk_bf16_f32 v47, v30, v31
    s_nop 3
    buffer_store_dwordx4 v[32:35], v237, s[16:19], s25 offen offset:0
    buffer_store_dwordx4 v[36:39], v237, s[16:19], s25 offen offset:64
    buffer_store_dwordx4 v[40:43], v237, s[16:19], s25 offen offset:128
    buffer_store_dwordx4 v[44:47], v237, s[16:19], s25 offen offset:192
    s_waitcnt vmcnt(0)
    s_add_u32 s25, s25, 16384
    s_cmp_lt_u32 s25, 409600
    s_cbranch_scc1 L_slow_tile
L_end:
    s_endpgm
.section .rodata,"a"
.p2align 6
.amdhsa_kernel standalone__mha_softmax__near_ridge_kernel
  .amdhsa_next_free_vgpr 512
  .amdhsa_next_free_sgpr 64
  .amdhsa_accum_offset 256
  .amdhsa_group_segment_fixed_size 0
  .amdhsa_kernarg_size 48
  .amdhsa_user_sgpr_count 2
  .amdhsa_user_sgpr_kernarg_segment_ptr 1
  .amdhsa_system_sgpr_workgroup_id_x 1
.end_amdhsa_kernel
```
